```python
import torch

def _softmax(x, axis=-1):
    return torch.softmax(x, dim=axis)
def _gelu(x):
    return torch.nn.functional.gelu(x, approximate="tanh")
def _silu(x):
    return torch.nn.functional.silu(x)
def _sigmoid(x):
    return torch.sigmoid(x)
def _layernorm(x, axis=-1, eps=1e-5):
    m = x.mean(dim=axis, keepdim=True)
    v = x.var(dim=axis, keepdim=True, unbiased=False)
    return (x - m) / torch.sqrt(v + eps)
def _scatter_add(tgt, idx, src, axis=0):
    return tgt.clone().index_add_(axis, idx, src)
def _segment_sum(src, seg, n):
    out = torch.zeros((n,) + src.shape[1:], dtype=src.dtype)
    return out.index_add_(0, seg, src)
def _pad(x, pw):
    flat = tuple(v for pair in reversed(pw) for v in pair)
    return torch.nn.functional.pad(x, flat)

kernel_name = 'recurrent_scan__linear_attn_block__mixer_token_mlp__prompt'

def setup_inputs():

    _w = (lambda a: (lambda t: t.to(torch.bfloat16) if t.is_floating_point() else t)(torch.as_tensor(a)))
    def _A_setup():
        B, S, D = 1, 2048, 512
        return {
            "x": _w((lambda *s: torch.randn(*s, dtype=torch.bfloat16) * 0.05)(B, S, D)),
            "wqkv": _w((lambda *s: torch.randn(*s, dtype=torch.bfloat16) * 0.2)(D, 3 * D)),
            "wo": _w((lambda *s: torch.randn(*s, dtype=torch.bfloat16) * 0.2)(D, D)),
        }
    _A_in = _A_setup()

    def _B_setup():
        B, S, D, F = 1, 2048, 512, 1792
        return {
            "x": _w((lambda *s: torch.randn(*s, dtype=torch.bfloat16) * 0.05)(B, S, D)),
            "w1": _w((lambda *s: torch.randn(*s, dtype=torch.bfloat16) * 0.4)(S, F) * (S ** -0.5)),
            "b1": _w((lambda *s: torch.randn(*s, dtype=torch.bfloat16) * 3.2)(F) * 0.02),
            "w2": _w((lambda *s: torch.randn(*s, dtype=torch.bfloat16) * 0.1)(F, S) * (F ** -0.5)),
            "b2": _w((lambda *s: torch.randn(*s, dtype=torch.bfloat16) * 0.2)(S) * 0.02),
        }
    _B_in = _B_setup()

    return {
        "A_x": _A_in["x"],
        "A_wqkv": _A_in["wqkv"],
        "A_wo": _A_in["wo"],
        "B_x": _B_in["x"],
        "B_w1": _B_in["w1"],
        "B_b1": _B_in["b1"],
        "B_w2": _B_in["w2"],
        "B_b2": _B_in["b2"],
    }

def reference(A_x, A_wqkv, A_wo, B_x, B_w1, B_b1, B_w2, B_b2):
    def _A_ref(x, wqkv, wo):
        B, S, D = x.shape
        H = 32; Dh = D // H
        qkv = (lambda x, *d: x.permute(*d))((x @ wqkv).reshape(B, S, 3, H, Dh), 2, 0, 3, 1, 4)
        q, k, v = qkv[0], qkv[1], qkv[2]
        phi = lambda t: torch.where(t > 0, t + 1, torch.exp(t)) + 1e-6
        pq, pk = phi(q), phi(k)
        kv = torch.einsum("bhsd,bhse->bhde", pk, v)
        z = torch.einsum("bhsd->bhd", pk)
        num = torch.einsum("bhqd,bhde->bhqe", pq, kv)
        den = torch.einsum("bhqd,bhd->bhq", pq, z)[..., None] + 1e-6
        o = num / den
        return (lambda x, *d: x.permute(*d))(o, 0, 2, 1, 3).reshape(B, S, D) @ wo

    def _B_ref(x, w1, b1, w2, b2):
        B, S, D = x.shape
        h = _layernorm(x, axis=-1)
        u = torch.einsum("bsd,sf->bdf", h, w1) + b1
        u = _gelu(u)
        y = torch.einsum("bdf,fs->bds", u, w2) + b2
        return (lambda x, *d: x.permute(*d))(y, 0, 2, 1)

    x = A_x
    xn = _layernorm(x, axis=-1)
    s = _A_ref(xn, A_wqkv, A_wo)
    g = _silu(_B_ref(xn, B_w1, B_b1, B_w2, B_b2))
    return x + s * g
```

```asm
; @launch grid=(256,1,1) block=(256,1,1) lds=163840
.amdgcn_target "amdgcn-amd-amdhsa--gfx950"
.text
.globl recurrent_scan__linear_attn_block__mixer_token_mlp__prompt_kernel
.p2align 8
.type recurrent_scan__linear_attn_block__mixer_token_mlp__prompt_kernel,@function
recurrent_scan__linear_attn_block__mixer_token_mlp__prompt_kernel:
L_first:
    s_load_dwordx2 s[8:9], s[0:1], 0
    s_load_dwordx2 s[28:29], s[0:1], 80
    s_lshr_b32 s56, s2, 3
    s_cmp_ge_u32 s56, 32
    s_cbranch_scc1 L_end
    s_getpc_b64 s[70:71]
    s_lshl_b32 s58, s56, 10
    v_lshl_add_u32 v84, v0, 2, s58
    global_load_dword v84, v84, s[70:71]
    s_and_b32 s55, s2, 7
    s_xor_b32 s55, s55, 1
    s_lshl_b32 s55, s55, 5
    s_add_u32 s55, s55, s56
    s_lshl_b32 s57, s55, 13
    s_lshl_b32 s10, 1, 21
    s_lshl_b32 s11, 1, 17
    v_lshrrev_b32 v24, 5, v0
    v_and_b32 v2, 31, v0
    v_lshlrev_b32 v5, 4, v2
    v_lshl_add_u32 v7, v24, 10, v5
    s_waitcnt lgkmcnt(0)
    buffer_load_dwordx4 v[44:47], v7, s[8:11], s57 offen
    buffer_load_dwordx4 v[48:51], v7, s[8:11], s57 offen offset:512
    s_load_dwordx2 s[12:13], s[0:1], 8
    s_load_dwordx2 s[20:21], s[0:1], 32
    s_load_dwordx2 s[36:37], s[0:1], 72
    s_mov_b32 s30, 0x10000000
    s_mov_b32 s31, 0x20000
    v_mov_b32 v76, 0
    v_mov_b32 v77, 0
    v_mov_b32 v78, 0
    v_mov_b32 v79, 0
    s_cmp_lg_u32 s2, 0
    s_cbranch_scc1 L_noinit0
    v_lshlrev_b32_e64 v11, 4, v0
    v_add_u32 v11, 0x620000, v11
    buffer_store_dwordx4 v[76:79], v11, s[28:31], 0 offen sc1
    s_movk_i32 s57, 0x1000
    buffer_store_dwordx4 v[76:79], v11, s[28:31], s57 offen sc1
L_noinit0:
    v_lshrrev_b32 v4, 6, v0
    v_and_b32_e64 v1, 63, v0
    v_readfirstlane_b32 s48, v4
    v_bfe_u32 v3, v0, 5, 1
    s_lshl_b32 s57, s55, 3
    v_add_u32 v24, s57, v24
    s_and_b32 s6, s2, 1
    s_bfe_u32 s7, s2, 0x20001
    s_and_b32 s3, s56, 3
    s_lshr_b32 s4, s56, 2
    s_mov_b32 s14, 0x180000
    s_mov_b32 s15, 0x20000
    s_mov_b32 s38, 0x100
    s_mov_b32 s39, 0x20000
    s_mov_b32 s22, 0x700000
    s_mov_b32 s23, 0x20000
    s_lshl_b32 s60, s48, 13
    v_and_b32 v4, 7, v1
    v_bfe_u32 v5, v1, 4, 1
    v_lshlrev_b32 v5, 2, v5
    v_xor_b32 v4, v4, v5
    v_lshlrev_b32_e64 v13, 4, v4
    v_mov_b32 v12, 1
    s_add_u32 s58, s58, 0x8000
    s_min_u32 s58, s58, L_last - L_first - 1152
    v_lshl_add_u32 v86, v0, 2, s58
    global_load_dword v86, v86, s[70:71]
    s_waitcnt lgkmcnt(0)
    s_load_dwordx2 s[16:17], s[0:1], 16
    s_load_dwordx2 s[24:25], s[0:1], 48
    s_load_dwordx2 s[32:33], s[0:1], 64
    s_load_dwordx2 s[40:41], s[0:1], 40
    s_load_dwordx2 s[44:45], s[0:1], 56
    s_cmp_eq_u32 s6, 1
    s_cbranch_scc1 L_preA
    s_cmp_eq_u32 s4, 0
    s_cbranch_scc1 L_preP
    s_mov_b32 s5, 0
    s_mul_i32 s57, s7, 28
    s_lshr_b32 s56, s2, 3
    s_add_u32 s56, s56, s57
    s_sub_u32 s56, s56, 4
    s_lshr_b32 s52, s56, 3
    s_and_b32 s51, s56, 7
    s_mul_i32 s66, s51, 2
    s_mul_i32 s56, s52, 0
    s_add_u32 s66, s66, s56
    s_and_b32 s66, s66, 15
    s_lshl_b32 s67, s66, 11
    s_mul_i32 s66, s66, 57344
    s_mul_i32 s56, s48, 1835008
    s_lshl_b32 s57, s52, 8
    s_add_u32 s56, s56, s57
    s_lshr_b32 s57, s48, 1
    s_lshl_b32 s57, s57, 7
    s_add_u32 s56, s56, s57
    v_lshrrev_b32 v4, 3, v1
    v_mul_u32_u24 v4, 3584, v4
    v_add3_u32 v14, v4, v13, s56
    v_add_u32 v15, 0x6c00, v14
    v_xor_b32 v16, 0x80, v14
    v_xor_b32 v17, 0x80, v15
    s_add_u32 m0, s60, 0x0
    s_nop 0
    buffer_load_dwordx4 v14, s[20:23], s66 offen lds
    buffer_load_dwordx4 v15, s[20:23], s66 offen offset:1024 lds
    s_add_u32 m0, s60, 0x800
    s_nop 0
    buffer_load_dwordx4 v16, s[20:23], s66 offen lds
    s_lshr_b32 s57, s67, 11
    v_add_u32 v4, s57, v2
    v_cmp_lt_u32 vcc, 15, v2
    v_and_b32 v4, 15, v4
    s_nop 0
    v_cndmask_b32_e64 v4, v4, v2, vcc
    v_mul_u32_u24 v21, 57344, v4
    v_lshlrev_b32_e64 v22, 11, v4
    buffer_load_dwordx4 v17, s[20:23], s66 offen offset:1024 lds
    v_readlane_b32 s66, v21, 1
    s_add_u32 m0, s60, 0x1000
    s_nop 3
    buffer_load_dwordx4 v14, s[20:23], s66 offen lds
    buffer_load_dwordx4 v15, s[20:23], s66 offen offset:1024 lds
    s_lshl_b32 s56, s52, 8
    s_lshl_b32 s57, s48, 6
    s_add_u32 s56, s56, s57
    v_lshl_add_u32 v29, v3, 3, s56
    s_branch L_ln
L_preP:
    s_mov_b32 s5, 2
    s_mul_i32 s57, s7, 28
    s_lshr_b32 s56, s2, 3
    s_bitcmp1_b32 s7, 0
    s_cselect_b32 s58, 0, 32
    s_add_u32 s56, s56, s58
    s_add_u32 s56, s56, s57
    s_sub_u32 s56, s56, 4
    s_lshr_b32 s52, s56, 3
    s_and_b32 s51, s56, 7
    s_mul_i32 s66, s51, 2
    s_mul_i32 s56, s52, 0
    s_add_u32 s66, s66, s56
    s_and_b32 s66, s66, 15
    s_lshl_b32 s67, s66, 11
    s_mul_i32 s66, s66, 57344
    s_mul_i32 s56, s48, 1835008
    s_lshl_b32 s57, s52, 8
    s_add_u32 s56, s56, s57
    v_lshrrev_b32_e64 v4, 1, v1
    v_mul_u32_u24 v4, 3584, v4
    v_and_b32_e64 v5, 1, v1
    v_lshlrev_b32 v5, 7, v5
    v_add3_u32 v14, v4, v5, s56
    s_lshl_b32 s56, s7, 2
    s_add_u32 s56, s56, s3
    s_lshl_b32 s57, s56, 11
    s_add_u32 s57, s57, 0x600000
    v_lshl_add_u32 v15, v0, 3, s57
    s_lshl_b32 s57, s56, 7
    s_add_u32 s57, s57, 0x608000
    s_lshl_b32 s58, s56, 9
    s_lshl_b32 s59, s48, 15
    s_add_u32 s58, s58, s59
    s_add_u32 s58, s58, 0x628000
    s_cmp_eq_u32 s48, 3
    s_cselect_b32 s57, s57, s58
    s_cselect_b32 s58, 15, 63
    v_and_b32 v4, s58, v1
    v_lshl_add_u32 v16, v4, 3, s57
    s_lshl_b32 s57, s48, 2
    s_cmp_eq_u32 s2, 0
    s_cselect_b32 s57, s57, 0x80000000
    v_mov_b32_e64 v6, s57
    s_cbranch_scc0 L_noinit1
    s_waitcnt vmcnt(1)
L_noinit1:
    buffer_store_dword v12, v6, s[36:39], 0 offen sc1
    buffer_store_dwordx2 v[76:77], v15, s[28:31], 0 offen sc1
    buffer_store_dwordx2 v[76:77], v16, s[28:31], 0 offen sc1
    v_mov_b32 v4, 0x80000000
    buffer_load_dword v99, v4, s[28:31], 0 offen
    buffer_load_dword v100, v4, s[28:31], 0 offen
    buffer_load_dword v101, v4, s[28:31], 0 offen
    s_branch L_ln
L_preA:
    s_mov_b32 s5, 1
    s_lshl_b32 s50, s7, 1
    s_and_b32 s56, s3, 1
    s_add_u32 s50, s50, s56
    s_lshr_b32 s49, s2, 4
    s_mul_i32 s56, s49, 1
    s_mul_i32 s57, s50, 0
    s_add_u32 s61, s56, s57
    s_and_b32 s61, s61, 7
    s_mov_b32 s57, 0x75634120
    s_bitcmp1_b32 s49, 3
    s_cselect_b32 s57, s57, 0x75634120
    s_bitcmp1_b32 s50, 0
    s_cselect_b32 s57, s57, 0x76543210
    s_mul_i32 s67, s61, 0x11111111
    s_add_u32 s67, s67, s57
    s_lshl_b32 s71, s48, 12
    s_mul_i32 s65, s48, 6144
    s_add_u32 s65, s65, 16384
    v_lshrrev_b32_e64 v5, 3, v1
    s_mul_i32 s56, s48, 49152
    s_lshl_b32 s57, s50, 7
    s_add_u32 s56, s56, s57
    v_mul_u32_u24 v4, 3072, v5
    v_add3_u32 v18, v4, v13, s56
    v_add_u32 v19, 0x6000, v18
    v_xor_b32 v30, 0x80, v18
    v_xor_b32 v31, 0x80, v19
    v_and_b32 v4, 7, v1
    v_lshrrev_b32 v6, 4, v1
    v_xor_b32 v4, v4, v6
    v_lshlrev_b32 v4, 4, v4
    v_lshl_add_u32 v4, v5, 10, v4
    s_lshl_b32 s56, s49, 17
    s_lshl_b32 s57, s48, 15
    s_add_u32 s56, s56, s57
    v_add_u32 v14, s56, v4
    v_xor_b32 v4, 64, v14
    v_add_u32 v15, 0x1c00, v4
    v_add_u32 v16, 0x3800, v14
    v_add_u32 v17, 0x5400, v4
    s_bfe_u32 s61, s67, 0x30000
    s_mul_i32 s63, s61, 196608
    s_lshl_b32 s62, s61, 7
    s_add_u32 m0, s65, 0x0
    s_nop 0
    buffer_load_dwordx4 v30, s[12:15], s63 offen offset:0 lds
    buffer_load_dwordx4 v18, s[12:15], s63 offen offset:1024 lds
    buffer_load_dwordx4 v18, s[12:15], s63 offen offset:2048 lds
    s_add_u32 m0, s71, 0x0
    s_nop 0
    buffer_load_dwordx4 v14, s[8:11], s62 offen offset:0 lds
    buffer_load_dwordx4 v15, s[8:11], s62 offen offset:1024 lds
    s_add_u32 m0, s65, 0xc00
    s_nop 0
    buffer_load_dwordx4 v31, s[12:15], s63 offen offset:0 lds
    s_lshl_b32 s56, s49, 3
    s_add_u32 s56, s56, s50
    s_lshl_b32 s56, s56, 2
    s_add_u32 s56, s56, s48
    s_lshl_b32 s56, s56, 10
    v_lshl_add_u32 v29, v1, 4, s56
L_ln:
    s_mov_b32 s18, 0x80000
    s_mov_b32 s19, 0x20000
    s_mov_b32 s26, 0x700000
    s_mov_b32 s27, 0x20000
    s_mov_b32 s34, 0x200000
    s_mov_b32 s35, 0x20000
    s_mov_b32 s42, 0xe00
    s_mov_b32 s43, 0x20000
    s_mov_b32 s46, 0x1000
    s_mov_b32 s47, 0x20000
    s_lshl_b32 s64, s48, 11
    s_mov_b32 s72, 0x0000ffff
    s_mov_b32 s73, 0x0000ffff
    s_mov_b32 s53, s4
    s_lshr_b32 s56, s55, 5
    s_lshl_b32 s56, s56, 2
    s_add_u32 s54, s56, s3
    s_mul_i32 s68, s53, 0
    s_mul_i32 s56, s54, 0
    s_add_u32 s68, s68, s56
    s_mul_i32 s56, s68, 2341
    s_lshr_b32 s56, s56, 16
    s_mul_i32 s56, s56, 28
    s_sub_u32 s68, s68, s56
    s_lshl_b32 s69, s68, 11
    s_lshl_b32 s68, s68, 16
    v_mov_b32 v8, 0x80000000
    v_lshlrev_b32 v25, 3, v24
    v_cmp_eq_u32_e64 vcc, 0, v2
    v_add_u32 v25, 0x610000, v25
    v_and_b32 v4, 7, v24
    v_cndmask_b32 v25, v8, v25, vcc
    v_mul_u32_u24 v4, 1088, v4
    v_lshl_add_u32 v4, v2, 4, v4
    s_cmp_eq_u32 s5, 0
    s_cselect_b32 s59, 2, 4
    s_lshl_b32 s59, s59, 15
    v_add_u32 v26, s59, v4
    v_bfe_u32 v4, v1, 2, 2
    v_mul_u32_u24 v4, 1088, v4
    v_lshrrev_b32_e64 v5, 4, v1
    v_lshl_add_u32 v4, v5, 5, v4
    v_and_b32_e64 v5, 3, v1
    v_lshl_add_u32 v4, v5, 3, v4
    s_lshl_b32 s56, s48, 8
    s_add_u32 s56, s56, s59
    v_add_u32 v27, s56, v4
    s_lshr_b32 s56, s55, 1
    s_lshl_b32 s56, s56, 11
    s_and_b32 s57, s55, 1
    s_lshl_b32 s57, s57, 9
    s_add_u32 s56, s56, s57
    s_lshl_b32 s57, s48, 19
    s_add_u32 s56, s56, s57
    v_lshlrev_b32_e64 v4, 4, v2
    v_lshl_add_u32 v4, v3, 10, v4
    v_add_u32 v28, s56, v4
    v_lshrrev_b32 v11, 2, v0
    v_and_b32 v11, 0xfc, v11
    v_cmp_gt_u32 vcc, 64, v0
    s_nop 1
    v_cndmask_b32_e64 v11, v8, v11, vcc
    s_mov_b32 s56, s55
    s_lshl_b32 s56, s56, 4
    s_add_u32 s56, s56, 0x620000
    v_mov_b32_e64 v9, s56
    s_mov_b32 s58, 0x40000
    v_mov_b32 v36, 0x3727c5ac
    s_lshl_b32 s56, s54, 7
    v_lshrrev_b32 v4, 2, v0
    v_lshl_add_u32 v4, v4, 1, s56
    s_waitcnt lgkmcnt(0)
    buffer_load_ushort v43, v4, s[44:47], 0 offen
    s_cmp_eq_u32 s5, 1
    s_cbranch_scc1 L_midA
    s_cmp_eq_u32 s5, 2
    s_cbranch_scc1 L_midP
    buffer_load_dword v85, v29, s[40:43], 0 offen
    s_add_u32 m0, s60, 0x1800
    s_nop 0
    buffer_load_dwordx4 v16, s[20:23], s66 offen lds
    buffer_load_dwordx4 v17, s[20:23], s66 offen offset:1024 lds
    v_readlane_b32 s66, v21, 2
    s_add_u32 m0, s60, 0x18000
    s_nop 3
    buffer_load_dwordx4 v14, s[20:23], s66 offen lds
    buffer_load_dwordx4 v15, s[20:23], s66 offen offset:1024 lds
    s_branch L_ln2
L_midP:
    buffer_load_dword v108, v8, s[28:31], 0 offen
    buffer_load_dword v109, v8, s[28:31], 0 offen
    buffer_load_dword v110, v8, s[28:31], 0 offen
    buffer_load_dword v111, v8, s[28:31], 0 offen
    buffer_load_dword v92, v14, s[20:23], s66 offen
    s_add_u32 s66, s66, 114688
    s_add_u32 s66, s66, 802816
    v_add_u32 v14, 0xe0000, v14
    s_cmp_ge_u32 s66, 917504
    s_cselect_b32 s59, 917504, 0
    s_sub_u32 s66, s66, s59
    s_branch L_ln2
L_midA:
    buffer_load_dword v85, v29, s[16:19], 0 offen
    buffer_load_dwordx4 v19, s[12:15], s63 offen offset:1024 lds
    buffer_load_dwordx4 v19, s[12:15], s63 offen offset:2048 lds
    s_add_u32 m0, s71, 0x0
    s_nop 0
    buffer_load_dwordx4 v16, s[8:11], s62 offen offset:2048 lds
    buffer_load_dwordx4 v17, s[8:11], s62 offen offset:3072 lds
L_ln2:
    s_waitcnt vmcnt(14)
    v_lshlrev_b32 v52, 16, v44
    v_and_b32 v53, 0xffff0000, v44
    v_lshlrev_b32_e64 v54, 16, v45
    v_and_b32 v55, 0xffff0000, v45
    v_lshlrev_b32_e64 v56, 16, v46
    v_and_b32 v57, 0xffff0000, v46
    v_lshlrev_b32_e64 v58, 16, v47
    v_and_b32 v59, 0xffff0000, v47
    s_waitcnt vmcnt(13)
    v_lshlrev_b32 v60, 16, v48
    v_and_b32 v61, 0xffff0000, v48
    v_lshlrev_b32_e64 v62, 16, v49
    v_and_b32 v63, 0xffff0000, v49
    v_lshlrev_b32_e64 v64, 16, v50
    v_and_b32 v65, 0xffff0000, v50
    v_lshlrev_b32_e64 v66, 16, v51
    v_and_b32 v67, 0xffff0000, v51
    v_pk_add_f32 v[68:69], v[52:53], v[54:55]
    v_pk_add_f32 v[68:69], v[68:69], v[56:57]
    v_pk_add_f32 v[68:69], v[68:69], v[58:59]
    v_pk_add_f32 v[68:69], v[68:69], v[60:61]
    v_pk_add_f32 v[68:69], v[68:69], v[62:63]
    v_pk_add_f32 v[68:69], v[68:69], v[64:65]
    v_pk_add_f32 v[68:69], v[68:69], v[66:67]
    v_add_f32 v68, v68, v69
    s_nop 1
    v_add_f32_dpp v68, v68, v68 quad_perm:[1,0,3,2] row_mask:0xf bank_mask:0xf
    s_nop 1
    v_add_f32_dpp v68, v68, v68 quad_perm:[2,3,0,1] row_mask:0xf bank_mask:0xf
    s_nop 1
    v_add_f32_dpp v68, v68, v68 row_half_mirror row_mask:0xf bank_mask:0xf
    s_nop 1
    v_add_f32_dpp v68, v68, v68 row_mirror row_mask:0xf bank_mask:0xf
    v_mov_b32 v4, v68
    s_nop 1
    v_permlane16_swap_b32 v4, v68
    v_add_f32_e64 v68, v68, v4
    v_mul_f32 v70, 0x3b000000, v68
    v_pk_add_f32 v[52:53], v[52:53], v[70:71] op_sel:[0,0] op_sel_hi:[1,0] neg_lo:[0,1] neg_hi:[0,1]
    v_pk_add_f32 v[54:55], v[54:55], v[70:71] op_sel:[0,0] op_sel_hi:[1,0] neg_lo:[0,1] neg_hi:[0,1]
    v_pk_add_f32 v[56:57], v[56:57], v[70:71] op_sel:[0,0] op_sel_hi:[1,0] neg_lo:[0,1] neg_hi:[0,1]
    v_pk_add_f32 v[58:59], v[58:59], v[70:71] op_sel:[0,0] op_sel_hi:[1,0] neg_lo:[0,1] neg_hi:[0,1]
    v_pk_add_f32 v[60:61], v[60:61], v[70:71] op_sel:[0,0] op_sel_hi:[1,0] neg_lo:[0,1] neg_hi:[0,1]
    v_pk_add_f32 v[62:63], v[62:63], v[70:71] op_sel:[0,0] op_sel_hi:[1,0] neg_lo:[0,1] neg_hi:[0,1]
    v_pk_add_f32 v[64:65], v[64:65], v[70:71] op_sel:[0,0] op_sel_hi:[1,0] neg_lo:[0,1] neg_hi:[0,1]
    v_pk_add_f32 v[66:67], v[66:67], v[70:71] op_sel:[0,0] op_sel_hi:[1,0] neg_lo:[0,1] neg_hi:[0,1]
    v_pk_mul_f32 v[68:69], v[52:53], v[52:53]
    v_pk_fma_f32 v[68:69], v[54:55], v[54:55], v[68:69]
    v_pk_fma_f32 v[68:69], v[56:57], v[56:57], v[68:69]
    v_pk_fma_f32 v[68:69], v[58:59], v[58:59], v[68:69]
    v_pk_fma_f32 v[68:69], v[60:61], v[60:61], v[68:69]
    v_pk_fma_f32 v[68:69], v[62:63], v[62:63], v[68:69]
    v_pk_fma_f32 v[68:69], v[64:65], v[64:65], v[68:69]
    v_pk_fma_f32 v[68:69], v[66:67], v[66:67], v[68:69]
    v_add_f32 v68, v68, v69
    s_nop 1
    v_add_f32_dpp v68, v68, v68 quad_perm:[1,0,3,2] row_mask:0xf bank_mask:0xf
    s_nop 1
    v_add_f32_dpp v68, v68, v68 quad_perm:[2,3,0,1] row_mask:0xf bank_mask:0xf
    s_nop 1
    v_add_f32_dpp v68, v68, v68 row_half_mirror row_mask:0xf bank_mask:0xf
    s_nop 1
    v_add_f32_dpp v68, v68, v68 row_mirror row_mask:0xf bank_mask:0xf
    v_mov_b32 v4, v68
    s_nop 1
    v_permlane16_swap_b32 v4, v68
    v_add_f32_e64 v68, v68, v4
    v_fmamk_f32 v68, v68, 0x3b000000, v36
    v_rsq_f32 v71, v68
    s_nop 0
    v_pk_mul_f32 v[52:53], v[52:53], v[70:71] op_sel:[0,1] op_sel_hi:[1,1]
    v_pk_mul_f32 v[54:55], v[54:55], v[70:71] op_sel:[0,1] op_sel_hi:[1,1]
    v_pk_mul_f32 v[56:57], v[56:57], v[70:71] op_sel:[0,1] op_sel_hi:[1,1]
    v_pk_mul_f32 v[58:59], v[58:59], v[70:71] op_sel:[0,1] op_sel_hi:[1,1]
    v_pk_mul_f32 v[60:61], v[60:61], v[70:71] op_sel:[0,1] op_sel_hi:[1,1]
    v_pk_mul_f32 v[62:63], v[62:63], v[70:71] op_sel:[0,1] op_sel_hi:[1,1]
    v_pk_mul_f32 v[64:65], v[64:65], v[70:71] op_sel:[0,1] op_sel_hi:[1,1]
    v_pk_mul_f32 v[66:67], v[66:67], v[70:71] op_sel:[0,1] op_sel_hi:[1,1]
L_mid2A:
L_ln3:
    v_pk_add_f32 v[68:69], v[52:53], v[54:55]
    v_pk_mul_f32 v[74:75], v[52:53], v[52:53]
    v_pk_fma_f32 v[74:75], v[54:55], v[54:55], v[74:75]
    v_pk_add_f32 v[68:69], v[68:69], v[56:57]
    v_pk_fma_f32 v[74:75], v[56:57], v[56:57], v[74:75]
    v_pk_add_f32 v[68:69], v[68:69], v[58:59]
    v_pk_fma_f32 v[74:75], v[58:59], v[58:59], v[74:75]
    v_pk_add_f32 v[68:69], v[68:69], v[60:61]
    v_pk_fma_f32 v[74:75], v[60:61], v[60:61], v[74:75]
    v_pk_add_f32 v[68:69], v[68:69], v[62:63]
    v_pk_fma_f32 v[74:75], v[62:63], v[62:63], v[74:75]
    v_pk_add_f32 v[68:69], v[68:69], v[64:65]
    v_pk_fma_f32 v[74:75], v[64:65], v[64:65], v[74:75]
    v_pk_add_f32 v[68:69], v[68:69], v[66:67]
    v_pk_fma_f32 v[74:75], v[66:67], v[66:67], v[74:75]
    v_add_f32 v68, v68, v69
    v_add_f32 v74, v74, v75
    s_nop 0
    v_add_f32_dpp v68, v68, v68 quad_perm:[1,0,3,2] row_mask:0xf bank_mask:0xf
    v_add_f32_dpp v74, v74, v74 quad_perm:[1,0,3,2] row_mask:0xf bank_mask:0xf
    s_nop 0
    v_add_f32_dpp v68, v68, v68 quad_perm:[2,3,0,1] row_mask:0xf bank_mask:0xf
    v_add_f32_dpp v74, v74, v74 quad_perm:[2,3,0,1] row_mask:0xf bank_mask:0xf
    s_nop 0
    v_add_f32_dpp v68, v68, v68 row_half_mirror row_mask:0xf bank_mask:0xf
    v_add_f32_dpp v74, v74, v74 row_half_mirror row_mask:0xf bank_mask:0xf
    s_nop 0
    v_add_f32_dpp v68, v68, v68 row_mirror row_mask:0xf bank_mask:0xf
    v_add_f32_dpp v74, v74, v74 row_mirror row_mask:0xf bank_mask:0xf
    v_mov_b32 v69, v68
    v_mov_b32 v75, v74
    s_nop 0
    v_permlane16_swap_b32 v69, v68
    v_permlane16_swap_b32 v75, v74
    v_add_f32 v68, v68, v69
    v_add_f32_e64 v74, v74, v75
    v_mul_f32 v72, 0x3b000000, v68
    v_fmamk_f32 v74, v74, 0x3b000000, v36
    v_fma_f32 v74, -v72, v72, v74
    v_rsq_f32 v73, v74
    s_nop 0
    v_mul_f32_e64 v72, v72, v73
    v_pk_fma_f32 v[52:53], v[52:53], v[72:73], v[72:73] op_sel:[0,1,0] op_sel_hi:[1,1,0] neg_lo:[0,0,1] neg_hi:[0,0,1]
    v_pk_fma_f32 v[54:55], v[54:55], v[72:73], v[72:73] op_sel:[0,1,0] op_sel_hi:[1,1,0] neg_lo:[0,0,1] neg_hi:[0,0,1]
    v_pk_fma_f32 v[56:57], v[56:57], v[72:73], v[72:73] op_sel:[0,1,0] op_sel_hi:[1,1,0] neg_lo:[0,0,1] neg_hi:[0,0,1]
    v_pk_fma_f32 v[58:59], v[58:59], v[72:73], v[72:73] op_sel:[0,1,0] op_sel_hi:[1,1,0] neg_lo:[0,0,1] neg_hi:[0,0,1]
    v_pk_fma_f32 v[60:61], v[60:61], v[72:73], v[72:73] op_sel:[0,1,0] op_sel_hi:[1,1,0] neg_lo:[0,0,1] neg_hi:[0,0,1]
    v_pk_fma_f32 v[62:63], v[62:63], v[72:73], v[72:73] op_sel:[0,1,0] op_sel_hi:[1,1,0] neg_lo:[0,0,1] neg_hi:[0,0,1]
    v_pk_fma_f32 v[64:65], v[64:65], v[72:73], v[72:73] op_sel:[0,1,0] op_sel_hi:[1,1,0] neg_lo:[0,0,1] neg_hi:[0,0,1]
    v_pk_fma_f32 v[66:67], v[66:67], v[72:73], v[72:73] op_sel:[0,1,0] op_sel_hi:[1,1,0] neg_lo:[0,0,1] neg_hi:[0,0,1]
    v_cvt_pk_bf16_f32 v44, v52, v53
    v_cvt_pk_bf16_f32 v45, v54, v55
    v_cvt_pk_bf16_f32 v46, v56, v57
    v_cvt_pk_bf16_f32 v47, v58, v59
    v_cvt_pk_bf16_f32 v48, v60, v61
    v_cvt_pk_bf16_f32 v49, v62, v63
    v_cvt_pk_bf16_f32 v50, v64, v65
    v_cvt_pk_bf16_f32 v51, v66, v67
    ds_write_b128 v26, v[44:47]
    ds_write_b128 v26, v[48:51] offset:512
    s_waitcnt lgkmcnt(0)
    s_barrier
    ds_read_b64_tr_b16 v[52:53], v27 offset:0
    ds_read_b64_tr_b16 v[54:55], v27 offset:4352
    ds_read_b64_tr_b16 v[56:57], v27 offset:128
    ds_read_b64_tr_b16 v[58:59], v27 offset:4480
    buffer_store_dwordx2 v[70:71], v25, s[28:31], 0 offen sc1
    s_waitcnt lgkmcnt(2)
    buffer_store_dwordx4 v[52:55], v28, s[28:31], 0 offen sc1
    s_waitcnt lgkmcnt(0)
    buffer_store_dwordx4 v[56:59], v28, s[28:31], s58 offen sc1
    s_cmp_eq_u32 s5, 1
    s_cbranch_scc1 L_roleA
    s_cmp_eq_u32 s5, 2
    s_cbranch_scc1 L_roleP
    v_bfe_u32 v4, v1, 2, 2
    v_lshlrev_b32_e64 v4, 7, v4
    v_lshl_add_u32 v4, v3, 10, v4
    v_bfe_u32 v5, v1, 4, 1
    v_lshl_add_u32 v4, v5, 5, v4
    v_and_b32_e64 v5, 3, v1
    v_lshl_add_u32 v4, v5, 3, v4
    v_bfe_u32 v5, v1, 3, 1
    v_lshl_add_u32 v4, v5, 6, v4
    s_and_b32 s56, s48, 1
    s_lshl_b32 s56, s56, 6
    v_xor_b32 v4, s56, v4
    v_add_u32 v30, s60, v4
    v_xor_b32_e64 v33, 64, v30
    v_add_u32 v31, 0x10000, v30
    v_add_u32 v32, 0x20000, v30
    v_add_u32 v34, 0x10000, v33
    v_add_u32 v35, 0x20000, v33
    s_lshl_b32 s56, s51, 18
    s_lshl_b32 s57, s48, 16
    s_add_u32 s56, s56, s57
    v_lshl_add_u32 v18, v1, 4, s56
    s_mul_i32 s56, s48, 1835008
    s_lshl_b32 s57, s54, 7
    s_add_u32 s56, s56, s57
    v_lshrrev_b32_e64 v4, 3, v1
    v_mul_u32_u24 v4, 4096, v4
    v_add3_u32 v19, v4, v13, s56
    v_add_u32 v20, 0x7c00, v19
    s_add_u32 m0, s60, 0x18800
    s_nop 0
    buffer_load_dwordx4 v16, s[20:23], s66 offen lds
    buffer_load_dwordx4 v17, s[20:23], s66 offen offset:1024 lds
    v_readlane_b32 s66, v21, 3
    s_add_u32 m0, s60, 0x19000
    s_nop 3
    buffer_load_dwordx4 v14, s[20:23], s66 offen lds
    buffer_load_dwordx4 v15, s[20:23], s66 offen offset:1024 lds
    s_add_u32 m0, s60, 0x19800
    s_nop 0
    buffer_load_dwordx4 v16, s[20:23], s66 offen lds
    buffer_load_dword v10, v11, s[36:39], 0 offen sc1
    buffer_load_dwordx4 v17, s[20:23], s66 offen offset:1024 lds
    v_readlane_b32 s66, v21, 4
    s_add_u32 m0, s60, 0x20000
    s_nop 3
    buffer_load_dwordx4 v14, s[20:23], s66 offen lds
    buffer_load_dwordx4 v15, s[20:23], s66 offen offset:1024 lds
    s_add_u32 m0, s60, 0x20800
    s_nop 0
    buffer_load_dwordx4 v16, s[20:23], s66 offen lds
    buffer_load_dwordx4 v17, s[20:23], s66 offen offset:1024 lds
    v_readlane_b32 s66, v21, 5
    s_add_u32 m0, s60, 0x21000
    s_nop 3
    buffer_load_dwordx4 v14, s[20:23], s66 offen lds
    buffer_load_dwordx4 v15, s[20:23], s66 offen offset:1024 lds
    s_add_u32 m0, s60, 0x21800
    s_nop 0
    buffer_load_dwordx4 v16, s[20:23], s66 offen lds
    buffer_load_dwordx4 v17, s[20:23], s66 offen offset:1024 lds
    v_readlane_b32 s66, v21, 6
    s_waitcnt vmcnt(9)
    v_mov_b32 v10, v10
    s_cmp_lg_u32 s48, 0
    s_cbranch_scc1 L_ok_rdym
    v_cmp_ne_u32_e64 vcc, 1, v10
    s_nop 0
    s_cbranch_vccnz L_slow_rdym
L_ok_rdym:
    v_lshlrev_b32 v11, 4, v0
    v_add_u32 v11, 0x620000, v11
    s_barrier
    s_cmp_lg_u32 s48, 0
    s_cbranch_scc1 L_nf_f1m
    buffer_store_dword v12, v9, s[28:31], 0 offen sc1
L_nf_f1m:
    buffer_load_dwordx2 v[108:109], v29, s[40:43], 0 offen offset:0
    buffer_load_dwordx2 v[110:111], v29, s[40:43], 0 offen offset:16
    buffer_load_dwordx2 v[112:113], v29, s[40:43], 0 offen offset:32
    buffer_load_dwordx2 v[114:115], v29, s[40:43], 0 offen offset:48
    ds_read_b64_tr_b16 a[64:65], v30 offset:0
    ds_read_b64_tr_b16 a[66:67], v30 offset:512
    ds_read_b64_tr_b16 a[68:69], v33 offset:0
    ds_read_b64_tr_b16 a[70:71], v33 offset:512
    ds_read_b64_tr_b16 a[72:73], v30 offset:2048
    ds_read_b64_tr_b16 a[74:75], v30 offset:2560
    ds_read_b64_tr_b16 a[76:77], v33 offset:2048
    ds_read_b64_tr_b16 a[78:79], v33 offset:2560
    ds_read_b64_tr_b16 a[80:81], v30 offset:4096
    ds_read_b64_tr_b16 a[82:83], v30 offset:4608
    ds_read_b64_tr_b16 a[84:85], v33 offset:4096
    ds_read_b64_tr_b16 a[86:87], v33 offset:4608
    ds_read_b64_tr_b16 a[88:89], v30 offset:6144
    ds_read_b64_tr_b16 a[90:91], v30 offset:6656
    ds_read_b64_tr_b16 a[92:93], v33 offset:6144
    ds_read_b64_tr_b16 a[94:95], v33 offset:6656
    ds_read_b64_tr_b16 a[96:97], v31 offset:32768
    ds_read_b64_tr_b16 a[98:99], v31 offset:33280
    ds_read_b64_tr_b16 a[100:101], v34 offset:32768
    ds_read_b64_tr_b16 a[102:103], v34 offset:33280
    ds_read_b64_tr_b16 a[104:105], v31 offset:34816
    ds_read_b64_tr_b16 a[106:107], v31 offset:35328
    ds_read_b64_tr_b16 a[108:109], v34 offset:34816
    ds_read_b64_tr_b16 a[110:111], v34 offset:35328
    s_add_u32 m0, s60, 0x8000
    s_nop 0
    buffer_load_dwordx4 v14, s[20:23], s66 offen lds
    buffer_load_dwordx4 v15, s[20:23], s66 offen offset:1024 lds
    s_add_u32 m0, s60, 0x8800
    s_nop 0
    buffer_load_dwordx4 v16, s[20:23], s66 offen lds
    buffer_load_dwordx4 v17, s[20:23], s66 offen offset:1024 lds
    v_readlane_b32 s66, v21, 7
    s_waitcnt vmcnt(16)
    ds_read_b64_tr_b16 a[112:113], v31 offset:36864
    ds_read_b64_tr_b16 a[114:115], v31 offset:37376
    ds_read_b64_tr_b16 a[116:117], v34 offset:36864
    ds_read_b64_tr_b16 a[118:119], v34 offset:37376
    ds_read_b64_tr_b16 a[120:121], v31 offset:38912
    ds_read_b64_tr_b16 a[122:123], v31 offset:39424
    ds_read_b64_tr_b16 a[124:125], v34 offset:38912
    ds_read_b64_tr_b16 a[126:127], v34 offset:39424
    s_add_u32 m0, s60, 0x9000
    s_nop 0
    buffer_load_dwordx4 v14, s[20:23], s66 offen lds
    buffer_load_dwordx4 v15, s[20:23], s66 offen offset:1024 lds
    s_add_u32 m0, s60, 0x9800
    s_nop 0
    buffer_load_dwordx4 v16, s[20:23], s66 offen lds
    buffer_load_dwordx4 v17, s[20:23], s66 offen offset:1024 lds
    v_readlane_b32 s66, v21, 8
    s_lshl_b32 s56, s54, 6
    v_lshrrev_b32 v4, 2, v0
    v_add_u32 v4, s56, v4
    v_and_b32_e64 v5, 3, v1
    v_lshlrev_b32 v5, 4, v5
    v_lshl_add_u32 v5, v4, 10, v5
    s_lshl_b32 s56, s53, 7
    v_add_u32 v6, s56, v5
    buffer_load_dwordx4 v[248:251], v6, s[8:11], 0 offen
    buffer_load_dwordx4 v[252:255], v6, s[8:11], 0 offen offset:64
    s_waitcnt vmcnt(18)
    ds_read_b64_tr_b16 a[128:129], v32 offset:0
    ds_read_b64_tr_b16 a[130:131], v32 offset:512
    ds_read_b64_tr_b16 a[132:133], v35 offset:0
    ds_read_b64_tr_b16 a[134:135], v35 offset:512
    ds_read_b64_tr_b16 a[136:137], v32 offset:2048
    ds_read_b64_tr_b16 a[138:139], v32 offset:2560
    ds_read_b64_tr_b16 a[140:141], v35 offset:2048
    ds_read_b64_tr_b16 a[142:143], v35 offset:2560
    s_add_u32 m0, s60, 0x10000
    s_nop 0
    buffer_load_dwordx4 v14, s[20:23], s66 offen lds
    buffer_load_dwordx4 v15, s[20:23], s66 offen offset:1024 lds
    s_add_u32 m0, s60, 0x10800
    s_nop 0
    buffer_load_dwordx4 v16, s[20:23], s66 offen lds
    buffer_load_dwordx4 v17, s[20:23], s66 offen offset:1024 lds
    v_readlane_b32 s66, v21, 9
    s_waitcnt vmcnt(18)
    ds_read_b64_tr_b16 a[144:145], v32 offset:4096
    ds_read_b64_tr_b16 a[146:147], v32 offset:4608
    ds_read_b64_tr_b16 a[148:149], v35 offset:4096
    ds_read_b64_tr_b16 a[150:151], v35 offset:4608
    ds_read_b64_tr_b16 a[152:153], v32 offset:6144
    ds_read_b64_tr_b16 a[154:155], v32 offset:6656
    ds_read_b64_tr_b16 a[156:157], v35 offset:6144
    ds_read_b64_tr_b16 a[158:159], v35 offset:6656
    s_add_u32 m0, s60, 0x11000
    s_nop 0
    buffer_load_dwordx4 v14, s[20:23], s66 offen lds
    buffer_load_dwordx4 v15, s[20:23], s66 offen offset:1024 lds
    s_add_u32 m0, s60, 0x11800
    s_nop 0
    buffer_load_dwordx4 v16, s[20:23], s66 offen lds
    buffer_load_dwordx4 v17, s[20:23], s66 offen offset:1024 lds
    v_readlane_b32 s66, v21, 10
    s_waitcnt vmcnt(14)
    ds_read_b64_tr_b16 v[124:125], v30 offset:32768
    ds_read_b64_tr_b16 v[126:127], v30 offset:33280
    ds_read_b64_tr_b16 v[128:129], v33 offset:32768
    ds_read_b64_tr_b16 v[130:131], v33 offset:33280
    ds_read_b64_tr_b16 v[132:133], v30 offset:34816
    ds_read_b64_tr_b16 v[134:135], v30 offset:35328
    ds_read_b64_tr_b16 v[136:137], v33 offset:34816
    ds_read_b64_tr_b16 v[138:139], v33 offset:35328
    s_add_u32 m0, s60, 0x0
    s_waitcnt lgkmcnt(15)
    buffer_load_dwordx4 v14, s[20:23], s66 offen lds
    buffer_load_dwordx4 v15, s[20:23], s66 offen offset:1024 lds
    s_add_u32 m0, s60, 0x800
    s_nop 0
    buffer_load_dwordx4 v16, s[20:23], s66 offen lds
    buffer_load_dwordx4 v17, s[20:23], s66 offen offset:1024 lds
    v_readlane_b32 s66, v21, 11
    s_waitcnt vmcnt(14)
    ds_read_b64_tr_b16 v[140:141], v30 offset:36864
    ds_read_b64_tr_b16 v[142:143], v30 offset:37376
    ds_read_b64_tr_b16 v[144:145], v33 offset:36864
    ds_read_b64_tr_b16 v[146:147], v33 offset:37376
    ds_read_b64_tr_b16 v[148:149], v30 offset:38912
    ds_read_b64_tr_b16 v[150:151], v30 offset:39424
    ds_read_b64_tr_b16 v[152:153], v33 offset:38912
    ds_read_b64_tr_b16 v[154:155], v33 offset:39424
    s_add_u32 m0, s60, 0x1000
    s_nop 0
    buffer_load_dwordx4 v14, s[20:23], s66 offen lds
    buffer_load_dwordx4 v15, s[20:23], s66 offen offset:1024 lds
    s_add_u32 m0, s60, 0x1800
    s_nop 0
    buffer_load_dwordx4 v16, s[20:23], s66 offen lds
    buffer_load_dwordx4 v17, s[20:23], s66 offen offset:1024 lds
    v_readlane_b32 s66, v21, 12
    s_add_u32 m0, s60, 0x18000
    s_nop 3
    buffer_load_dwordx4 v14, s[20:23], s66 offen lds
    buffer_load_dwordx4 v15, s[20:23], s66 offen offset:1024 lds
    s_add_u32 m0, s60, 0x18800
    s_nop 0
    buffer_load_dwordx4 v16, s[20:23], s66 offen lds
    buffer_load_dwordx4 v17, s[20:23], s66 offen offset:1024 lds
    v_readlane_b32 s66, v21, 13
    s_add_u32 m0, s60, 0x19000
    s_nop 3
    buffer_load_dwordx4 v14, s[20:23], s66 offen lds
    buffer_load_dwordx4 v15, s[20:23], s66 offen offset:1024 lds
    s_add_u32 m0, s60, 0x19800
    s_nop 0
    buffer_load_dwordx4 v16, s[20:23], s66 offen lds
    buffer_load_dwordx4 v17, s[20:23], s66 offen offset:1024 lds
    v_readlane_b32 s66, v21, 14
    s_add_u32 m0, s60, 0x20000
    s_nop 3
    buffer_load_dwordx4 v14, s[20:23], s66 offen lds
    buffer_load_dwordx4 v15, s[20:23], s66 offen offset:1024 lds
    s_add_u32 m0, s60, 0x20800
    s_nop 0
    buffer_load_dwordx4 v16, s[20:23], s66 offen lds
    buffer_load_dwordx4 v17, s[20:23], s66 offen offset:1024 lds
    v_readlane_b32 s66, v21, 15
    buffer_load_dword v10, v11, s[28:31], 0 offen sc1
    s_add_u32 m0, s60, 0x21000
    s_waitcnt lgkmcnt(15)
    s_nop 1
    buffer_load_dwordx4 v14, s[20:23], s66 offen lds
    buffer_load_dwordx4 v15, s[20:23], s66 offen offset:1024 lds
    s_add_u32 m0, s60, 0x21800
    s_nop 0
    buffer_load_dwordx4 v16, s[20:23], s66 offen lds
    buffer_load_dwordx4 v17, s[20:23], s66 offen offset:1024 lds
    v_readlane_b32 s66, v21, 16
    s_add_u32 m0, s60, 0x8000
    s_waitcnt lgkmcnt(8)
    s_nop 2
    buffer_load_dwordx4 v14, s[20:23], s66 offen lds
    buffer_load_dwordx4 v15, s[20:23], s66 offen offset:1024 lds
    s_add_u32 m0, s60, 0x8800
    s_nop 0
    buffer_load_dwordx4 v16, s[20:23], s66 offen lds
    buffer_load_dwordx4 v17, s[20:23], s66 offen offset:1024 lds
    v_readlane_b32 s66, v21, 17
    s_add_u32 m0, s60, 0x9000
    s_waitcnt lgkmcnt(0)
    s_nop 2
    buffer_load_dwordx4 v14, s[20:23], s66 offen lds
    buffer_load_dwordx4 v15, s[20:23], s66 offen offset:1024 lds
    s_add_u32 m0, s60, 0x9800
    s_nop 0
    buffer_load_dwordx4 v16, s[20:23], s66 offen lds
    buffer_load_dwordx4 v17, s[20:23], s66 offen offset:1024 lds
    v_readlane_b32 s66, v21, 18
    v_readlane_b32 s67, v22, 8
    s_waitcnt vmcnt(12)
    v_cmp_ne_u32_e64 vcc, 1, v10
    s_nop 0
    s_cbranch_vccnz L_slow_f1m
L_ok_f1m:
    s_nop 0
    buffer_load_dwordx4 a[0:3], v18, s[28:31], s67 offen sc1
    buffer_load_dwordx4 a[4:7], v18, s[28:31], s67 offen offset:1024 sc1
    v_readlane_b32 s67, v22, 9
    s_nop 4
    buffer_load_dwordx4 a[8:11], v18, s[28:31], s67 offen sc1
    buffer_load_dwordx4 a[12:15], v18, s[28:31], s67 offen offset:1024 sc1
    v_readlane_b32 s67, v22, 10
    s_nop 4
    buffer_load_dwordx4 a[16:19], v18, s[28:31], s67 offen sc1
    buffer_load_dwordx4 a[20:23], v18, s[28:31], s67 offen offset:1024 sc1
    v_readlane_b32 s67, v22, 0
    s_nop 4
    buffer_load_dwordx4 a[24:27], v18, s[28:31], s67 offen sc1
    buffer_load_dwordx4 a[28:31], v18, s[28:31], s67 offen offset:1024 sc1
    v_readlane_b32 s67, v22, 11
    v_lshl_add_u32 v23, v1, 4, s60
    v_add_u32 v24, 0x10000, v23
    v_xor_b32 v25, 0x2000, v23
    v_xor_b32 v26, 0xc000, v23
    v_xor_b32 v27, 0x16000, v23
    v_mov_b32 v40, 0xc0135761
    v_mov_b32 v41, 0xbdd2d3e8
    v_mov_b32 v42, 1.0
    v_lshlrev_b32 v44, 16, v108
    v_and_b32 v45, 0xffff0000, v108
    v_lshlrev_b32_e64 v46, 16, v109
    v_and_b32 v47, 0xffff0000, v109
    v_lshlrev_b32_e64 v48, 16, v110
    v_and_b32 v49, 0xffff0000, v110
    v_lshlrev_b32_e64 v50, 16, v111
    v_and_b32 v51, 0xffff0000, v111
    v_lshlrev_b32_e64 v52, 16, v112
    v_and_b32 v53, 0xffff0000, v112
    v_lshlrev_b32_e64 v54, 16, v113
    v_and_b32 v55, 0xffff0000, v113
    v_lshlrev_b32_e64 v56, 16, v114
    v_and_b32 v57, 0xffff0000, v114
    v_lshlrev_b32_e64 v58, 16, v115
    v_and_b32 v59, 0xffff0000, v115
    v_lshlrev_b32_e64 v60, 16, v108
    v_and_b32 v61, 0xffff0000, v108
    v_lshlrev_b32_e64 v62, 16, v109
    v_and_b32 v63, 0xffff0000, v109
    v_lshlrev_b32_e64 v64, 16, v110
    v_and_b32 v65, 0xffff0000, v110
    v_lshlrev_b32_e64 v66, 16, v111
    v_and_b32 v67, 0xffff0000, v111
    v_lshlrev_b32_e64 v68, 16, v112
    v_and_b32 v69, 0xffff0000, v112
    v_lshlrev_b32_e64 v70, 16, v113
    v_and_b32 v71, 0xffff0000, v113
    v_lshlrev_b32_e64 v72, 16, v114
    v_and_b32 v73, 0xffff0000, v114
    v_lshlrev_b32_e64 v74, 16, v115
    v_and_b32 v75, 0xffff0000, v115
    s_mul_i32 s56, s51, 229376
    s_lshl_b32 s57, s52, 14
    s_add_u32 s56, s56, s57
    s_lshl_b32 s57, s48, 12
    s_add_u32 s56, s56, s57
    s_add_u32 s56, s56, 0x200000
    v_lshl_add_u32 v28, v1, 4, s56
    s_lshl_b32 s56, s51, 4
    s_add_u32 s56, s56, s52
    s_lshl_b32 s56, s56, 6
    s_add_u32 s56, s56, 0x628000
    v_mov_b32_e64 v9, s56
    s_barrier
    ds_read_b64_tr_b16 v[76:77], v31 offset:0
    ds_read_b64_tr_b16 v[78:79], v31 offset:512
    ds_read_b64_tr_b16 v[80:81], v34 offset:0
    ds_read_b64_tr_b16 v[82:83], v34 offset:512
    ds_read_b64_tr_b16 v[84:85], v31 offset:2048
    ds_read_b64_tr_b16 v[86:87], v31 offset:2560
    ds_read_b64_tr_b16 v[88:89], v34 offset:2048
    ds_read_b64_tr_b16 v[90:91], v34 offset:2560
    s_waitcnt vmcnt(7) lgkmcnt(6)
    v_mfma_f32_32x32x16_bf16 v[44:59], v[76:79], a[0:3], v[44:59]
    ds_read_b64_tr_b16 v[92:93], v31 offset:4096
    ds_read_b64_tr_b16 v[94:95], v31 offset:4608
    ds_read_b64_tr_b16 v[96:97], v34 offset:4096
    s_waitcnt vmcnt(6)
    v_mfma_f32_32x32x16_bf16 v[60:75], v[76:79], a[4:7], v[60:75]
    buffer_load_dwordx4 a[32:35], v18, s[28:31], s67 offen sc1
    s_waitcnt lgkmcnt(7)
    v_mfma_f32_32x32x16_bf16 a[160:175], v[80:83], a[0:3], 0
    ds_read_b64_tr_b16 v[98:99], v34 offset:4608
    ds_read_b64_tr_b16 v[100:101], v31 offset:6144
    ds_read_b64_tr_b16 v[102:103], v31 offset:6656
    v_mfma_f32_32x32x16_bf16 a[176:191], v[80:83], a[4:7], 0
    buffer_load_dwordx4 a[36:39], v18, s[28:31], s67 offen offset:1024 sc1
    v_readlane_b32 s67, v22, 12
    s_waitcnt lgkmcnt(8)
    v_mfma_f32_32x32x16_bf16 a[192:207], v[84:87], a[0:3], 0
    ds_read_b64_tr_b16 v[104:105], v34 offset:6144
    ds_read_b64_tr_b16 v[106:107], v34 offset:6656
    v_mfma_f32_32x32x16_bf16 a[208:223], v[84:87], a[4:7], 0
    buffer_load_dwordx4 a[40:43], v18, s[28:31], s67 offen sc1
    s_waitcnt lgkmcnt(8)
    v_mfma_f32_32x32x16_bf16 a[224:239], v[88:91], a[0:3], 0
    v_mfma_f32_32x32x16_bf16 a[240:255], v[88:91], a[4:7], 0
    buffer_load_dwordx4 a[44:47], v18, s[28:31], s67 offen offset:1024 sc1
    v_readlane_b32 s67, v22, 13
    s_waitcnt vmcnt(9) lgkmcnt(6)
    v_mfma_f32_32x32x16_bf16 v[44:59], v[92:95], a[8:11], v[44:59]
    ds_read_b64_tr_b16 v[76:77], v30 offset:0
    ds_read_b64_tr_b16 v[78:79], v30 offset:512
    ds_read_b64_tr_b16 v[80:81], v33 offset:0
    s_waitcnt vmcnt(8)
    v_mfma_f32_32x32x16_bf16 v[60:75], v[92:95], a[12:15], v[60:75]
    buffer_load_dwordx4 a[48:51], v18, s[28:31], s67 offen sc1
    s_waitcnt lgkmcnt(7)
    v_mfma_f32_32x32x16_bf16 a[160:175], v[96:99], a[8:11], a[160:175]
    ds_read_b64_tr_b16 v[82:83], v33 offset:512
    ds_read_b64_tr_b16 v[84:85], v30 offset:2048
    ds_read_b64_tr_b16 v[86:87], v30 offset:2560
    v_mfma_f32_32x32x16_bf16 a[176:191], v[96:99], a[12:15], a[176:191]
    buffer_load_dwordx4 a[52:55], v18, s[28:31], s67 offen offset:1024 sc1
    v_readlane_b32 s67, v22, 1
    s_waitcnt lgkmcnt(8)
    v_mfma_f32_32x32x16_bf16 a[192:207], v[100:103], a[8:11], a[192:207]
    ds_read_b64_tr_b16 v[88:89], v33 offset:2048
    ds_read_b64_tr_b16 v[90:91], v33 offset:2560
    v_mfma_f32_32x32x16_bf16 a[208:223], v[100:103], a[12:15], a[208:223]
    buffer_load_dwordx4 a[56:59], v18, s[28:31], s67 offen sc1
    s_waitcnt lgkmcnt(8)
    v_mfma_f32_32x32x16_bf16 a[224:239], v[104:107], a[8:11], a[224:239]
    v_mfma_f32_32x32x16_bf16 a[240:255], v[104:107], a[12:15], a[240:255]
    buffer_load_dwordx4 a[60:63], v18, s[28:31], s67 offen offset:1024 sc1
    v_readlane_b32 s67, v22, 14
    s_waitcnt vmcnt(11) lgkmcnt(6)
    v_mfma_f32_32x32x16_bf16 v[44:59], v[76:79], a[16:19], v[44:59]
    s_waitcnt vmcnt(10)
    v_mfma_f32_32x32x16_bf16 v[60:75], v[76:79], a[20:23], v[60:75]
    s_nop 0
    buffer_load_dwordx4 a[0:3], v18, s[28:31], s67 offen sc1
    s_waitcnt lgkmcnt(4)
    v_mfma_f32_32x32x16_bf16 a[160:175], v[80:83], a[16:19], a[160:175]
    v_mfma_f32_32x32x16_bf16 a[176:191], v[80:83], a[20:23], a[176:191]
    buffer_load_dwordx4 a[4:7], v18, s[28:31], s67 offen offset:1024 sc1
    v_readlane_b32 s67, v22, 15
    s_waitcnt lgkmcnt(2)
    v_mfma_f32_32x32x16_bf16 a[192:207], v[84:87], a[16:19], a[192:207]
    v_mfma_f32_32x32x16_bf16 a[208:223], v[84:87], a[20:23], a[208:223]
    s_nop 1
    buffer_load_dwordx4 a[8:11], v18, s[28:31], s67 offen sc1
    s_waitcnt lgkmcnt(0)
    v_mfma_f32_32x32x16_bf16 a[224:239], v[88:91], a[16:19], a[224:239]
    v_mfma_f32_32x32x16_bf16 a[240:255], v[88:91], a[20:23], a[240:255]
    buffer_load_dwordx4 a[12:15], v18, s[28:31], s67 offen offset:1024 sc1
    v_readlane_b32 s67, v22, 16
    s_barrier
    s_waitcnt vmcnt(13)
    v_mfma_f32_32x32x16_bf16 v[44:59], a[64:67], a[24:27], v[44:59]
    ds_read_b64_tr_b16 v[92:93], v30 offset:4096
    ds_read_b64_tr_b16 v[94:95], v30 offset:4608
    ds_read_b64_tr_b16 v[96:97], v33 offset:4096
    s_waitcnt vmcnt(12)
    v_mfma_f32_32x32x16_bf16 v[60:75], a[64:67], a[28:31], v[60:75]
    buffer_load_dwordx4 a[16:19], v18, s[28:31], s67 offen sc1
    v_mfma_f32_32x32x16_bf16 a[160:175], a[68:71], a[24:27], a[160:175]
    ds_read_b64_tr_b16 v[98:99], v33 offset:4608
    ds_read_b64_tr_b16 v[100:101], v30 offset:6144
    ds_read_b64_tr_b16 v[102:103], v30 offset:6656
    v_mfma_f32_32x32x16_bf16 a[176:191], a[68:71], a[28:31], a[176:191]
    buffer_load_dwordx4 a[20:23], v18, s[28:31], s67 offen offset:1024 sc1
    v_readlane_b32 s67, v22, 2
    v_mfma_f32_32x32x16_bf16 a[192:207], a[72:75], a[24:27], a[192:207]
    ds_read_b64_tr_b16 v[104:105], v33 offset:6144
    ds_read_b64_tr_b16 v[106:107], v33 offset:6656
    v_mfma_f32_32x32x16_bf16 a[208:223], a[72:75], a[28:31], a[208:223]
    s_add_u32 m0, s60, 0x10000
    s_nop 0
    buffer_load_dwordx4 v14, s[20:23], s66 offen lds
    v_mfma_f32_32x32x16_bf16 a[224:239], a[76:79], a[24:27], a[224:239]
    v_mfma_f32_32x32x16_bf16 a[240:255], a[76:79], a[28:31], a[240:255]
    buffer_load_dwordx4 v15, s[20:23], s66 offen offset:1024 lds
    s_waitcnt vmcnt(15) lgkmcnt(6)
    v_mfma_f32_32x32x16_bf16 v[44:59], v[92:95], a[32:35], v[44:59]
    ds_read_b64_tr_b16 v[76:77], v31 offset:32768
    ds_read_b64_tr_b16 v[78:79], v31 offset:33280
    ds_read_b64_tr_b16 v[80:81], v34 offset:32768
    s_waitcnt vmcnt(14)
    v_mfma_f32_32x32x16_bf16 v[60:75], v[92:95], a[36:39], v[60:75]
    s_add_u32 m0, s60, 0x10800
    s_nop 0
    buffer_load_dwordx4 v16, s[20:23], s66 offen lds
    s_waitcnt lgkmcnt(7)
    v_mfma_f32_32x32x16_bf16 a[160:175], v[96:99], a[32:35], a[160:175]
    ds_read_b64_tr_b16 v[82:83], v34 offset:33280
    ds_read_b64_tr_b16 v[84:85], v31 offset:34816
    ds_read_b64_tr_b16 v[86:87], v31 offset:35328
    v_mfma_f32_32x32x16_bf16 a[176:191], v[96:99], a[36:39], a[176:191]
    buffer_load_dwordx4 v17, s[20:23], s66 offen offset:1024 lds
    v_readlane_b32 s66, v21, 19
    s_waitcnt lgkmcnt(8)
    v_mfma_f32_32x32x16_bf16 a[192:207], v[100:103], a[32:35], a[192:207]
    ds_read_b64_tr_b16 v[88:89], v34 offset:34816
    ds_read_b64_tr_b16 v[90:91], v34 offset:35328
    v_mfma_f32_32x32x16_bf16 a[208:223], v[100:103], a[36:39], a[208:223]
    buffer_load_dwordx4 a[24:27], v18, s[28:31], s67 offen sc1
    s_waitcnt lgkmcnt(8)
    v_mfma_f32_32x32x16_bf16 a[224:239], v[104:107], a[32:35], a[224:239]
    v_mfma_f32_32x32x16_bf16 a[240:255], v[104:107], a[36:39], a[240:255]
    buffer_load_dwordx4 a[28:31], v18, s[28:31], s67 offen offset:1024 sc1
    v_readlane_b32 s67, v22, 17
    s_waitcnt vmcnt(17) lgkmcnt(6)
    v_mfma_f32_32x32x16_bf16 v[44:59], v[76:79], a[40:43], v[44:59]
    ds_read_b64_tr_b16 v[92:93], v31 offset:36864
    ds_read_b64_tr_b16 v[94:95], v31 offset:37376
    ds_read_b64_tr_b16 v[96:97], v34 offset:36864
    s_waitcnt vmcnt(16)
    v_mfma_f32_32x32x16_bf16 v[60:75], v[76:79], a[44:47], v[60:75]
    buffer_load_dwordx4 a[32:35], v18, s[28:31], s67 offen sc1
    s_waitcnt lgkmcnt(7)
    v_mfma_f32_32x32x16_bf16 a[160:175], v[80:83], a[40:43], a[160:175]
    ds_read_b64_tr_b16 v[98:99], v34 offset:37376
    ds_read_b64_tr_b16 v[100:101], v31 offset:38912
    ds_read_b64_tr_b16 v[102:103], v31 offset:39424
    v_mfma_f32_32x32x16_bf16 a[176:191], v[80:83], a[44:47], a[176:191]
    buffer_load_dwordx4 a[36:39], v18, s[28:31], s67 offen offset:1024 sc1
    v_readlane_b32 s67, v22, 18
    s_waitcnt lgkmcnt(8)
    v_mfma_f32_32x32x16_bf16 a[192:207], v[84:87], a[40:43], a[192:207]
    ds_read_b64_tr_b16 v[104:105], v34 offset:38912
    ds_read_b64_tr_b16 v[106:107], v34 offset:39424
    v_mfma_f32_32x32x16_bf16 a[208:223], v[84:87], a[44:47], a[208:223]
    s_add_u32 m0, s60, 0x11000
    s_nop 0
    buffer_load_dwordx4 v14, s[20:23], s66 offen lds
    s_waitcnt lgkmcnt(8)
    v_mfma_f32_32x32x16_bf16 a[224:239], v[88:91], a[40:43], a[224:239]
    v_mfma_f32_32x32x16_bf16 a[240:255], v[88:91], a[44:47], a[240:255]
    buffer_load_dwordx4 v15, s[20:23], s66 offen offset:1024 lds
    s_waitcnt vmcnt(19) lgkmcnt(6)
    v_mfma_f32_32x32x16_bf16 v[44:59], v[92:95], a[48:51], v[44:59]
    s_waitcnt vmcnt(18)
    v_mfma_f32_32x32x16_bf16 v[60:75], v[92:95], a[52:55], v[60:75]
    s_add_u32 m0, s60, 0x11800
    s_nop 0
    buffer_load_dwordx4 v16, s[20:23], s66 offen lds
    s_waitcnt lgkmcnt(4)
    v_mfma_f32_32x32x16_bf16 a[160:175], v[96:99], a[48:51], a[160:175]
    v_mfma_f32_32x32x16_bf16 a[176:191], v[96:99], a[52:55], a[176:191]
    buffer_load_dwordx4 v17, s[20:23], s66 offen offset:1024 lds
    v_readlane_b32 s66, v21, 20
    s_waitcnt lgkmcnt(2)
    v_mfma_f32_32x32x16_bf16 a[192:207], v[100:103], a[48:51], a[192:207]
    v_mfma_f32_32x32x16_bf16 a[208:223], v[100:103], a[52:55], a[208:223]
    buffer_load_dwordx4 a[40:43], v18, s[28:31], s67 offen sc1
    s_waitcnt lgkmcnt(0)
    v_mfma_f32_32x32x16_bf16 a[224:239], v[104:107], a[48:51], a[224:239]
    v_mfma_f32_32x32x16_bf16 a[240:255], v[104:107], a[52:55], a[240:255]
    buffer_load_dwordx4 a[44:47], v18, s[28:31], s67 offen offset:1024 sc1
    v_readlane_b32 s67, v22, 3
    s_barrier
    s_waitcnt vmcnt(21)
    v_mfma_f32_32x32x16_bf16 v[44:59], a[80:83], a[56:59], v[44:59]
    ds_read_b64_tr_b16 v[76:77], v32 offset:0
    ds_read_b64_tr_b16 v[78:79], v32 offset:512
    ds_read_b64_tr_b16 v[80:81], v35 offset:0
    s_waitcnt vmcnt(20)
    v_mfma_f32_32x32x16_bf16 v[60:75], a[80:83], a[60:63], v[60:75]
    buffer_load_dwordx4 a[48:51], v18, s[28:31], s67 offen sc1
    v_mfma_f32_32x32x16_bf16 a[160:175], a[84:87], a[56:59], a[160:175]
    ds_read_b64_tr_b16 v[82:83], v35 offset:512
    ds_read_b64_tr_b16 v[84:85], v32 offset:2048
    ds_read_b64_tr_b16 v[86:87], v32 offset:2560
    v_mfma_f32_32x32x16_bf16 a[176:191], a[84:87], a[60:63], a[176:191]
    buffer_load_dwordx4 a[52:55], v18, s[28:31], s67 offen offset:1024 sc1
    v_readlane_b32 s67, v22, 19
    v_mfma_f32_32x32x16_bf16 a[192:207], a[88:91], a[56:59], a[192:207]
    ds_read_b64_tr_b16 v[88:89], v35 offset:2048
    ds_read_b64_tr_b16 v[90:91], v35 offset:2560
    v_mfma_f32_32x32x16_bf16 a[208:223], a[88:91], a[60:63], a[208:223]
    s_add_u32 m0, s60, 0x0
    s_nop 0
    buffer_load_dwordx4 v14, s[20:23], s66 offen lds
    v_mfma_f32_32x32x16_bf16 a[224:239], a[92:95], a[56:59], a[224:239]
    v_mfma_f32_32x32x16_bf16 a[240:255], a[92:95], a[60:63], a[240:255]
    buffer_load_dwordx4 v15, s[20:23], s66 offen offset:1024 lds
    s_waitcnt vmcnt(23) lgkmcnt(6)
    v_mfma_f32_32x32x16_bf16 v[44:59], v[76:79], a[0:3], v[44:59]
    ds_read_b64_tr_b16 v[92:93], v32 offset:4096
    ds_read_b64_tr_b16 v[94:95], v32 offset:4608
    ds_read_b64_tr_b16 v[96:97], v35 offset:4096
    s_waitcnt vmcnt(22)
    v_mfma_f32_32x32x16_bf16 v[60:75], v[76:79], a[4:7], v[60:75]
    s_add_u32 m0, s60, 0x800
    s_nop 0
    buffer_load_dwordx4 v16, s[20:23], s66 offen lds
    s_waitcnt lgkmcnt(7)
    v_mfma_f32_32x32x16_bf16 a[160:175], v[80:83], a[0:3], a[160:175]
    ds_read_b64_tr_b16 v[98:99], v35 offset:4608
    ds_read_b64_tr_b16 v[100:101], v32 offset:6144
    ds_read_b64_tr_b16 v[102:103], v32 offset:6656
    v_mfma_f32_32x32x16_bf16 a[176:191], v[80:83], a[4:7], a[176:191]
    buffer_load_dwordx4 v17, s[20:23], s66 offen offset:1024 lds
    v_readlane_b32 s66, v21, 21
    s_waitcnt lgkmcnt(8)
    v_mfma_f32_32x32x16_bf16 a[192:207], v[84:87], a[0:3], a[192:207]
    ds_read_b64_tr_b16 v[104:105], v35 offset:6144
    ds_read_b64_tr_b16 v[106:107], v35 offset:6656
    v_mfma_f32_32x32x16_bf16 a[208:223], v[84:87], a[4:7], a[208:223]
    buffer_load_dwordx4 a[56:59], v18, s[28:31], s67 offen sc1
    s_waitcnt lgkmcnt(8)
    v_mfma_f32_32x32x16_bf16 a[224:239], v[88:91], a[0:3], a[224:239]
    v_mfma_f32_32x32x16_bf16 a[240:255], v[88:91], a[4:7], a[240:255]
    buffer_load_dwordx4 a[60:63], v18, s[28:31], s67 offen offset:1024 sc1
    v_readlane_b32 s67, v22, 20
    s_waitcnt vmcnt(25) lgkmcnt(6)
    v_mfma_f32_32x32x16_bf16 v[44:59], v[92:95], a[8:11], v[44:59]
    ds_read_b64_tr_b16 v[76:77], v30 offset:32768
    ds_read_b64_tr_b16 v[78:79], v30 offset:33280
    ds_read_b64_tr_b16 v[80:81], v33 offset:32768
    s_waitcnt vmcnt(24)
    v_mfma_f32_32x32x16_bf16 v[60:75], v[92:95], a[12:15], v[60:75]
    buffer_load_dwordx4 a[0:3], v18, s[28:31], s67 offen sc1
    s_waitcnt lgkmcnt(7)
    v_mfma_f32_32x32x16_bf16 a[160:175], v[96:99], a[8:11], a[160:175]
    ds_read_b64_tr_b16 v[82:83], v33 offset:33280
    ds_read_b64_tr_b16 v[84:85], v30 offset:34816
    ds_read_b64_tr_b16 v[86:87], v30 offset:35328
    v_mfma_f32_32x32x16_bf16 a[176:191], v[96:99], a[12:15], a[176:191]
    buffer_load_dwordx4 a[4:7], v18, s[28:31], s67 offen offset:1024 sc1
    v_readlane_b32 s67, v22, 21
    s_waitcnt lgkmcnt(8)
    v_mfma_f32_32x32x16_bf16 a[192:207], v[100:103], a[8:11], a[192:207]
    ds_read_b64_tr_b16 v[88:89], v33 offset:34816
    ds_read_b64_tr_b16 v[90:91], v33 offset:35328
    v_mfma_f32_32x32x16_bf16 a[208:223], v[100:103], a[12:15], a[208:223]
    s_add_u32 m0, s60, 0x1000
    s_nop 0
    buffer_load_dwordx4 v14, s[20:23], s66 offen lds
    s_waitcnt lgkmcnt(8)
    v_mfma_f32_32x32x16_bf16 a[224:239], v[104:107], a[8:11], a[224:239]
    v_mfma_f32_32x32x16_bf16 a[240:255], v[104:107], a[12:15], a[240:255]
    buffer_load_dwordx4 v15, s[20:23], s66 offen offset:1024 lds
    s_waitcnt vmcnt(27) lgkmcnt(6)
    v_mfma_f32_32x32x16_bf16 v[44:59], v[76:79], a[16:19], v[44:59]
    s_waitcnt vmcnt(26)
    v_mfma_f32_32x32x16_bf16 v[60:75], v[76:79], a[20:23], v[60:75]
    s_add_u32 m0, s60, 0x1800
    s_nop 0
    buffer_load_dwordx4 v16, s[20:23], s66 offen lds
    s_waitcnt lgkmcnt(4)
    v_mfma_f32_32x32x16_bf16 a[160:175], v[80:83], a[16:19], a[160:175]
    v_mfma_f32_32x32x16_bf16 a[176:191], v[80:83], a[20:23], a[176:191]
    buffer_load_dwordx4 v17, s[20:23], s66 offen offset:1024 lds
    v_readlane_b32 s66, v21, 22
    s_waitcnt lgkmcnt(2)
    v_mfma_f32_32x32x16_bf16 a[192:207], v[84:87], a[16:19], a[192:207]
    v_mfma_f32_32x32x16_bf16 a[208:223], v[84:87], a[20:23], a[208:223]
    buffer_load_dwordx4 a[8:11], v18, s[28:31], s67 offen sc1
    s_waitcnt lgkmcnt(0)
    v_mfma_f32_32x32x16_bf16 a[224:239], v[88:91], a[16:19], a[224:239]
    v_mfma_f32_32x32x16_bf16 a[240:255], v[88:91], a[20:23], a[240:255]
    buffer_load_dwordx4 a[12:15], v18, s[28:31], s67 offen offset:1024 sc1
    v_readlane_b32 s67, v22, 4
    s_barrier
    s_waitcnt vmcnt(25)
    v_mfma_f32_32x32x16_bf16 v[44:59], a[96:99], a[24:27], v[44:59]
    ds_read_b64_tr_b16 v[92:93], v30 offset:36864
    ds_read_b64_tr_b16 v[94:95], v30 offset:37376
    ds_read_b64_tr_b16 v[96:97], v33 offset:36864
    s_waitcnt vmcnt(24)
    v_mfma_f32_32x32x16_bf16 v[60:75], a[96:99], a[28:31], v[60:75]
    buffer_load_dwordx4 a[16:19], v18, s[28:31], s67 offen sc1
    v_mfma_f32_32x32x16_bf16 a[160:175], a[100:103], a[24:27], a[160:175]
    ds_read_b64_tr_b16 v[98:99], v33 offset:37376
    ds_read_b64_tr_b16 v[100:101], v30 offset:38912
    ds_read_b64_tr_b16 v[102:103], v30 offset:39424
    v_mfma_f32_32x32x16_bf16 a[176:191], a[100:103], a[28:31], a[176:191]
    buffer_load_dwordx4 a[20:23], v18, s[28:31], s67 offen offset:1024 sc1
    v_readlane_b32 s67, v22, 22
    v_mfma_f32_32x32x16_bf16 a[192:207], a[104:107], a[24:27], a[192:207]
    ds_read_b64_tr_b16 v[104:105], v33 offset:38912
    ds_read_b64_tr_b16 v[106:107], v33 offset:39424
    v_mfma_f32_32x32x16_bf16 a[208:223], a[104:107], a[28:31], a[208:223]
    s_add_u32 m0, s60, 0x18000
    s_nop 0
    buffer_load_dwordx4 v14, s[20:23], s66 offen lds
    v_mfma_f32_32x32x16_bf16 a[224:239], a[108:111], a[24:27], a[224:239]
    v_mfma_f32_32x32x16_bf16 a[240:255], a[108:111], a[28:31], a[240:255]
    buffer_load_dwordx4 v15, s[20:23], s66 offen offset:1024 lds
    s_waitcnt vmcnt(27) lgkmcnt(6)
    v_mfma_f32_32x32x16_bf16 v[44:59], v[92:95], a[32:35], v[44:59]
    ds_read_b64_tr_b16 v[76:77], v31 offset:0
    ds_read_b64_tr_b16 v[78:79], v31 offset:512
    ds_read_b64_tr_b16 v[80:81], v34 offset:0
    s_waitcnt vmcnt(26)
    v_mfma_f32_32x32x16_bf16 v[60:75], v[92:95], a[36:39], v[60:75]
    s_add_u32 m0, s60, 0x18800
    s_nop 0
    buffer_load_dwordx4 v16, s[20:23], s66 offen lds
    s_waitcnt lgkmcnt(7)
    v_mfma_f32_32x32x16_bf16 a[160:175], v[96:99], a[32:35], a[160:175]
    ds_read_b64_tr_b16 v[82:83], v34 offset:512
    ds_read_b64_tr_b16 v[84:85], v31 offset:2048
    ds_read_b64_tr_b16 v[86:87], v31 offset:2560
    v_mfma_f32_32x32x16_bf16 a[176:191], v[96:99], a[36:39], a[176:191]
    buffer_load_dwordx4 v17, s[20:23], s66 offen offset:1024 lds
    v_readlane_b32 s66, v21, 23
    s_waitcnt lgkmcnt(8)
    v_mfma_f32_32x32x16_bf16 a[192:207], v[100:103], a[32:35], a[192:207]
    ds_read_b64_tr_b16 v[88:89], v34 offset:2048
    ds_read_b64_tr_b16 v[90:91], v34 offset:2560
    v_mfma_f32_32x32x16_bf16 a[208:223], v[100:103], a[36:39], a[208:223]
    buffer_load_dwordx4 a[24:27], v18, s[28:31], s67 offen sc1
    s_waitcnt lgkmcnt(8)
    v_mfma_f32_32x32x16_bf16 a[224:239], v[104:107], a[32:35], a[224:239]
    v_mfma_f32_32x32x16_bf16 a[240:255], v[104:107], a[36:39], a[240:255]
    buffer_load_dwordx4 a[28:31], v18, s[28:31], s67 offen offset:1024 sc1
    v_readlane_b32 s67, v22, 23
    s_waitcnt vmcnt(25) lgkmcnt(6)
    v_mfma_f32_32x32x16_bf16 v[44:59], v[76:79], a[40:43], v[44:59]
    s_waitcnt vmcnt(24)
    v_mfma_f32_32x32x16_bf16 v[60:75], v[76:79], a[44:47], v[60:75]
    s_add_u32 m0, s60, 0x19000
    s_nop 0
    buffer_load_dwordx4 v14, s[20:23], s66 offen lds
    s_waitcnt lgkmcnt(4)
    v_mfma_f32_32x32x16_bf16 a[160:175], v[80:83], a[40:43], a[160:175]
    v_mfma_f32_32x32x16_bf16 a[176:191], v[80:83], a[44:47], a[176:191]
    buffer_load_dwordx4 v15, s[20:23], s66 offen offset:1024 lds
    s_waitcnt lgkmcnt(2)
    v_mfma_f32_32x32x16_bf16 a[192:207], v[84:87], a[40:43], a[192:207]
    v_mfma_f32_32x32x16_bf16 a[208:223], v[84:87], a[44:47], a[208:223]
    s_add_u32 m0, s60, 0x19800
    s_nop 0
    buffer_load_dwordx4 v16, s[20:23], s66 offen lds
    s_waitcnt lgkmcnt(0)
    v_mfma_f32_32x32x16_bf16 a[224:239], v[88:91], a[40:43], a[224:239]
    v_mfma_f32_32x32x16_bf16 a[240:255], v[88:91], a[44:47], a[240:255]
    buffer_load_dwordx4 v17, s[20:23], s66 offen offset:1024 lds
    v_readlane_b32 s66, v21, 24
    s_waitcnt vmcnt(27)
    v_mfma_f32_32x32x16_bf16 v[44:59], a[112:115], a[48:51], v[44:59]
    ds_read_b64_tr_b16 v[92:93], v31 offset:4096
    ds_read_b64_tr_b16 v[94:95], v31 offset:4608
    ds_read_b64_tr_b16 v[96:97], v34 offset:4096
    s_waitcnt vmcnt(26)
    v_mfma_f32_32x32x16_bf16 v[60:75], a[112:115], a[52:55], v[60:75]
    buffer_load_dwordx4 a[32:35], v18, s[28:31], s67 offen sc1
    v_mfma_f32_32x32x16_bf16 a[160:175], a[116:119], a[48:51], a[160:175]
    ds_read_b64_tr_b16 v[98:99], v34 offset:4608
    ds_read_b64_tr_b16 v[100:101], v31 offset:6144
    ds_read_b64_tr_b16 v[102:103], v31 offset:6656
    v_mfma_f32_32x32x16_bf16 a[176:191], a[116:119], a[52:55], a[176:191]
    buffer_load_dwordx4 a[36:39], v18, s[28:31], s67 offen offset:1024 sc1
    v_readlane_b32 s67, v22, 24
    v_mfma_f32_32x32x16_bf16 a[192:207], a[120:123], a[48:51], a[192:207]
    ds_read_b64_tr_b16 v[104:105], v34 offset:6144
    ds_read_b64_tr_b16 v[106:107], v34 offset:6656
    v_mfma_f32_32x32x16_bf16 a[208:223], a[120:123], a[52:55], a[208:223]
    s_add_u32 m0, s60, 0x20000
    s_nop 0
    buffer_load_dwordx4 v14, s[20:23], s66 offen lds
    v_mfma_f32_32x32x16_bf16 a[224:239], a[124:127], a[48:51], a[224:239]
    v_mfma_f32_32x32x16_bf16 a[240:255], a[124:127], a[52:55], a[240:255]
    buffer_load_dwordx4 v15, s[20:23], s66 offen offset:1024 lds
    s_barrier
    s_waitcnt vmcnt(25) lgkmcnt(6)
    v_mfma_f32_32x32x16_bf16 v[44:59], v[92:95], a[56:59], v[44:59]
    ds_read_b64_tr_b16 v[76:77], v30 offset:0
    ds_read_b64_tr_b16 v[78:79], v30 offset:512
    ds_read_b64_tr_b16 v[80:81], v33 offset:0
    s_waitcnt vmcnt(24)
    v_mfma_f32_32x32x16_bf16 v[60:75], v[92:95], a[60:63], v[60:75]
    s_add_u32 m0, s60, 0x20800
    s_nop 0
    buffer_load_dwordx4 v16, s[20:23], s66 offen lds
    s_waitcnt lgkmcnt(7)
    v_mfma_f32_32x32x16_bf16 a[160:175], v[96:99], a[56:59], a[160:175]
    ds_read_b64_tr_b16 v[82:83], v33 offset:512
    ds_read_b64_tr_b16 v[84:85], v30 offset:2048
    ds_read_b64_tr_b16 v[86:87], v30 offset:2560
    v_mfma_f32_32x32x16_bf16 a[176:191], v[96:99], a[60:63], a[176:191]
    buffer_load_dwordx4 v17, s[20:23], s66 offen offset:1024 lds
    v_readlane_b32 s66, v21, 25
    s_waitcnt lgkmcnt(8)
    v_mfma_f32_32x32x16_bf16 a[192:207], v[100:103], a[56:59], a[192:207]
    ds_read_b64_tr_b16 v[88:89], v33 offset:2048
    ds_read_b64_tr_b16 v[90:91], v33 offset:2560
    v_mfma_f32_32x32x16_bf16 a[208:223], v[100:103], a[60:63], a[208:223]
    buffer_load_dwordx4 a[40:43], v18, s[28:31], s67 offen sc1
    s_waitcnt lgkmcnt(8)
    v_mfma_f32_32x32x16_bf16 a[224:239], v[104:107], a[56:59], a[224:239]
    v_mfma_f32_32x32x16_bf16 a[240:255], v[104:107], a[60:63], a[240:255]
    buffer_load_dwordx4 a[44:47], v18, s[28:31], s67 offen offset:1024 sc1
    v_readlane_b32 s67, v22, 5
    s_waitcnt vmcnt(27) lgkmcnt(6)
    v_mfma_f32_32x32x16_bf16 v[44:59], v[76:79], a[0:3], v[44:59]
    s_waitcnt vmcnt(22)
    ds_read_b64_tr_b16 v[92:93], v30 offset:4096
    ds_read_b64_tr_b16 v[94:95], v30 offset:4608
    ds_read_b64_tr_b16 v[96:97], v33 offset:4096
    v_mfma_f32_32x32x16_bf16 v[60:75], v[76:79], a[4:7], v[60:75]
    buffer_load_dwordx4 a[48:51], v18, s[28:31], s67 offen sc1
    s_waitcnt lgkmcnt(7)
    v_mfma_f32_32x32x16_bf16 a[160:175], v[80:83], a[0:3], a[160:175]
    ds_read_b64_tr_b16 v[98:99], v33 offset:4608
    ds_read_b64_tr_b16 v[100:101], v30 offset:6144
    ds_read_b64_tr_b16 v[102:103], v30 offset:6656
    v_mfma_f32_32x32x16_bf16 a[176:191], v[80:83], a[4:7], a[176:191]
    buffer_load_dwordx4 a[52:55], v18, s[28:31], s67 offen offset:1024 sc1
    v_readlane_b32 s67, v22, 25
    s_waitcnt lgkmcnt(8)
    v_mfma_f32_32x32x16_bf16 a[192:207], v[84:87], a[0:3], a[192:207]
    ds_read_b64_tr_b16 v[104:105], v33 offset:6144
    ds_read_b64_tr_b16 v[106:107], v33 offset:6656
    v_mfma_f32_32x32x16_bf16 a[208:223], v[84:87], a[4:7], a[208:223]
    s_add_u32 m0, s60, 0x21000
    s_nop 0
    buffer_load_dwordx4 v14, s[20:23], s66 offen lds
    s_waitcnt lgkmcnt(8)
    v_mfma_f32_32x32x16_bf16 a[224:239], v[88:91], a[0:3], a[224:239]
    v_mfma_f32_32x32x16_bf16 a[240:255], v[88:91], a[4:7], a[240:255]
    buffer_load_dwordx4 v15, s[20:23], s66 offen offset:1024 lds
    s_waitcnt vmcnt(25) lgkmcnt(6)
    v_mfma_f32_32x32x16_bf16 v[44:59], v[92:95], a[8:11], v[44:59]
    s_waitcnt vmcnt(24)
    v_mfma_f32_32x32x16_bf16 v[60:75], v[92:95], a[12:15], v[60:75]
    s_add_u32 m0, s60, 0x21800
    s_nop 0
    buffer_load_dwordx4 v16, s[20:23], s66 offen lds
    s_waitcnt lgkmcnt(4)
    v_mfma_f32_32x32x16_bf16 a[160:175], v[96:99], a[8:11], a[160:175]
    v_mfma_f32_32x32x16_bf16 a[176:191], v[96:99], a[12:15], a[176:191]
    buffer_load_dwordx4 v17, s[20:23], s66 offen offset:1024 lds
    v_readlane_b32 s66, v21, 26
    s_waitcnt lgkmcnt(2)
    v_mfma_f32_32x32x16_bf16 a[192:207], v[100:103], a[8:11], a[192:207]
    v_mfma_f32_32x32x16_bf16 a[208:223], v[100:103], a[12:15], a[208:223]
    buffer_load_dwordx4 a[56:59], v18, s[28:31], s67 offen sc1
    s_waitcnt lgkmcnt(0)
    v_mfma_f32_32x32x16_bf16 a[224:239], v[104:107], a[8:11], a[224:239]
    v_mfma_f32_32x32x16_bf16 a[240:255], v[104:107], a[12:15], a[240:255]
    buffer_load_dwordx4 a[60:63], v18, s[28:31], s67 offen offset:1024 sc1
    v_readlane_b32 s67, v22, 26
    s_waitcnt vmcnt(27)
    v_mfma_f32_32x32x16_bf16 v[44:59], a[128:131], a[16:19], v[44:59]
    s_waitcnt vmcnt(22)
    ds_read_b64_tr_b16 v[76:77], v31 offset:32768
    ds_read_b64_tr_b16 v[78:79], v31 offset:33280
    ds_read_b64_tr_b16 v[80:81], v34 offset:32768
    v_mfma_f32_32x32x16_bf16 v[60:75], a[128:131], a[20:23], v[60:75]
    s_add_u32 m0, s60, 0x8000
    s_nop 0
    buffer_load_dwordx4 v14, s[20:23], s66 offen lds
    v_mfma_f32_32x32x16_bf16 a[160:175], a[132:135], a[16:19], a[160:175]
    ds_read_b64_tr_b16 v[82:83], v34 offset:33280
    ds_read_b64_tr_b16 v[84:85], v31 offset:34816
    ds_read_b64_tr_b16 v[86:87], v31 offset:35328
    v_mfma_f32_32x32x16_bf16 a[176:191], a[132:135], a[20:23], a[176:191]
    buffer_load_dwordx4 v15, s[20:23], s66 offen offset:1024 lds
    v_mfma_f32_32x32x16_bf16 a[192:207], a[136:139], a[16:19], a[192:207]
    ds_read_b64_tr_b16 v[88:89], v34 offset:34816
    ds_read_b64_tr_b16 v[90:91], v34 offset:35328
    v_mfma_f32_32x32x16_bf16 a[208:223], a[136:139], a[20:23], a[208:223]
    s_add_u32 m0, s60, 0x8800
    s_nop 0
    buffer_load_dwordx4 v16, s[20:23], s66 offen lds
    v_mfma_f32_32x32x16_bf16 a[224:239], a[140:143], a[16:19], a[224:239]
    v_mfma_f32_32x32x16_bf16 a[240:255], a[140:143], a[20:23], a[240:255]
    buffer_load_dwordx4 v17, s[20:23], s66 offen offset:1024 lds
    v_readlane_b32 s66, v21, 27
    s_barrier
    s_waitcnt vmcnt(25) lgkmcnt(6)
    v_mfma_f32_32x32x16_bf16 v[44:59], v[76:79], a[24:27], v[44:59]
    s_waitcnt vmcnt(20)
    ds_read_b64_tr_b16 v[92:93], v31 offset:36864
    ds_read_b64_tr_b16 v[94:95], v31 offset:37376
    ds_read_b64_tr_b16 v[96:97], v34 offset:36864
    v_mfma_f32_32x32x16_bf16 v[60:75], v[76:79], a[28:31], v[60:75]
    buffer_load_dwordx4 a[0:3], v18, s[28:31], s67 offen sc1
    s_waitcnt lgkmcnt(7)
    v_mfma_f32_32x32x16_bf16 a[160:175], v[80:83], a[24:27], a[160:175]
    ds_read_b64_tr_b16 v[98:99], v34 offset:37376
    ds_read_b64_tr_b16 v[100:101], v31 offset:38912
    ds_read_b64_tr_b16 v[102:103], v31 offset:39424
    v_mfma_f32_32x32x16_bf16 a[176:191], v[80:83], a[28:31], a[176:191]
    buffer_load_dwordx4 a[4:7], v18, s[28:31], s67 offen offset:1024 sc1
    v_readlane_b32 s67, v22, 27
    s_waitcnt lgkmcnt(8)
    v_mfma_f32_32x32x16_bf16 a[192:207], v[84:87], a[24:27], a[192:207]
    ds_read_b64_tr_b16 v[104:105], v34 offset:38912
    ds_read_b64_tr_b16 v[106:107], v34 offset:39424
    v_mfma_f32_32x32x16_bf16 a[208:223], v[84:87], a[28:31], a[208:223]
    s_add_u32 m0, s60, 0x9000
    s_nop 0
    buffer_load_dwordx4 v14, s[20:23], s66 offen lds
    s_waitcnt lgkmcnt(8)
    v_mfma_f32_32x32x16_bf16 a[224:239], v[88:91], a[24:27], a[224:239]
    v_mfma_f32_32x32x16_bf16 a[240:255], v[88:91], a[28:31], a[240:255]
    buffer_load_dwordx4 v15, s[20:23], s66 offen offset:1024 lds
    s_waitcnt vmcnt(23) lgkmcnt(6)
    v_mfma_f32_32x32x16_bf16 v[44:59], v[92:95], a[32:35], v[44:59]
    s_waitcnt vmcnt(18)
    ds_read_b64_tr_b16 v[76:77], v32 offset:0
    ds_read_b64_tr_b16 v[78:79], v32 offset:512
    ds_read_b64_tr_b16 v[80:81], v35 offset:0
    v_mfma_f32_32x32x16_bf16 v[60:75], v[92:95], a[36:39], v[60:75]
    s_add_u32 m0, s60, 0x9800
    s_nop 0
    buffer_load_dwordx4 v16, s[20:23], s66 offen lds
    s_waitcnt lgkmcnt(7)
    v_mfma_f32_32x32x16_bf16 a[160:175], v[96:99], a[32:35], a[160:175]
    ds_read_b64_tr_b16 v[82:83], v35 offset:512
    ds_read_b64_tr_b16 v[84:85], v32 offset:2048
    ds_read_b64_tr_b16 v[86:87], v32 offset:2560
    v_mfma_f32_32x32x16_bf16 a[176:191], v[96:99], a[36:39], a[176:191]
    buffer_load_dwordx4 v17, s[20:23], s66 offen offset:1024 lds
    v_readlane_b32 s66, v21, 28
    s_waitcnt lgkmcnt(8)
    v_mfma_f32_32x32x16_bf16 a[192:207], v[100:103], a[32:35], a[192:207]
    ds_read_b64_tr_b16 v[88:89], v35 offset:2048
    ds_read_b64_tr_b16 v[90:91], v35 offset:2560
    v_mfma_f32_32x32x16_bf16 a[208:223], v[100:103], a[36:39], a[208:223]
    buffer_load_dwordx4 a[8:11], v18, s[28:31], s67 offen sc1
    s_waitcnt lgkmcnt(8)
    v_mfma_f32_32x32x16_bf16 a[224:239], v[104:107], a[32:35], a[224:239]
    v_mfma_f32_32x32x16_bf16 a[240:255], v[104:107], a[36:39], a[240:255]
    buffer_load_dwordx4 a[12:15], v18, s[28:31], s67 offen offset:1024 sc1
    v_readlane_b32 s67, v22, 6
    s_waitcnt vmcnt(21) lgkmcnt(6)
    v_mfma_f32_32x32x16_bf16 v[44:59], v[76:79], a[40:43], v[44:59]
    s_waitcnt vmcnt(20)
    v_mfma_f32_32x32x16_bf16 v[60:75], v[76:79], a[44:47], v[60:75]
    s_nop 0
    buffer_load_dwordx4 a[16:19], v18, s[28:31], s67 offen sc1
    s_waitcnt lgkmcnt(4)
    v_mfma_f32_32x32x16_bf16 a[160:175], v[80:83], a[40:43], a[160:175]
    v_mfma_f32_32x32x16_bf16 a[176:191], v[80:83], a[44:47], a[176:191]
    buffer_load_dwordx4 a[20:23], v18, s[28:31], s67 offen offset:1024 sc1
    v_readlane_b32 s67, v22, 28
    s_waitcnt lgkmcnt(2)
    v_mfma_f32_32x32x16_bf16 a[192:207], v[84:87], a[40:43], a[192:207]
    v_mfma_f32_32x32x16_bf16 a[208:223], v[84:87], a[44:47], a[208:223]
    s_add_u32 m0, s60, 0x10000
    s_nop 0
    buffer_load_dwordx4 v14, s[20:23], s66 offen lds
    s_waitcnt lgkmcnt(0)
    v_mfma_f32_32x32x16_bf16 a[224:239], v[88:91], a[40:43], a[224:239]
    v_mfma_f32_32x32x16_bf16 a[240:255], v[88:91], a[44:47], a[240:255]
    buffer_load_dwordx4 v15, s[20:23], s66 offen offset:1024 lds
    s_waitcnt vmcnt(23)
    v_mfma_f32_32x32x16_bf16 v[44:59], a[144:147], a[48:51], v[44:59]
    s_waitcnt vmcnt(18)
    ds_read_b64_tr_b16 v[92:93], v32 offset:4096
    ds_read_b64_tr_b16 v[94:95], v32 offset:4608
    ds_read_b64_tr_b16 v[96:97], v35 offset:4096
    v_mfma_f32_32x32x16_bf16 v[60:75], a[144:147], a[52:55], v[60:75]
    s_add_u32 m0, s60, 0x10800
    s_nop 0
    buffer_load_dwordx4 v16, s[20:23], s66 offen lds
    v_mfma_f32_32x32x16_bf16 a[160:175], a[148:151], a[48:51], a[160:175]
    ds_read_b64_tr_b16 v[98:99], v35 offset:4608
    ds_read_b64_tr_b16 v[100:101], v32 offset:6144
    ds_read_b64_tr_b16 v[102:103], v32 offset:6656
    v_mfma_f32_32x32x16_bf16 a[176:191], a[148:151], a[52:55], a[176:191]
    buffer_load_dwordx4 v17, s[20:23], s66 offen offset:1024 lds
    v_readlane_b32 s66, v21, 29
    v_mfma_f32_32x32x16_bf16 a[192:207], a[152:155], a[48:51], a[192:207]
    ds_read_b64_tr_b16 v[104:105], v35 offset:6144
    ds_read_b64_tr_b16 v[106:107], v35 offset:6656
    v_mfma_f32_32x32x16_bf16 a[208:223], a[152:155], a[52:55], a[208:223]
    buffer_load_dwordx4 a[24:27], v18, s[28:31], s67 offen sc1
    v_mfma_f32_32x32x16_bf16 a[224:239], a[156:159], a[48:51], a[224:239]
    v_mfma_f32_32x32x16_bf16 a[240:255], a[156:159], a[52:55], a[240:255]
    buffer_load_dwordx4 a[28:31], v18, s[28:31], s67 offen offset:1024 sc1
    v_readlane_b32 s67, v22, 29
    s_barrier
    s_waitcnt vmcnt(21) lgkmcnt(6)
    v_mfma_f32_32x32x16_bf16 v[44:59], v[92:95], a[56:59], v[44:59]
    s_waitcnt vmcnt(16)
    ds_read_b64_tr_b16 v[76:77], v30 offset:32768
    ds_read_b64_tr_b16 v[78:79], v30 offset:33280
    ds_read_b64_tr_b16 v[80:81], v33 offset:32768
    v_mfma_f32_32x32x16_bf16 v[60:75], v[92:95], a[60:63], v[60:75]
    s_add_u32 m0, s60, 0x11000
    s_nop 0
    buffer_load_dwordx4 v14, s[20:23], s66 offen lds
    s_waitcnt lgkmcnt(7)
    v_mfma_f32_32x32x16_bf16 a[160:175], v[96:99], a[56:59], a[160:175]
    ds_read_b64_tr_b16 v[82:83], v33 offset:33280
    ds_read_b64_tr_b16 v[84:85], v30 offset:34816
    ds_read_b64_tr_b16 v[86:87], v30 offset:35328
    v_mfma_f32_32x32x16_bf16 a[176:191], v[96:99], a[60:63], a[176:191]
    buffer_load_dwordx4 v15, s[20:23], s66 offen offset:1024 lds
    s_waitcnt lgkmcnt(8)
    v_mfma_f32_32x32x16_bf16 a[192:207], v[100:103], a[56:59], a[192:207]
    ds_read_b64_tr_b16 v[88:89], v33 offset:34816
    ds_read_b64_tr_b16 v[90:91], v33 offset:35328
    v_mfma_f32_32x32x16_bf16 a[208:223], v[100:103], a[60:63], a[208:223]
    s_add_u32 m0, s60, 0x11800
    s_nop 0
    buffer_load_dwordx4 v16, s[20:23], s66 offen lds
    s_waitcnt lgkmcnt(8)
    v_mfma_f32_32x32x16_bf16 a[224:239], v[104:107], a[56:59], a[224:239]
    v_mfma_f32_32x32x16_bf16 a[240:255], v[104:107], a[60:63], a[240:255]
    buffer_load_dwordx4 v17, s[20:23], s66 offen offset:1024 lds
    v_readlane_b32 s66, v21, 30
    s_waitcnt vmcnt(19) lgkmcnt(6)
    v_mfma_f32_32x32x16_bf16 v[44:59], v[76:79], a[0:3], v[44:59]
    s_waitcnt vmcnt(14)
    ds_read_b64_tr_b16 v[92:93], v30 offset:36864
    ds_read_b64_tr_b16 v[94:95], v30 offset:37376
    ds_read_b64_tr_b16 v[96:97], v33 offset:36864
    v_mfma_f32_32x32x16_bf16 v[60:75], v[76:79], a[4:7], v[60:75]
    buffer_load_dwordx4 a[32:35], v18, s[28:31], s67 offen sc1
    s_waitcnt lgkmcnt(7)
    v_mfma_f32_32x32x16_bf16 a[160:175], v[80:83], a[0:3], a[160:175]
    ds_read_b64_tr_b16 v[98:99], v33 offset:37376
    ds_read_b64_tr_b16 v[100:101], v30 offset:38912
    ds_read_b64_tr_b16 v[102:103], v30 offset:39424
    v_mfma_f32_32x32x16_bf16 a[176:191], v[80:83], a[4:7], a[176:191]
    buffer_load_dwordx4 a[36:39], v18, s[28:31], s67 offen offset:1024 sc1
    v_readlane_b32 s67, v22, 7
    s_waitcnt lgkmcnt(8)
    v_mfma_f32_32x32x16_bf16 a[192:207], v[84:87], a[0:3], a[192:207]
    ds_read_b64_tr_b16 v[104:105], v33 offset:38912
    ds_read_b64_tr_b16 v[106:107], v33 offset:39424
    v_mfma_f32_32x32x16_bf16 a[208:223], v[84:87], a[4:7], a[208:223]
    buffer_load_dwordx4 a[40:43], v18, s[28:31], s67 offen sc1
    s_waitcnt lgkmcnt(8)
    v_mfma_f32_32x32x16_bf16 a[224:239], v[88:91], a[0:3], a[224:239]
    v_mfma_f32_32x32x16_bf16 a[240:255], v[88:91], a[4:7], a[240:255]
    buffer_load_dwordx4 a[44:47], v18, s[28:31], s67 offen offset:1024 sc1
    v_readlane_b32 s67, v22, 30
    s_waitcnt vmcnt(17) lgkmcnt(6)
    v_mfma_f32_32x32x16_bf16 v[44:59], v[92:95], a[8:11], v[44:59]
    s_waitcnt vmcnt(16)
    v_mfma_f32_32x32x16_bf16 v[60:75], v[92:95], a[12:15], v[60:75]
    s_add_u32 m0, s60, 0x0
    s_nop 0
    buffer_load_dwordx4 v14, s[20:23], s66 offen lds
    s_waitcnt lgkmcnt(4)
    v_mfma_f32_32x32x16_bf16 a[160:175], v[96:99], a[8:11], a[160:175]
    v_mfma_f32_32x32x16_bf16 a[176:191], v[96:99], a[12:15], a[176:191]
    buffer_load_dwordx4 v15, s[20:23], s66 offen offset:1024 lds
    s_waitcnt lgkmcnt(2)
    v_mfma_f32_32x32x16_bf16 a[192:207], v[100:103], a[8:11], a[192:207]
    v_mfma_f32_32x32x16_bf16 a[208:223], v[100:103], a[12:15], a[208:223]
    s_add_u32 m0, s60, 0x800
    s_nop 0
    buffer_load_dwordx4 v16, s[20:23], s66 offen lds
    s_waitcnt lgkmcnt(0)
    v_mfma_f32_32x32x16_bf16 a[224:239], v[104:107], a[8:11], a[224:239]
    v_mfma_f32_32x32x16_bf16 a[240:255], v[104:107], a[12:15], a[240:255]
    s_waitcnt vmcnt(18)
    v_mfma_f32_32x32x16_bf16 v[44:59], v[124:127], a[16:19], v[44:59]
    s_waitcnt vmcnt(13)
    ds_read_b64_tr_b16 v[76:77], v31 offset:0
    ds_read_b64_tr_b16 v[78:79], v31 offset:512
    ds_read_b64_tr_b16 v[80:81], v34 offset:0
    v_mfma_f32_32x32x16_bf16 v[60:75], v[124:127], a[20:23], v[60:75]
    buffer_load_dwordx4 v17, s[20:23], s66 offen offset:1024 lds
    v_readlane_b32 s66, v21, 31
    v_mfma_f32_32x32x16_bf16 a[160:175], v[128:131], a[16:19], a[160:175]
    ds_read_b64_tr_b16 v[82:83], v34 offset:512
    ds_read_b64_tr_b16 v[84:85], v31 offset:2048
    ds_read_b64_tr_b16 v[86:87], v31 offset:2560
    v_mfma_f32_32x32x16_bf16 a[176:191], v[128:131], a[20:23], a[176:191]
    buffer_load_dwordx4 a[48:51], v18, s[28:31], s67 offen sc1
    v_mfma_f32_32x32x16_bf16 a[192:207], v[132:135], a[16:19], a[192:207]
    ds_read_b64_tr_b16 v[88:89], v34 offset:2048
    ds_read_b64_tr_b16 v[90:91], v34 offset:2560
    v_mfma_f32_32x32x16_bf16 a[208:223], v[132:135], a[20:23], a[208:223]
    buffer_load_dwordx4 a[52:55], v18, s[28:31], s67 offen offset:1024 sc1
    v_readlane_b32 s67, v22, 31
    v_mfma_f32_32x32x16_bf16 a[224:239], v[136:139], a[16:19], a[224:239]
    v_mfma_f32_32x32x16_bf16 a[240:255], v[136:139], a[20:23], a[240:255]
    s_barrier
    s_waitcnt vmcnt(15) lgkmcnt(6)
    v_mfma_f32_32x32x16_bf16 v[44:59], v[76:79], a[24:27], v[44:59]
    s_waitcnt vmcnt(10)
    ds_read_b64_tr_b16 v[92:93], v31 offset:4096
    ds_read_b64_tr_b16 v[94:95], v31 offset:4608
    ds_read_b64_tr_b16 v[96:97], v34 offset:4096
    v_mfma_f32_32x32x16_bf16 v[60:75], v[76:79], a[28:31], v[60:75]
    s_add_u32 m0, s60, 0x1000
    s_nop 0
    buffer_load_dwordx4 v14, s[20:23], s66 offen lds
    s_waitcnt lgkmcnt(7)
    v_mfma_f32_32x32x16_bf16 a[160:175], v[80:83], a[24:27], a[160:175]
    ds_read_b64_tr_b16 v[98:99], v34 offset:4608
    ds_read_b64_tr_b16 v[100:101], v31 offset:6144
    ds_read_b64_tr_b16 v[102:103], v31 offset:6656
    v_mfma_f32_32x32x16_bf16 a[176:191], v[80:83], a[28:31], a[176:191]
    buffer_load_dwordx4 v15, s[20:23], s66 offen offset:1024 lds
    s_waitcnt lgkmcnt(8)
    v_mfma_f32_32x32x16_bf16 a[192:207], v[84:87], a[24:27], a[192:207]
    ds_read_b64_tr_b16 v[104:105], v34 offset:6144
    ds_read_b64_tr_b16 v[106:107], v34 offset:6656
    v_mfma_f32_32x32x16_bf16 a[208:223], v[84:87], a[28:31], a[208:223]
    s_add_u32 m0, s60, 0x1800
    s_nop 0
    buffer_load_dwordx4 v16, s[20:23], s66 offen lds
    s_waitcnt lgkmcnt(8)
    v_mfma_f32_32x32x16_bf16 a[224:239], v[88:91], a[24:27], a[224:239]
    v_mfma_f32_32x32x16_bf16 a[240:255], v[88:91], a[28:31], a[240:255]
    s_waitcnt vmcnt(12) lgkmcnt(6)
    v_mfma_f32_32x32x16_bf16 v[44:59], v[92:95], a[32:35], v[44:59]
    s_waitcnt vmcnt(11)
    v_mfma_f32_32x32x16_bf16 v[60:75], v[92:95], a[36:39], v[60:75]
    buffer_load_dwordx4 v17, s[20:23], s66 offen offset:1024 lds
    s_waitcnt lgkmcnt(4)
    v_mfma_f32_32x32x16_bf16 a[160:175], v[96:99], a[32:35], a[160:175]
    v_mfma_f32_32x32x16_bf16 a[176:191], v[96:99], a[36:39], a[176:191]
    buffer_load_dwordx4 a[56:59], v18, s[28:31], s67 offen sc1
    s_waitcnt lgkmcnt(2)
    v_mfma_f32_32x32x16_bf16 a[192:207], v[100:103], a[32:35], a[192:207]
    v_mfma_f32_32x32x16_bf16 a[208:223], v[100:103], a[36:39], a[208:223]
    buffer_load_dwordx4 a[60:63], v18, s[28:31], s67 offen offset:1024 sc1
    s_waitcnt lgkmcnt(0)
    v_mfma_f32_32x32x16_bf16 a[224:239], v[104:107], a[32:35], a[224:239]
    v_mfma_f32_32x32x16_bf16 a[240:255], v[104:107], a[36:39], a[240:255]
    s_waitcnt vmcnt(13)
    v_mfma_f32_32x32x16_bf16 v[44:59], v[140:143], a[40:43], v[44:59]
    s_waitcnt vmcnt(8)
    ds_read_b64_tr_b16 v[76:77], v30 offset:0
    ds_read_b64_tr_b16 v[78:79], v30 offset:512
    ds_read_b64_tr_b16 v[80:81], v33 offset:0
    ds_read_b64_tr_b16 v[82:83], v33 offset:512
    v_mfma_f32_32x32x16_bf16 v[60:75], v[140:143], a[44:47], v[60:75]
    ds_read_b64_tr_b16 v[84:85], v30 offset:2048
    ds_read_b64_tr_b16 v[86:87], v30 offset:2560
    ds_read_b64_tr_b16 v[88:89], v33 offset:2048
    ds_read_b64_tr_b16 v[90:91], v33 offset:2560
    v_mfma_f32_32x32x16_bf16 a[160:175], v[144:147], a[40:43], a[160:175]
    v_mfma_f32_32x32x16_bf16 a[176:191], v[144:147], a[44:47], a[176:191]
    s_add_u32 m0, s60, 0x18000
    s_mov_b32 s68, 0x0
    buffer_load_dwordx4 v19, s[24:27], s68 offen lds
    v_mfma_f32_32x32x16_bf16 a[192:207], v[148:151], a[40:43], a[192:207]
    v_mfma_f32_32x32x16_bf16 a[208:223], v[148:151], a[44:47], a[208:223]
    buffer_load_dwordx4 v20, s[24:27], s68 offen offset:1024 lds
    v_mfma_f32_32x32x16_bf16 a[224:239], v[152:155], a[40:43], a[224:239]
    v_mfma_f32_32x32x16_bf16 a[240:255], v[152:155], a[44:47], a[240:255]
    s_add_u32 m0, s60, 0x18800
    s_mov_b32 s68, 0x10000
    buffer_load_dwordx4 v19, s[24:27], s68 offen lds
    s_waitcnt vmcnt(10) lgkmcnt(6)
    v_mfma_f32_32x32x16_bf16 v[44:59], v[76:79], a[48:51], v[44:59]
    s_waitcnt vmcnt(5)
    ds_read_b64_tr_b16 v[92:93], v30 offset:4096
    ds_read_b64_tr_b16 v[94:95], v30 offset:4608
    ds_read_b64_tr_b16 v[96:97], v33 offset:4096
    ds_read_b64_tr_b16 v[98:99], v33 offset:4608
    v_mfma_f32_32x32x16_bf16 v[60:75], v[76:79], a[52:55], v[60:75]
    ds_read_b64_tr_b16 v[100:101], v30 offset:6144
    ds_read_b64_tr_b16 v[102:103], v30 offset:6656
    ds_read_b64_tr_b16 v[104:105], v33 offset:6144
    ds_read_b64_tr_b16 v[106:107], v33 offset:6656
    s_waitcnt lgkmcnt(12)
    v_mfma_f32_32x32x16_bf16 a[160:175], v[80:83], a[48:51], a[160:175]
    v_mfma_f32_32x32x16_bf16 a[176:191], v[80:83], a[52:55], a[176:191]
    buffer_load_dwordx4 v20, s[24:27], s68 offen offset:1024 lds
    s_waitcnt lgkmcnt(10)
    v_mfma_f32_32x32x16_bf16 a[192:207], v[84:87], a[48:51], a[192:207]
    v_mfma_f32_32x32x16_bf16 a[208:223], v[84:87], a[52:55], a[208:223]
    s_add_u32 m0, s60, 0x19000
    s_mov_b32 s68, 0x20000
    buffer_load_dwordx4 v19, s[24:27], s68 offen lds
    s_waitcnt lgkmcnt(8)
    v_mfma_f32_32x32x16_bf16 a[224:239], v[88:91], a[48:51], a[224:239]
    v_mfma_f32_32x32x16_bf16 a[240:255], v[88:91], a[52:55], a[240:255]
    buffer_load_dwordx4 v20, s[24:27], s68 offen offset:1024 lds
    s_barrier
    s_waitcnt vmcnt(7) lgkmcnt(4)
    v_mfma_f32_32x32x16_bf16 a[160:175], v[96:99], a[56:59], a[160:175]
    v_bfe_u32 v4, v1, 2, 2
    v_lshlrev_b32_e64 v4, 7, v4
    v_lshl_add_u32 v4, v3, 9, v4
    v_bfe_u32 v5, v1, 4, 1
    v_lshl_add_u32 v4, v5, 5, v4
    v_and_b32 v5, 3, v1
    s_waitcnt lgkmcnt(2)
    v_mfma_f32_32x32x16_bf16 a[192:207], v[100:103], a[56:59], a[192:207]
    v_lshl_add_u32 v4, v5, 3, v4
    v_bfe_u32 v5, v1, 3, 1
    v_lshl_add_u32 v4, v5, 6, v4
    v_add_u32 v30, s60, v4
    v_xor_b32 v33, 64, v30
    v_add_u32 v31, 0x10000, v30
    s_waitcnt lgkmcnt(0)
    v_mfma_f32_32x32x16_bf16 a[224:239], v[104:107], a[56:59], a[224:239]
    v_add_u32 v32, 0x20000, v30
    v_add_u32 v34, 0x10000, v33
    v_add_u32 v35, 0x20000, v33
    s_waitcnt vmcnt(6)
    v_mfma_f32_32x32x16_bf16 a[176:191], v[96:99], a[60:63], a[176:191]
    ds_write_b128 v23, a[160:163] offset:0
    v_mfma_f32_32x32x16_bf16 a[208:223], v[100:103], a[60:63], a[208:223]
    ds_write_b128 v23, a[164:167] offset:1024
    v_mfma_f32_32x32x16_bf16 a[240:255], v[104:107], a[60:63], a[240:255]
    ds_write_b128 v23, a[192:195] offset:32768
    v_mfma_f32_32x32x16_bf16 v[44:59], v[92:95], a[56:59], v[44:59]
    ds_write_b128 v23, a[196:199] offset:33792
    v_mfma_f32_32x32x16_bf16 v[60:75], v[92:95], a[60:63], v[60:75]
    ds_write_b128 v24, a[224:227] offset:0
    ds_write_b128 v24, a[228:231] offset:1024
    s_waitcnt lgkmcnt(0)
    s_barrier
    ds_read_b128 v[124:127], v25 offset:0
    ds_read_b128 v[132:135], v26 offset:0
    ds_read_b128 v[140:143], v27 offset:0
    ds_read_b128 v[128:131], v25 offset:1024
    ds_read_b128 v[136:139], v26 offset:1024
    ds_read_b128 v[144:147], v27 offset:1024
    ds_write_b128 v23, a[168:171] offset:2048
    ds_write_b128 v23, a[172:175] offset:3072
    s_waitcnt lgkmcnt(6)
    v_pk_add_f32 v[124:125], v[124:125], v[132:133]
    s_waitcnt lgkmcnt(5)
    v_pk_add_f32 v[44:45], v[44:45], v[140:141]
    v_pk_add_f32 v[44:45], v[44:45], v[124:125]
    v_pk_add_f32 v[126:127], v[126:127], v[134:135]
    v_pk_add_f32 v[46:47], v[46:47], v[142:143]
    v_pk_add_f32 v[46:47], v[46:47], v[126:127]
    s_waitcnt lgkmcnt(3)
    v_pk_add_f32 v[128:129], v[128:129], v[136:137]
    ds_write_b128 v23, a[200:203] offset:34816
    s_add_u32 m0, s60, 0x19800
    s_mov_b32 s68, 0x30000
    buffer_load_dwordx4 v19, s[24:27], s68 offen lds
    s_waitcnt lgkmcnt(3)
    v_pk_add_f32 v[48:49], v[48:49], v[144:145]
    v_pk_add_f32 v[48:49], v[48:49], v[128:129]
    v_pk_add_f32 v[130:131], v[130:131], v[138:139]
    v_pk_add_f32 v[50:51], v[50:51], v[146:147]
    v_pk_add_f32 v[50:51], v[50:51], v[130:131]
    v_pk_mul_f32 v[76:77], v[44:45], v[44:45]
    v_pk_mul_f32 v[78:79], v[46:47], v[46:47]
    ds_write_b128 v23, a[204:207] offset:35840
    v_pk_mul_f32 v[80:81], v[48:49], v[48:49]
    v_pk_mul_f32 v[82:83], v[50:51], v[50:51]
    v_pk_fma_f32 v[76:77], v[76:77], v[40:41], v[40:41] op_sel:[0,1,0] op_sel_hi:[1,1,0]
    v_pk_fma_f32 v[78:79], v[78:79], v[40:41], v[40:41] op_sel:[0,1,0] op_sel_hi:[1,1,0]
    v_pk_fma_f32 v[80:81], v[80:81], v[40:41], v[40:41] op_sel:[0,1,0] op_sel_hi:[1,1,0]
    v_pk_fma_f32 v[82:83], v[82:83], v[40:41], v[40:41] op_sel:[0,1,0] op_sel_hi:[1,1,0]
    v_pk_mul_f32 v[76:77], v[76:77], v[44:45]
    ds_write_b128 v24, a[232:235] offset:2048
    v_pk_mul_f32 v[78:79], v[78:79], v[46:47]
    v_pk_mul_f32 v[80:81], v[80:81], v[48:49]
    v_pk_mul_f32 v[82:83], v[82:83], v[50:51]
    v_exp_f32 v76, v76
    v_exp_f32 v77, v77
    v_exp_f32_e64 v78, v78
    buffer_load_dwordx4 v20, s[24:27], s68 offen offset:1024 lds
    v_exp_f32_e64 v79, v79
    ds_write_b128 v24, a[236:239] offset:3072
    v_exp_f32 v80, v80
    v_exp_f32 v81, v81
    v_exp_f32 v82, v82
    v_exp_f32 v83, v83
    s_waitcnt lgkmcnt(0)
    s_barrier
    ds_read_b128 v[148:151], v25 offset:2048
    ds_read_b128 v[156:159], v26 offset:2048
    ds_read_b128 v[164:167], v27 offset:2048
    ds_read_b128 v[152:155], v25 offset:3072
    ds_read_b128 v[160:163], v26 offset:3072
    ds_read_b128 v[168:171], v27 offset:3072
    v_pk_add_f32 v[76:77], v[76:77], v[42:43] op_sel:[0,0] op_sel_hi:[1,0]
    v_pk_add_f32 v[78:79], v[78:79], v[42:43] op_sel:[0,0] op_sel_hi:[1,0]
    v_pk_add_f32 v[80:81], v[80:81], v[42:43] op_sel:[0,0] op_sel_hi:[1,0]
    v_pk_add_f32 v[82:83], v[82:83], v[42:43] op_sel:[0,0] op_sel_hi:[1,0]
    v_rcp_f32 v76, v76
    v_rcp_f32 v77, v77
    v_rcp_f32 v78, v78
    v_rcp_f32 v79, v79
    v_rcp_f32 v80, v80
    v_rcp_f32 v81, v81
    v_rcp_f32 v82, v82
    v_rcp_f32 v83, v83
    v_pk_mul_f32 v[76:77], v[76:77], v[44:45]
    v_pk_mul_f32 v[78:79], v[78:79], v[46:47]
    s_add_u32 m0, s60, 0x20000
    s_mov_b32 s68, 0x40000
    buffer_load_dwordx4 v19, s[24:27], s68 offen lds
    v_pk_mul_f32 v[80:81], v[80:81], v[48:49]
    v_pk_mul_f32 v[82:83], v[82:83], v[50:51]
    v_cvt_pk_bf16_f32 v92, v76, v77
    v_cvt_pk_bf16_f32 v93, v78, v79
    v_cvt_pk_bf16_f32 v94, v80, v81
    v_cvt_pk_bf16_f32 v95, v82, v83
    buffer_store_dwordx4 v[92:95], v28, s[28:31], 0 offen offset:0 sc1
    s_waitcnt lgkmcnt(4)
    v_pk_add_f32 v[148:149], v[148:149], v[156:157]
    s_waitcnt lgkmcnt(3)
    v_pk_add_f32 v[52:53], v[52:53], v[164:165]
    v_pk_add_f32 v[52:53], v[52:53], v[148:149]
    v_pk_add_f32 v[150:151], v[150:151], v[158:159]
    v_pk_add_f32 v[54:55], v[54:55], v[166:167]
    ds_write_b128 v23, a[176:179] offset:4096
    v_pk_add_f32 v[54:55], v[54:55], v[150:151]
    s_waitcnt lgkmcnt(2)
    v_pk_add_f32 v[152:153], v[152:153], v[160:161]
    s_waitcnt lgkmcnt(1)
    v_pk_add_f32 v[56:57], v[56:57], v[168:169]
    v_pk_add_f32 v[56:57], v[56:57], v[152:153]
    v_pk_add_f32 v[154:155], v[154:155], v[162:163]
    ds_write_b128 v23, a[180:183] offset:5120
    v_pk_add_f32 v[58:59], v[58:59], v[170:171]
    v_pk_add_f32 v[58:59], v[58:59], v[154:155]
    v_pk_mul_f32 v[76:77], v[52:53], v[52:53]
    v_pk_mul_f32 v[78:79], v[54:55], v[54:55]
    v_pk_mul_f32 v[80:81], v[56:57], v[56:57]
    ds_write_b128 v23, a[208:211] offset:36864
    buffer_load_dwordx4 v20, s[24:27], s68 offen offset:1024 lds
    v_pk_mul_f32 v[82:83], v[58:59], v[58:59]
    v_pk_fma_f32 v[76:77], v[76:77], v[40:41], v[40:41] op_sel:[0,1,0] op_sel_hi:[1,1,0]
    v_pk_fma_f32 v[78:79], v[78:79], v[40:41], v[40:41] op_sel:[0,1,0] op_sel_hi:[1,1,0]
    v_pk_fma_f32 v[80:81], v[80:81], v[40:41], v[40:41] op_sel:[0,1,0] op_sel_hi:[1,1,0]
    v_pk_fma_f32 v[82:83], v[82:83], v[40:41], v[40:41] op_sel:[0,1,0] op_sel_hi:[1,1,0]
    ds_write_b128 v23, a[212:215] offset:37888
    v_pk_mul_f32 v[76:77], v[76:77], v[52:53]
    v_pk_mul_f32 v[78:79], v[78:79], v[54:55]
    v_pk_mul_f32 v[80:81], v[80:81], v[56:57]
    v_pk_mul_f32 v[82:83], v[82:83], v[58:59]
    v_exp_f32_e64 v76, v76
    ds_write_b128 v24, a[240:243] offset:4096
    v_exp_f32 v77, v77
    v_exp_f32 v78, v78
    v_exp_f32 v79, v79
    v_exp_f32 v80, v80
    v_exp_f32_e64 v81, v81
    ds_write_b128 v24, a[244:247] offset:5120
    s_add_u32 m0, s60, 0x20800
    s_mov_b32 s68, 0x50000
    buffer_load_dwordx4 v19, s[24:27], s68 offen lds
    v_exp_f32 v82, v82
    v_exp_f32 v83, v83
    v_pk_add_f32 v[76:77], v[76:77], v[42:43] op_sel:[0,0] op_sel_hi:[1,0]
    v_pk_add_f32 v[78:79], v[78:79], v[42:43] op_sel:[0,0] op_sel_hi:[1,0]
    s_waitcnt lgkmcnt(0)
    s_barrier
    ds_read_b128 v[124:127], v25 offset:4096
    ds_read_b128 v[132:135], v26 offset:4096
    ds_read_b128 v[140:143], v27 offset:4096
    ds_read_b128 v[128:131], v25 offset:5120
    ds_read_b128 v[136:139], v26 offset:5120
    ds_read_b128 v[144:147], v27 offset:5120
    v_pk_add_f32 v[80:81], v[80:81], v[42:43] op_sel:[0,0] op_sel_hi:[1,0]
    v_pk_add_f32 v[82:83], v[82:83], v[42:43] op_sel:[0,0] op_sel_hi:[1,0]
    v_rcp_f32 v76, v76
    v_rcp_f32 v77, v77
    v_rcp_f32 v78, v78
    v_rcp_f32 v79, v79
    v_rcp_f32 v80, v80
    v_rcp_f32 v81, v81
    v_rcp_f32 v82, v82
    v_rcp_f32 v83, v83
    v_pk_mul_f32 v[76:77], v[76:77], v[52:53]
    v_pk_mul_f32 v[78:79], v[78:79], v[54:55]
    v_pk_mul_f32 v[80:81], v[80:81], v[56:57]
    v_pk_mul_f32 v[82:83], v[82:83], v[58:59]
    v_cvt_pk_bf16_f32 v96, v76, v77
    v_cvt_pk_bf16_f32 v97, v78, v79
    v_cvt_pk_bf16_f32 v98, v80, v81
    v_cvt_pk_bf16_f32 v99, v82, v83
    buffer_store_dwordx4 v[96:99], v28, s[28:31], 0 offen offset:2048 sc1
    buffer_load_dwordx4 v20, s[24:27], s68 offen offset:1024 lds
    s_waitcnt lgkmcnt(4)
    v_pk_add_f32 v[124:125], v[124:125], v[132:133]
    s_waitcnt lgkmcnt(3)
    v_pk_add_f32 v[60:61], v[60:61], v[140:141]
    v_pk_add_f32 v[60:61], v[60:61], v[124:125]
    v_pk_add_f32 v[126:127], v[126:127], v[134:135]
    v_pk_add_f32 v[62:63], v[62:63], v[142:143]
    ds_write_b128 v23, a[184:187] offset:6144
    v_pk_add_f32 v[62:63], v[62:63], v[126:127]
    s_waitcnt lgkmcnt(2)
    v_pk_add_f32 v[128:129], v[128:129], v[136:137]
    s_waitcnt lgkmcnt(1)
    v_pk_add_f32 v[64:65], v[64:65], v[144:145]
    v_pk_add_f32 v[64:65], v[64:65], v[128:129]
    v_pk_add_f32 v[130:131], v[130:131], v[138:139]
    ds_write_b128 v23, a[188:191] offset:7168
    v_pk_add_f32 v[66:67], v[66:67], v[146:147]
    v_pk_add_f32 v[66:67], v[66:67], v[130:131]
    v_pk_mul_f32 v[76:77], v[60:61], v[60:61]
    v_pk_mul_f32 v[78:79], v[62:63], v[62:63]
    v_pk_mul_f32 v[80:81], v[64:65], v[64:65]
    ds_write_b128 v23, a[216:219] offset:38912
    v_pk_mul_f32 v[82:83], v[66:67], v[66:67]
    v_pk_fma_f32 v[76:77], v[76:77], v[40:41], v[40:41] op_sel:[0,1,0] op_sel_hi:[1,1,0]
    v_pk_fma_f32 v[78:79], v[78:79], v[40:41], v[40:41] op_sel:[0,1,0] op_sel_hi:[1,1,0]
    v_pk_fma_f32 v[80:81], v[80:81], v[40:41], v[40:41] op_sel:[0,1,0] op_sel_hi:[1,1,0]
    s_add_u32 m0, s60, 0x21000
    s_mov_b32 s68, 0x60000
    buffer_load_dwordx4 v19, s[24:27], s68 offen lds
    v_pk_fma_f32 v[82:83], v[82:83], v[40:41], v[40:41] op_sel:[0,1,0] op_sel_hi:[1,1,0]
    ds_write_b128 v23, a[220:223] offset:39936
    v_pk_mul_f32 v[76:77], v[76:77], v[60:61]
    v_pk_mul_f32 v[78:79], v[78:79], v[62:63]
    v_pk_mul_f32 v[80:81], v[80:81], v[64:65]
    v_pk_mul_f32 v[82:83], v[82:83], v[66:67]
    v_exp_f32_e64 v76, v76
    ds_write_b128 v24, a[248:251] offset:6144
    v_exp_f32 v77, v77
    v_exp_f32 v78, v78
    v_exp_f32 v79, v79
    v_exp_f32 v80, v80
    v_exp_f32_e64 v81, v81
    ds_write_b128 v24, a[252:255] offset:7168
    buffer_load_dwordx4 v20, s[24:27], s68 offen offset:1024 lds
    v_exp_f32 v82, v82
    v_exp_f32 v83, v83
    v_pk_add_f32 v[76:77], v[76:77], v[42:43] op_sel:[0,0] op_sel_hi:[1,0]
    v_pk_add_f32 v[78:79], v[78:79], v[42:43] op_sel:[0,0] op_sel_hi:[1,0]
    s_waitcnt lgkmcnt(0)
    s_barrier
    ds_read_b128 v[148:151], v25 offset:6144
    ds_read_b128 v[156:159], v26 offset:6144
    ds_read_b128 v[164:167], v27 offset:6144
    ds_read_b128 v[152:155], v25 offset:7168
    ds_read_b128 v[160:163], v26 offset:7168
    ds_read_b128 v[168:171], v27 offset:7168
    v_pk_add_f32 v[80:81], v[80:81], v[42:43] op_sel:[0,0] op_sel_hi:[1,0]
    v_pk_add_f32 v[82:83], v[82:83], v[42:43] op_sel:[0,0] op_sel_hi:[1,0]
    v_rcp_f32 v76, v76
    v_rcp_f32 v77, v77
    v_rcp_f32 v78, v78
    v_rcp_f32 v79, v79
    v_rcp_f32 v80, v80
    v_rcp_f32 v81, v81
    v_rcp_f32_e64 v82, v82
    v_rcp_f32 v83, v83
    v_pk_mul_f32 v[76:77], v[76:77], v[60:61]
    v_pk_mul_f32 v[78:79], v[78:79], v[62:63]
    v_pk_mul_f32 v[80:81], v[80:81], v[64:65]
    v_pk_mul_f32 v[82:83], v[82:83], v[66:67]
    v_cvt_pk_bf16_f32 v100, v76, v77
    v_cvt_pk_bf16_f32 v101, v78, v79
    v_cvt_pk_bf16_f32 v102, v80, v81
    v_cvt_pk_bf16_f32 v103, v82, v83
    buffer_store_dwordx4 v[100:103], v28, s[28:31], 0 offen offset:1024 sc1
    s_waitcnt lgkmcnt(4)
    v_pk_add_f32 v[148:149], v[148:149], v[156:157]
    s_waitcnt lgkmcnt(3)
    v_pk_add_f32 v[68:69], v[68:69], v[164:165]
    v_pk_add_f32 v[68:69], v[68:69], v[148:149]
    v_pk_add_f32 v[150:151], v[150:151], v[158:159]
    v_pk_add_f32 v[70:71], v[70:71], v[166:167]
    v_pk_add_f32 v[70:71], v[70:71], v[150:151]
    s_waitcnt lgkmcnt(1)
    v_pk_add_f32 v[152:153], v[152:153], v[160:161]
    s_waitcnt lgkmcnt(0)
    v_pk_add_f32 v[72:73], v[72:73], v[168:169]
    v_pk_add_f32 v[72:73], v[72:73], v[152:153]
    s_waitcnt vmcnt(15)
    ds_read_b64_tr_b16 a[64:65], v31 offset:32768
    ds_read_b64_tr_b16 a[66:67], v31 offset:33792
    ds_read_b64_tr_b16 a[68:69], v34 offset:32768
    ds_read_b64_tr_b16 a[70:71], v34 offset:33792
    s_add_u32 m0, s60, 0x21800
    s_mov_b32 s68, 0x70000
    buffer_load_dwordx4 v19, s[24:27], s68 offen lds
    v_pk_add_f32 v[154:155], v[154:155], v[162:163]
    v_pk_add_f32 v[74:75], v[74:75], v[170:171]
    v_pk_add_f32 v[74:75], v[74:75], v[154:155]
    v_pk_mul_f32 v[76:77], v[68:69], v[68:69]
    v_pk_mul_f32 v[78:79], v[70:71], v[70:71]
    v_pk_mul_f32 v[80:81], v[72:73], v[72:73]
    v_pk_mul_f32 v[82:83], v[74:75], v[74:75]
    v_pk_fma_f32 v[76:77], v[76:77], v[40:41], v[40:41] op_sel:[0,1,0] op_sel_hi:[1,1,0]
    v_pk_fma_f32 v[78:79], v[78:79], v[40:41], v[40:41] op_sel:[0,1,0] op_sel_hi:[1,1,0]
    v_pk_fma_f32 v[80:81], v[80:81], v[40:41], v[40:41] op_sel:[0,1,0] op_sel_hi:[1,1,0]
    v_pk_fma_f32 v[82:83], v[82:83], v[40:41], v[40:41] op_sel:[0,1,0] op_sel_hi:[1,1,0]
    v_pk_mul_f32 v[76:77], v[76:77], v[68:69]
    v_pk_mul_f32 v[78:79], v[78:79], v[70:71]
    v_pk_mul_f32 v[80:81], v[80:81], v[72:73]
    v_pk_mul_f32 v[82:83], v[82:83], v[74:75]
    v_exp_f32 v76, v76
    v_exp_f32 v77, v77
    v_exp_f32 v78, v78
    v_exp_f32 v79, v79
    v_exp_f32 v80, v80
    v_exp_f32 v81, v81
    v_exp_f32 v82, v82
    v_exp_f32 v83, v83
    v_pk_add_f32 v[76:77], v[76:77], v[42:43] op_sel:[0,0] op_sel_hi:[1,0]
    v_pk_add_f32 v[78:79], v[78:79], v[42:43] op_sel:[0,0] op_sel_hi:[1,0]
    v_pk_add_f32 v[80:81], v[80:81], v[42:43] op_sel:[0,0] op_sel_hi:[1,0]
    v_pk_add_f32 v[82:83], v[82:83], v[42:43] op_sel:[0,0] op_sel_hi:[1,0]
    v_rcp_f32 v76, v76
    v_rcp_f32 v77, v77
    v_rcp_f32 v78, v78
    v_rcp_f32 v79, v79
    buffer_load_dwordx4 v20, s[24:27], s68 offen offset:1024 lds
    v_rcp_f32 v80, v80
    v_rcp_f32 v81, v81
    v_rcp_f32 v82, v82
    v_rcp_f32 v83, v83
    v_pk_mul_f32 v[76:77], v[76:77], v[68:69]
    v_pk_mul_f32 v[78:79], v[78:79], v[70:71]
    v_pk_mul_f32 v[80:81], v[80:81], v[72:73]
    v_pk_mul_f32 v[82:83], v[82:83], v[74:75]
    v_cvt_pk_bf16_f32 v104, v76, v77
    v_cvt_pk_bf16_f32 v105, v78, v79
    v_cvt_pk_bf16_f32 v106, v80, v81
    v_cvt_pk_bf16_f32 v107, v82, v83
    buffer_store_dwordx4 v[104:107], v28, s[28:31], 0 offen offset:3072 sc1
    s_barrier
    s_waitcnt vmcnt(16)
    ds_read_b64_tr_b16 a[72:73], v31 offset:34816
    ds_read_b64_tr_b16 a[74:75], v31 offset:35840
    ds_read_b64_tr_b16 a[76:77], v34 offset:34816
    ds_read_b64_tr_b16 a[78:79], v34 offset:35840
    s_add_u32 m0, s60, 0x18000
    s_mov_b32 s68, 0x80000
    s_waitcnt lgkmcnt(4)
    buffer_load_dwordx4 v19, s[24:27], s68 offen lds
    buffer_load_dwordx4 v20, s[24:27], s68 offen offset:1024 lds
    s_waitcnt vmcnt(16)
    ds_read_b64_tr_b16 a[80:81], v31 offset:36864
    ds_read_b64_tr_b16 a[82:83], v31 offset:37888
    ds_read_b64_tr_b16 a[84:85], v34 offset:36864
    ds_read_b64_tr_b16 a[86:87], v34 offset:37888
    s_add_u32 m0, s60, 0x18800
    s_mov_b32 s68, 0x90000
    s_waitcnt lgkmcnt(4)
    buffer_load_dwordx4 v19, s[24:27], s68 offen lds
    buffer_load_dwordx4 v20, s[24:27], s68 offen offset:1024 lds
    s_waitcnt vmcnt(16)
    ds_read_b64_tr_b16 a[88:89], v31 offset:38912
    ds_read_b64_tr_b16 a[90:91], v31 offset:39936
    ds_read_b64_tr_b16 a[92:93], v34 offset:38912
    ds_read_b64_tr_b16 a[94:95], v34 offset:39936
    s_add_u32 m0, s60, 0x19000
    s_mov_b32 s68, 0xa0000
    s_waitcnt lgkmcnt(4)
    buffer_load_dwordx4 v19, s[24:27], s68 offen lds
    buffer_load_dwordx4 v20, s[24:27], s68 offen offset:1024 lds
    s_waitcnt vmcnt(6)
    s_barrier
    s_cmp_lg_u32 s48, 0
    s_cbranch_scc1 L_nf_f2
    buffer_store_dword v12, v9, s[28:31], 0 offen sc1
L_nf_f2:
    v_bfe_u32 v4, v1, 1, 2
    v_and_b32 v5, 1, v1
    v_lshl_or_b32 v4, v5, 2, v4
    v_xor_b32 v4, v4, v3
    v_lshlrev_b32 v4, 4, v4
    v_lshl_add_u32 v4, v2, 7, v4
    ds_read_b64_tr_b16 a[96:97], v32 offset:0
    ds_read_b64_tr_b16 a[98:99], v32 offset:1024
    ds_read_b64_tr_b16 a[100:101], v35 offset:0
    ds_read_b64_tr_b16 a[102:103], v35 offset:1024
    s_add_u32 m0, s60, 0x19800
    s_mov_b32 s68, 0xb0000
    s_waitcnt lgkmcnt(4)
    buffer_load_dwordx4 v19, s[24:27], s68 offen lds
    s_add_u32 s56, s60, 0x18000
    buffer_load_dwordx4 v20, s[24:27], s68 offen offset:1024 lds
    v_add_u32 v14, s56, v4
    v_xor_b32 v15, 32, v14
    v_xor_b32 v16, 64, v14
    ds_read_b64_tr_b16 a[104:105], v32 offset:2048
    ds_read_b64_tr_b16 a[106:107], v32 offset:3072
    ds_read_b64_tr_b16 a[108:109], v35 offset:2048
    ds_read_b64_tr_b16 a[110:111], v35 offset:3072
    s_add_u32 m0, s60, 0x20000
    s_mov_b32 s68, 0xc0000
    s_waitcnt lgkmcnt(4)
    buffer_load_dwordx4 v19, s[24:27], s68 offen lds
    v_xor_b32 v17, 96, v14
    buffer_load_dwordx4 v20, s[24:27], s68 offen offset:1024 lds
    v_bfe_u32 v4, v1, 3, 2
    v_and_or_b32 v4, v1, 4, v4
    v_and_b32 v5, 3, v1
    ds_read_b64_tr_b16 a[112:113], v32 offset:4096
    ds_read_b64_tr_b16 a[114:115], v32 offset:5120
    ds_read_b64_tr_b16 a[116:117], v35 offset:4096
    ds_read_b64_tr_b16 a[118:119], v35 offset:5120
    s_add_u32 m0, s60, 0x20800
    s_mov_b32 s68, 0xd0000
    s_waitcnt lgkmcnt(4)
    buffer_load_dwordx4 v19, s[24:27], s68 offen lds
    v_lshlrev_b32 v5, 1, v5
    buffer_load_dwordx4 v20, s[24:27], s68 offen offset:1024 lds
    v_xor_b32 v4, v4, v5
    v_lshlrev_b32 v4, 4, v4
    v_lshrrev_b32_e64 v5, 2, v1
    ds_read_b64_tr_b16 a[120:121], v32 offset:6144
    ds_read_b64_tr_b16 a[122:123], v32 offset:7168
    ds_read_b64_tr_b16 a[124:125], v35 offset:6144
    ds_read_b64_tr_b16 a[126:127], v35 offset:7168
    s_add_u32 m0, s60, 0x21000
    s_mov_b32 s68, 0xe0000
    s_waitcnt lgkmcnt(4)
    buffer_load_dwordx4 v19, s[24:27], s68 offen lds
    v_lshl_add_u32 v4, v5, 7, v4
    buffer_load_dwordx4 v20, s[24:27], s68 offen offset:1024 lds
    s_add_u32 s56, s64, 0x18000
    v_add_u32 v18, s56, v4
    v_xor_b32 v26, 16, v18
    s_waitcnt vmcnt(12)
    ds_read_b64_tr_b16 v[172:173], v31 offset:32768
    ds_read_b64_tr_b16 v[174:175], v31 offset:33792
    ds_read_b64_tr_b16 v[176:177], v34 offset:32768
    ds_read_b64_tr_b16 v[178:179], v34 offset:33792
    s_add_u32 m0, s60, 0x21800
    s_mov_b32 s68, 0xf0000
    s_waitcnt lgkmcnt(4)
    buffer_load_dwordx4 v19, s[24:27], s68 offen lds
    v_mov_b32 v42, 1.0
    buffer_load_dwordx4 v20, s[24:27], s68 offen offset:1024 lds
    s_lshl_b32 s56, s54, 3
    s_add_u32 s56, s56, s53
    s_lshl_b32 s56, s56, 13
    s_waitcnt vmcnt(12)
    ds_read_b64_tr_b16 v[180:181], v31 offset:34816
    ds_read_b64_tr_b16 v[182:183], v31 offset:35840
    ds_read_b64_tr_b16 v[184:185], v34 offset:34816
    ds_read_b64_tr_b16 v[186:187], v34 offset:35840
    s_add_u32 m0, s60, 0x0
    s_mov_b32 s68, 0x100000
    buffer_load_dwordx4 v19, s[24:27], s68 offen lds
    s_add_u32 s56, s56, 0x800000
    buffer_load_dwordx4 v20, s[24:27], s68 offen offset:1024 lds
    v_lshl_add_u32 v23, v0, 4, s56
    v_add_u32 v28, 0x1000, v23
    s_mul_i32 s56, s53, 229376
    s_waitcnt vmcnt(12)
    ds_read_b64_tr_b16 v[188:189], v31 offset:36864
    ds_read_b64_tr_b16 v[190:191], v31 offset:37888
    ds_read_b64_tr_b16 v[192:193], v34 offset:36864
    ds_read_b64_tr_b16 v[194:195], v34 offset:37888
    s_add_u32 m0, s60, 0x800
    s_mov_b32 s68, 0x110000
    buffer_load_dwordx4 v19, s[24:27], s68 offen lds
    s_mul_i32 s57, s48, 57344
    buffer_load_dwordx4 v20, s[24:27], s68 offen offset:1024 lds
    s_add_u32 s56, s56, s57
    s_add_u32 s56, s56, 0x200000
    v_lshl_add_u32 v29, v1, 4, s56
    s_waitcnt vmcnt(12)
    ds_read_b64_tr_b16 v[196:197], v31 offset:38912
    ds_read_b64_tr_b16 v[198:199], v31 offset:39936
    ds_read_b64_tr_b16 v[200:201], v34 offset:38912
    ds_read_b64_tr_b16 v[202:203], v34 offset:39936
    s_add_u32 m0, s60, 0x1000
    s_mov_b32 s68, 0x120000
    buffer_load_dwordx4 v19, s[24:27], s68 offen lds
    s_lshl_b32 s56, s53, 4
    buffer_load_dwordx4 v20, s[24:27], s68 offen offset:1024 lds
    s_mul_i32 s57, s48, 7
    s_lshr_b32 s57, s57, 1
    s_add_u32 s56, s56, s57
    s_waitcnt vmcnt(12)
    ds_read_b64_tr_b16 v[204:205], v32 offset:0
    ds_read_b64_tr_b16 v[206:207], v32 offset:1024
    ds_read_b64_tr_b16 v[208:209], v35 offset:0
    ds_read_b64_tr_b16 v[210:211], v35 offset:1024
    s_add_u32 m0, s60, 0x1800
    s_mov_b32 s68, 0x130000
    buffer_load_dwordx4 v19, s[24:27], s68 offen lds
    s_lshl_b32 s56, s56, 6
    buffer_load_dwordx4 v20, s[24:27], s68 offen offset:1024 lds
    s_add_u32 s56, s56, 0x628000
    v_lshrrev_b32 v4, 4, v1
    v_lshl_add_u32 v11, v4, 6, s56
    s_waitcnt vmcnt(12)
    ds_read_b64_tr_b16 v[212:213], v32 offset:2048
    ds_read_b64_tr_b16 v[214:215], v32 offset:3072
    ds_read_b64_tr_b16 v[216:217], v35 offset:2048
    ds_read_b64_tr_b16 v[218:219], v35 offset:3072
    s_add_u32 m0, s60, 0x8000
    s_mov_b32 s68, 0x140000
    buffer_load_dwordx4 v19, s[24:27], s68 offen lds
    buffer_load_dwordx4 v20, s[24:27], s68 offen offset:1024 lds
    s_waitcnt vmcnt(12)
    ds_read_b64_tr_b16 v[220:221], v32 offset:4096
    ds_read_b64_tr_b16 v[222:223], v32 offset:5120
    ds_read_b64_tr_b16 v[224:225], v35 offset:4096
    ds_read_b64_tr_b16 v[226:227], v35 offset:5120
    s_add_u32 m0, s60, 0x8800
    s_mov_b32 s68, 0x150000
    buffer_load_dwordx4 v19, s[24:27], s68 offen lds
    buffer_load_dwordx4 v20, s[24:27], s68 offen offset:1024 lds
    s_waitcnt vmcnt(12)
    ds_read_b64_tr_b16 v[228:229], v32 offset:6144
    ds_read_b64_tr_b16 v[230:231], v32 offset:7168
    ds_read_b64_tr_b16 v[232:233], v35 offset:6144
    ds_read_b64_tr_b16 v[234:235], v35 offset:7168
    s_add_u32 m0, s60, 0x9000
    s_mov_b32 s68, 0x160000
    buffer_load_dwordx4 v19, s[24:27], s68 offen lds
    buffer_load_dwordx4 v20, s[24:27], s68 offen offset:1024 lds
    buffer_load_dword v10, v11, s[28:31], 0 offen sc1
    s_add_u32 m0, s60, 0x9800
    s_mov_b32 s68, 0x170000
    buffer_load_dwordx4 v19, s[24:27], s68 offen lds
    buffer_load_dwordx4 v20, s[24:27], s68 offen offset:1024 lds
    s_add_u32 m0, s60, 0x10000
    s_mov_b32 s68, 0x180000
    buffer_load_dwordx4 v19, s[24:27], s68 offen lds
    buffer_load_dwordx4 v20, s[24:27], s68 offen offset:1024 lds
    s_add_u32 m0, s60, 0x10800
    s_mov_b32 s68, 0x190000
    buffer_load_dwordx4 v19, s[24:27], s68 offen lds
    buffer_load_dwordx4 v20, s[24:27], s68 offen offset:1024 lds
    s_add_u32 m0, s60, 0x11000
    s_mov_b32 s68, 0x1a0000
    buffer_load_dwordx4 v19, s[24:27], s68 offen lds
    buffer_load_dwordx4 v20, s[24:27], s68 offen offset:1024 lds
    s_add_u32 m0, s60, 0x11800
    s_mov_b32 s68, 0x1b0000
    buffer_load_dwordx4 v19, s[24:27], s68 offen lds
    buffer_load_dwordx4 v20, s[24:27], s68 offen offset:1024 lds
L_join:
    s_waitcnt vmcnt(10)
    v_cmp_ne_u32 vcc, 1, v10
    s_nop 0
    s_cbranch_vccnz L_slow_f2
L_ok_f2:
L_join2:
    buffer_load_dwordx4 a[0:3], v29, s[28:31], s69 offen offset:0 sc1
    s_mov_b32 s69, 2048
    buffer_load_dwordx4 a[4:7], v29, s[28:31], s69 offen offset:0 sc1
    s_mov_b32 s69, 4096
    buffer_load_dwordx4 a[8:11], v29, s[28:31], s69 offen offset:0 sc1
    s_mov_b32 s69, 6144
    buffer_load_dwordx4 a[12:15], v29, s[28:31], s69 offen offset:0 sc1
    s_mov_b32 s69, 8192
    buffer_load_dwordx4 a[16:19], v29, s[28:31], s69 offen offset:0 sc1
    s_mov_b32 s69, 10240
    buffer_load_dwordx4 a[20:23], v29, s[28:31], s69 offen offset:0 sc1
    s_mov_b32 s69, 12288
    buffer_load_dwordx4 a[24:27], v29, s[28:31], s69 offen offset:0 sc1
    s_mov_b32 s69, 14336
    buffer_load_dwordx4 a[28:31], v29, s[28:31], s69 offen offset:0 sc1
    s_mov_b32 s69, 16384
    buffer_load_dwordx4 a[32:35], v29, s[28:31], s69 offen offset:0 sc1
    s_mov_b32 s69, 18432
    buffer_load_dwordx4 a[36:39], v29, s[28:31], s69 offen offset:0 sc1
    s_mov_b32 s69, 20480
    buffer_load_dwordx4 a[40:43], v29, s[28:31], s69 offen offset:0 sc1
    s_mov_b32 s69, 22528
    s_waitcnt vmcnt(10)
    v_mfma_f32_32x32x16_bf16 v[44:59], a[0:3], a[64:67], 0
    v_mfma_f32_32x32x16_bf16 v[60:75], a[0:3], a[68:71], 0
    buffer_load_dwordx4 a[44:47], v29, s[28:31], s69 offen offset:0 sc1
    s_mov_b32 s69, 24576
    s_waitcnt vmcnt(10)
    v_mfma_f32_32x32x16_bf16 v[44:59], a[4:7], a[72:75], v[44:59]
    v_mfma_f32_32x32x16_bf16 v[60:75], a[4:7], a[76:79], v[60:75]
    buffer_load_dwordx4 a[48:51], v29, s[28:31], s69 offen offset:0 sc1
    s_mov_b32 s69, 26624
    s_waitcnt vmcnt(10)
    v_mfma_f32_32x32x16_bf16 v[44:59], a[8:11], a[80:83], v[44:59]
    v_mfma_f32_32x32x16_bf16 v[60:75], a[8:11], a[84:87], v[60:75]
    buffer_load_dwordx4 a[52:55], v29, s[28:31], s69 offen offset:0 sc1
    s_mov_b32 s69, 28672
    s_waitcnt vmcnt(10)
    v_mfma_f32_32x32x16_bf16 v[44:59], a[12:15], a[88:91], v[44:59]
    v_mov_b32 v40, 0xbfb8aa3b
    v_lshlrev_b32 v38, 16, v43
    v_lshlrev_b32 v108, 16, v248
    v_mfma_f32_32x32x16_bf16 v[60:75], a[12:15], a[92:95], v[60:75]
    buffer_load_dwordx4 a[56:59], v29, s[28:31], s69 offen offset:0 sc1
    s_mov_b32 s69, 30720
    s_waitcnt vmcnt(10)
    v_mfma_f32_32x32x16_bf16 v[44:59], a[16:19], a[96:99], v[44:59]
    v_and_b32 v109, 0xffff0000, v248
    v_lshlrev_b32 v110, 16, v249
    v_and_b32 v111, 0xffff0000, v249
    v_mfma_f32_32x32x16_bf16 v[60:75], a[16:19], a[100:103], v[60:75]
    buffer_load_dwordx4 a[60:63], v29, s[28:31], s69 offen offset:0 sc1
    s_mov_b32 s69, 32768
    s_waitcnt vmcnt(10)
    v_mfma_f32_32x32x16_bf16 v[44:59], a[20:23], a[104:107], v[44:59]
    v_lshlrev_b32 v112, 16, v250
    v_and_b32 v113, 0xffff0000, v250
    v_lshlrev_b32_e64 v114, 16, v251
    v_mfma_f32_32x32x16_bf16 v[60:75], a[20:23], a[108:111], v[60:75]
    buffer_load_dwordx4 a[0:3], v29, s[28:31], s69 offen offset:0 sc1
    s_mov_b32 s69, 34816
    s_waitcnt vmcnt(10)
    v_mfma_f32_32x32x16_bf16 v[44:59], a[24:27], a[112:115], v[44:59]
    v_and_b32 v115, 0xffff0000, v251
    v_lshlrev_b32 v116, 16, v252
    v_and_b32 v117, 0xffff0000, v252
    v_mfma_f32_32x32x16_bf16 v[60:75], a[24:27], a[116:119], v[60:75]
    buffer_load_dwordx4 a[4:7], v29, s[28:31], s69 offen offset:0 sc1
    s_mov_b32 s69, 36864
    s_waitcnt vmcnt(10)
    v_mfma_f32_32x32x16_bf16 v[44:59], a[28:31], a[120:123], v[44:59]
    v_lshlrev_b32 v118, 16, v253
    v_and_b32 v119, 0xffff0000, v253
    v_lshlrev_b32_e64 v120, 16, v254
    v_mfma_f32_32x32x16_bf16 v[60:75], a[28:31], a[124:127], v[60:75]
    buffer_load_dwordx4 a[8:11], v29, s[28:31], s69 offen offset:0 sc1
    s_mov_b32 s69, 38912
    s_waitcnt vmcnt(10) lgkmcnt(15)
    v_mfma_f32_32x32x16_bf16 v[44:59], a[32:35], v[172:175], v[44:59]
    v_and_b32 v121, 0xffff0000, v254
    v_lshlrev_b32 v122, 16, v255
    v_and_b32 v123, 0xffff0000, v255
    v_mfma_f32_32x32x16_bf16 v[60:75], a[32:35], v[176:179], v[60:75]
    buffer_load_dwordx4 a[12:15], v29, s[28:31], s69 offen offset:0 sc1
    s_mov_b32 s69, 40960
    s_waitcnt vmcnt(10)
    v_mfma_f32_32x32x16_bf16 v[44:59], a[36:39], v[180:183], v[44:59]
    s_lshl_b32 s56, s54, 2
    s_lshr_b32 s57, s53, 1
    s_add_u32 s56, s56, s57
    v_mfma_f32_32x32x16_bf16 v[60:75], a[36:39], v[184:187], v[60:75]
    buffer_load_dwordx4 a[16:19], v29, s[28:31], s69 offen offset:0 sc1
    s_mov_b32 s69, 43008
    s_waitcnt vmcnt(10)
    v_mfma_f32_32x32x16_bf16 v[44:59], a[40:43], v[188:191], v[44:59]
    s_lshl_b32 s56, s56, 6
    s_add_u32 s56, s56, 0x638000
    v_mov_b32 v11, s56
    v_mfma_f32_32x32x16_bf16 v[60:75], a[40:43], v[192:195], v[60:75]
    buffer_load_dwordx4 a[20:23], v29, s[28:31], s69 offen offset:0 sc1
    s_mov_b32 s69, 45056
    s_waitcnt vmcnt(10)
    v_mfma_f32_32x32x16_bf16 v[44:59], a[44:47], v[196:199], v[44:59]
    v_mfma_f32_32x32x16_bf16 v[60:75], a[44:47], v[200:203], v[60:75]
    buffer_load_dwordx4 a[24:27], v29, s[28:31], s69 offen offset:0 sc1
    s_mov_b32 s69, 47104
    s_waitcnt vmcnt(10) lgkmcnt(14)
    v_mfma_f32_32x32x16_bf16 v[44:59], a[48:51], v[204:207], v[44:59]
    s_waitcnt lgkmcnt(12)
    v_mfma_f32_32x32x16_bf16 v[60:75], a[48:51], v[208:211], v[60:75]
    buffer_load_dwordx4 a[28:31], v29, s[28:31], s69 offen offset:0 sc1
    s_mov_b32 s69, 49152
    s_waitcnt vmcnt(10) lgkmcnt(10)
    v_mfma_f32_32x32x16_bf16 v[44:59], a[52:55], v[212:215], v[44:59]
    ds_read_b64_tr_b16 v[140:141], v30 offset:0
    ds_read_b64_tr_b16 v[142:143], v30 offset:1024
    ds_read_b64_tr_b16 v[144:145], v33 offset:0
    ds_read_b64_tr_b16 v[146:147], v33 offset:1024
    s_waitcnt lgkmcnt(12)
    v_mfma_f32_32x32x16_bf16 v[60:75], a[52:55], v[216:219], v[60:75]
    buffer_load_dwordx4 a[32:35], v29, s[28:31], s69 offen offset:0 sc1
    s_mov_b32 s69, 51200
    s_waitcnt vmcnt(10) lgkmcnt(10)
    v_mfma_f32_32x32x16_bf16 v[44:59], a[56:59], v[220:223], v[44:59]
    ds_read_b64_tr_b16 v[148:149], v30 offset:2048
    ds_read_b64_tr_b16 v[150:151], v30 offset:3072
    ds_read_b64_tr_b16 v[152:153], v33 offset:2048
    ds_read_b64_tr_b16 v[154:155], v33 offset:3072
    s_waitcnt lgkmcnt(12)
    v_mfma_f32_32x32x16_bf16 v[60:75], a[56:59], v[224:227], v[60:75]
    buffer_load_dwordx4 a[36:39], v29, s[28:31], s69 offen offset:0 sc1
    s_mov_b32 s69, 53248
    s_waitcnt vmcnt(10) lgkmcnt(10)
    v_mfma_f32_32x32x16_bf16 v[44:59], a[60:63], v[228:231], v[44:59]
    ds_read_b64_tr_b16 v[156:157], v30 offset:4096
    ds_read_b64_tr_b16 v[158:159], v30 offset:5120
    ds_read_b64_tr_b16 v[160:161], v33 offset:4096
    ds_read_b64_tr_b16 v[162:163], v33 offset:5120
    s_waitcnt lgkmcnt(12)
    v_mfma_f32_32x32x16_bf16 v[60:75], a[60:63], v[232:235], v[60:75]
    buffer_load_dwordx4 a[40:43], v29, s[28:31], s69 offen offset:0 sc1
    s_mov_b32 s69, 55296
    s_waitcnt vmcnt(10) lgkmcnt(10)
    v_mfma_f32_32x32x16_bf16 v[44:59], a[0:3], v[140:143], v[44:59]
    ds_read_b64_tr_b16 v[164:165], v30 offset:6144
    ds_read_b64_tr_b16 v[166:167], v30 offset:7168
    ds_read_b64_tr_b16 v[168:169], v33 offset:6144
    ds_read_b64_tr_b16 v[170:171], v33 offset:7168
    s_waitcnt lgkmcnt(12)
    v_mfma_f32_32x32x16_bf16 v[60:75], a[0:3], v[144:147], v[60:75]
    buffer_load_dwordx4 a[44:47], v29, s[28:31], s69 offen offset:0 sc1
    s_mov_b32 s69, 0
    s_waitcnt vmcnt(10) lgkmcnt(10)
    v_mfma_f32_32x32x16_bf16 v[44:59], a[4:7], v[148:151], v[44:59]
    ds_read_b64_tr_b16 v[140:141], v30 offset:32768
    ds_read_b64_tr_b16 v[142:143], v30 offset:33792
    ds_read_b64_tr_b16 v[144:145], v33 offset:32768
    ds_read_b64_tr_b16 v[146:147], v33 offset:33792
    s_waitcnt lgkmcnt(12)
    v_mfma_f32_32x32x16_bf16 v[60:75], a[4:7], v[152:155], v[60:75]
    buffer_load_dwordx4 a[48:51], v29, s[28:31], s69 offen offset:1024 sc1
    s_mov_b32 s69, 2048
    s_waitcnt vmcnt(10) lgkmcnt(10)
    v_mfma_f32_32x32x16_bf16 v[44:59], a[8:11], v[156:159], v[44:59]
    ds_read_b64_tr_b16 v[148:149], v30 offset:34816
    ds_read_b64_tr_b16 v[150:151], v30 offset:35840
    ds_read_b64_tr_b16 v[152:153], v33 offset:34816
    ds_read_b64_tr_b16 v[154:155], v33 offset:35840
    s_waitcnt lgkmcnt(12)
    v_mfma_f32_32x32x16_bf16 v[60:75], a[8:11], v[160:163], v[60:75]
    buffer_load_dwordx4 a[52:55], v29, s[28:31], s69 offen offset:1024 sc1
    s_mov_b32 s69, 4096
    s_waitcnt vmcnt(10) lgkmcnt(10)
    v_mfma_f32_32x32x16_bf16 v[44:59], a[12:15], v[164:167], v[44:59]
    ds_read_b64_tr_b16 v[156:157], v30 offset:36864
    ds_read_b64_tr_b16 v[158:159], v30 offset:37888
    ds_read_b64_tr_b16 v[160:161], v33 offset:36864
    ds_read_b64_tr_b16 v[162:163], v33 offset:37888
    s_waitcnt lgkmcnt(12)
    v_mfma_f32_32x32x16_bf16 v[60:75], a[12:15], v[168:171], v[60:75]
    buffer_load_dwordx4 a[56:59], v29, s[28:31], s69 offen offset:1024 sc1
    s_mov_b32 s69, 6144
    s_waitcnt vmcnt(10) lgkmcnt(10)
    v_mfma_f32_32x32x16_bf16 v[44:59], a[16:19], v[140:143], v[44:59]
    ds_read_b64_tr_b16 v[164:165], v30 offset:38912
    ds_read_b64_tr_b16 v[166:167], v30 offset:39936
    ds_read_b64_tr_b16 v[168:169], v33 offset:38912
    ds_read_b64_tr_b16 v[170:171], v33 offset:39936
    s_waitcnt lgkmcnt(12)
    v_mfma_f32_32x32x16_bf16 v[60:75], a[16:19], v[144:147], v[60:75]
    buffer_load_dwordx4 a[60:63], v29, s[28:31], s69 offen offset:1024 sc1
    s_mov_b32 s69, 8192
    s_waitcnt vmcnt(10) lgkmcnt(10)
    v_mfma_f32_32x32x16_bf16 v[44:59], a[20:23], v[148:151], v[44:59]
    ds_read_b64_tr_b16 v[140:141], v31 offset:0
    ds_read_b64_tr_b16 v[142:143], v31 offset:1024
    ds_read_b64_tr_b16 v[144:145], v34 offset:0
    ds_read_b64_tr_b16 v[146:147], v34 offset:1024
    s_waitcnt lgkmcnt(12)
    v_mfma_f32_32x32x16_bf16 v[60:75], a[20:23], v[152:155], v[60:75]
    buffer_load_dwordx4 a[0:3], v29, s[28:31], s69 offen offset:1024 sc1
    s_mov_b32 s69, 10240
    s_waitcnt vmcnt(10) lgkmcnt(10)
    v_mfma_f32_32x32x16_bf16 v[44:59], a[24:27], v[156:159], v[44:59]
    ds_read_b64_tr_b16 v[148:149], v31 offset:2048
    ds_read_b64_tr_b16 v[150:151], v31 offset:3072
    ds_read_b64_tr_b16 v[152:153], v34 offset:2048
    ds_read_b64_tr_b16 v[154:155], v34 offset:3072
    s_waitcnt lgkmcnt(12)
    v_mfma_f32_32x32x16_bf16 v[60:75], a[24:27], v[160:163], v[60:75]
    buffer_load_dwordx4 a[4:7], v29, s[28:31], s69 offen offset:1024 sc1
    s_mov_b32 s69, 12288
    s_waitcnt vmcnt(10) lgkmcnt(10)
    v_mfma_f32_32x32x16_bf16 v[44:59], a[28:31], v[164:167], v[44:59]
    ds_read_b64_tr_b16 v[156:157], v31 offset:4096
    ds_read_b64_tr_b16 v[158:159], v31 offset:5120
    ds_read_b64_tr_b16 v[160:161], v34 offset:4096
    ds_read_b64_tr_b16 v[162:163], v34 offset:5120
    s_waitcnt lgkmcnt(12)
    v_mfma_f32_32x32x16_bf16 v[60:75], a[28:31], v[168:171], v[60:75]
    buffer_load_dwordx4 a[8:11], v29, s[28:31], s69 offen offset:1024 sc1
    s_mov_b32 s69, 14336
    s_waitcnt vmcnt(10) lgkmcnt(10)
    v_mfma_f32_32x32x16_bf16 v[44:59], a[32:35], v[140:143], v[44:59]
    ds_read_b64_tr_b16 v[164:165], v31 offset:6144
    ds_read_b64_tr_b16 v[166:167], v31 offset:7168
    ds_read_b64_tr_b16 v[168:169], v34 offset:6144
    ds_read_b64_tr_b16 v[170:171], v34 offset:7168
    s_waitcnt lgkmcnt(12)
    v_mfma_f32_32x32x16_bf16 v[60:75], a[32:35], v[144:147], v[60:75]
    buffer_load_dwordx4 a[12:15], v29, s[28:31], s69 offen offset:1024 sc1
    s_mov_b32 s69, 16384
    s_waitcnt vmcnt(10) lgkmcnt(10)
    v_mfma_f32_32x32x16_bf16 v[44:59], a[36:39], v[148:151], v[44:59]
    s_waitcnt lgkmcnt(8)
    v_mfma_f32_32x32x16_bf16 v[60:75], a[36:39], v[152:155], v[60:75]
    buffer_load_dwordx4 a[16:19], v29, s[28:31], s69 offen offset:1024 sc1
    s_mov_b32 s69, 18432
    s_waitcnt vmcnt(10) lgkmcnt(6)
    v_mfma_f32_32x32x16_bf16 v[44:59], a[40:43], v[156:159], v[44:59]
    s_waitcnt lgkmcnt(4)
    v_mfma_f32_32x32x16_bf16 v[60:75], a[40:43], v[160:163], v[60:75]
    buffer_load_dwordx4 a[20:23], v29, s[28:31], s69 offen offset:1024 sc1
    s_mov_b32 s69, 20480
    s_waitcnt vmcnt(10) lgkmcnt(2)
    v_mfma_f32_32x32x16_bf16 v[44:59], a[44:47], v[164:167], v[44:59]
    s_waitcnt lgkmcnt(0)
    v_mfma_f32_32x32x16_bf16 v[60:75], a[44:47], v[168:171], v[60:75]
    buffer_load_dwordx4 a[24:27], v29, s[28:31], s69 offen offset:1024 sc1
    s_mov_b32 s69, 22528
    s_waitcnt vmcnt(10)
    v_mfma_f32_32x32x16_bf16 v[76:91], a[48:51], a[64:67], 0
    v_mfma_f32_32x32x16_bf16 v[92:107], a[48:51], a[68:71], 0
    buffer_load_dwordx4 a[28:31], v29, s[28:31], s69 offen offset:1024 sc1
    s_mov_b32 s69, 24576
    s_waitcnt vmcnt(10)
    v_mfma_f32_32x32x16_bf16 v[76:91], a[52:55], a[72:75], v[76:91]
    s_nop 0
    ds_write_b128 v14, v[44:47] offset:0
    v_mfma_f32_32x32x16_bf16 v[92:107], a[52:55], a[76:79], v[92:107]
    buffer_load_dwordx4 a[32:35], v29, s[28:31], s69 offen offset:1024 sc1
    s_mov_b32 s69, 26624
    s_waitcnt vmcnt(10)
    v_mfma_f32_32x32x16_bf16 v[76:91], a[56:59], a[80:83], v[76:91]
    ds_write_b128 v15, v[48:51] offset:0
    v_mfma_f32_32x32x16_bf16 v[92:107], a[56:59], a[84:87], v[92:107]
    buffer_load_dwordx4 a[36:39], v29, s[28:31], s69 offen offset:1024 sc1
    s_mov_b32 s69, 28672
    s_waitcnt vmcnt(10)
    v_mfma_f32_32x32x16_bf16 v[76:91], a[60:63], a[88:91], v[76:91]
    ds_write_b128 v16, v[52:55] offset:0
    v_mfma_f32_32x32x16_bf16 v[92:107], a[60:63], a[92:95], v[92:107]
    buffer_load_dwordx4 a[40:43], v29, s[28:31], s69 offen offset:1024 sc1
    s_mov_b32 s69, 30720
    s_waitcnt vmcnt(10)
    v_mfma_f32_32x32x16_bf16 v[76:91], a[0:3], a[96:99], v[76:91]
    ds_write_b128 v17, v[56:59] offset:0
    v_mfma_f32_32x32x16_bf16 v[92:107], a[0:3], a[100:103], v[92:107]
    buffer_load_dwordx4 a[44:47], v29, s[28:31], s69 offen offset:1024 sc1
    s_mov_b32 s69, 32768
    s_waitcnt vmcnt(10)
    v_mfma_f32_32x32x16_bf16 v[76:91], a[4:7], a[104:107], v[76:91]
    ds_write_b128 v14, v[60:63] offset:4096
    v_mfma_f32_32x32x16_bf16 v[92:107], a[4:7], a[108:111], v[92:107]
    buffer_load_dwordx4 a[48:51], v29, s[28:31], s69 offen offset:1024 sc1
    s_mov_b32 s69, 34816
    s_waitcnt vmcnt(10)
    v_mfma_f32_32x32x16_bf16 v[76:91], a[8:11], a[112:115], v[76:91]
    ds_write_b128 v15, v[64:67] offset:4096
    v_mfma_f32_32x32x16_bf16 v[92:107], a[8:11], a[116:119], v[92:107]
    buffer_load_dwordx4 a[52:55], v29, s[28:31], s69 offen offset:1024 sc1
    s_mov_b32 s69, 36864
    s_waitcnt vmcnt(10)
    v_mfma_f32_32x32x16_bf16 v[76:91], a[12:15], a[120:123], v[76:91]
    ds_write_b128 v16, v[68:71] offset:4096
    v_mfma_f32_32x32x16_bf16 v[92:107], a[12:15], a[124:127], v[92:107]
    buffer_load_dwordx4 a[56:59], v29, s[28:31], s69 offen offset:1024 sc1
    s_mov_b32 s69, 38912
    s_waitcnt vmcnt(10)
    v_mfma_f32_32x32x16_bf16 v[76:91], a[16:19], v[172:175], v[76:91]
    ds_write_b128 v17, v[72:75] offset:4096
    v_mfma_f32_32x32x16_bf16 v[92:107], a[16:19], v[176:179], v[92:107]
    buffer_load_dwordx4 a[60:63], v29, s[28:31], s69 offen offset:1024 sc1
    s_mov_b32 s69, 40960
    buffer_load_dword v10, v11, s[28:31], 0 offen sc1
    s_waitcnt vmcnt(11)
    v_mfma_f32_32x32x16_bf16 v[76:91], a[20:23], v[180:183], v[76:91]
    s_waitcnt lgkmcnt(0)
    s_barrier
    ds_read_b128 v[44:47], v18 offset:0
    ds_read_b128 v[48:51], v26 offset:0
    ds_read_b128 v[52:55], v18 offset:8192
    v_mfma_f32_32x32x16_bf16 v[92:107], a[20:23], v[184:187], v[92:107]
    buffer_load_dwordx4 a[0:3], v29, s[28:31], s69 offen offset:1024 sc1
    s_mov_b32 s69, 43008
    s_waitcnt vmcnt(11)
    v_mfma_f32_32x32x16_bf16 v[76:91], a[24:27], v[188:191], v[76:91]
    ds_read_b128 v[56:59], v26 offset:8192
    ds_read_b128 v[60:63], v18 offset:16384
    ds_read_b128 v[64:67], v26 offset:16384
    ds_read_b128 v[68:71], v18 offset:24576
    v_mfma_f32_32x32x16_bf16 v[92:107], a[24:27], v[192:195], v[92:107]
    buffer_load_dwordx4 a[4:7], v29, s[28:31], s69 offen offset:1024 sc1
    s_mov_b32 s69, 45056
    s_waitcnt vmcnt(11)
    v_mfma_f32_32x32x16_bf16 v[76:91], a[28:31], v[196:199], v[76:91]
    ds_read_b128 v[72:75], v26 offset:24576
    s_waitcnt lgkmcnt(5)
    v_add_f32 v44, v44, v52
    v_add_f32 v45, v45, v53
    s_waitcnt lgkmcnt(1)
    v_add_f32_e64 v60, v60, v68
    v_mfma_f32_32x32x16_bf16 v[92:107], a[28:31], v[200:203], v[92:107]
    buffer_load_dwordx4 a[8:11], v29, s[28:31], s69 offen offset:1024 sc1
    s_mov_b32 s69, 47104
    s_waitcnt vmcnt(11)
    v_mfma_f32_32x32x16_bf16 v[76:91], a[32:35], v[204:207], v[76:91]
    v_add_f32 v61, v61, v69
    v_add_f32 v46, v46, v54
    v_add_f32 v47, v47, v55
    v_add_f32 v62, v62, v70
    v_mfma_f32_32x32x16_bf16 v[92:107], a[32:35], v[208:211], v[92:107]
    buffer_load_dwordx4 a[12:15], v29, s[28:31], s69 offen offset:1024 sc1
    s_mov_b32 s69, 49152
    s_waitcnt vmcnt(11)
    v_mfma_f32_32x32x16_bf16 v[76:91], a[36:39], v[212:215], v[76:91]
    ds_read_b64_tr_b16 v[140:141], v30 offset:0
    ds_read_b64_tr_b16 v[142:143], v30 offset:1024
    ds_read_b64_tr_b16 v[144:145], v33 offset:0
    ds_read_b64_tr_b16 v[146:147], v33 offset:1024
    v_mfma_f32_32x32x16_bf16 v[92:107], a[36:39], v[216:219], v[92:107]
    buffer_load_dwordx4 a[16:19], v29, s[28:31], s69 offen offset:1024 sc1
    s_mov_b32 s69, 51200
    v_add_f32 v63, v63, v71
    v_add_f32 v48, v48, v56
    v_add_f32 v49, v49, v57
    s_waitcnt lgkmcnt(4)
    v_add_f32 v64, v64, v72
    s_waitcnt vmcnt(11)
    v_mfma_f32_32x32x16_bf16 v[76:91], a[40:43], v[220:223], v[76:91]
    ds_read_b64_tr_b16 v[148:149], v30 offset:2048
    ds_read_b64_tr_b16 v[150:151], v30 offset:3072
    ds_read_b64_tr_b16 v[152:153], v33 offset:2048
    ds_read_b64_tr_b16 v[154:155], v33 offset:3072
    v_mfma_f32_32x32x16_bf16 v[92:107], a[40:43], v[224:227], v[92:107]
    buffer_load_dwordx4 a[20:23], v29, s[28:31], s69 offen offset:1024 sc1
    s_mov_b32 s69, 53248
    v_add_f32 v65, v65, v73
    v_add_f32 v50, v50, v58
    v_add_f32_e64 v51, v51, v59
    v_add_f32 v66, v66, v74
    s_waitcnt vmcnt(11)
    v_mfma_f32_32x32x16_bf16 v[76:91], a[44:47], v[228:231], v[76:91]
    ds_read_b64_tr_b16 v[156:157], v30 offset:4096
    ds_read_b64_tr_b16 v[158:159], v30 offset:5120
    ds_read_b64_tr_b16 v[160:161], v33 offset:4096
    ds_read_b64_tr_b16 v[162:163], v33 offset:5120
    v_mfma_f32_32x32x16_bf16 v[92:107], a[44:47], v[232:235], v[92:107]
    buffer_load_dwordx4 a[24:27], v29, s[28:31], s69 offen offset:1024 sc1
    s_mov_b32 s69, 55296
    v_add_f32 v67, v67, v75
    v_add_f32 v124, v44, v60
    v_add_f32_e64 v125, v45, v61
    v_add_f32 v126, v46, v62
    s_waitcnt vmcnt(11) lgkmcnt(10)
    v_mfma_f32_32x32x16_bf16 v[76:91], a[48:51], v[140:143], v[76:91]
    ds_read_b64_tr_b16 v[164:165], v30 offset:6144
    ds_read_b64_tr_b16 v[166:167], v30 offset:7168
    ds_read_b64_tr_b16 v[168:169], v33 offset:6144
    ds_read_b64_tr_b16 v[170:171], v33 offset:7168
    s_waitcnt lgkmcnt(12)
    v_mfma_f32_32x32x16_bf16 v[92:107], a[48:51], v[144:147], v[92:107]
    buffer_load_dwordx4 a[28:31], v29, s[28:31], s69 offen offset:1024 sc1
    s_mov_b32 s69, 0
    v_add_f32 v127, v47, v63
    v_add_f32 v128, v48, v64
    v_add_f32_e64 v129, v49, v65
    v_add_f32 v130, v50, v66
    s_waitcnt vmcnt(11) lgkmcnt(10)
    v_mfma_f32_32x32x16_bf16 v[76:91], a[52:55], v[148:151], v[76:91]
    ds_read_b64_tr_b16 v[140:141], v30 offset:32768
    ds_read_b64_tr_b16 v[142:143], v30 offset:33792
    ds_read_b64_tr_b16 v[144:145], v33 offset:32768
    ds_read_b64_tr_b16 v[146:147], v33 offset:33792
    s_waitcnt lgkmcnt(12)
    v_mfma_f32_32x32x16_bf16 v[92:107], a[52:55], v[152:155], v[92:107]
    v_add_f32 v131, v51, v67
    v_add_f32 v124, v124, v38
    v_add_f32 v125, v125, v38
    v_add_f32 v126, v126, v38
    s_waitcnt vmcnt(10) lgkmcnt(10)
    v_mfma_f32_32x32x16_bf16 v[76:91], a[56:59], v[156:159], v[76:91]
    ds_read_b64_tr_b16 v[148:149], v30 offset:34816
    ds_read_b64_tr_b16 v[150:151], v30 offset:35840
    ds_read_b64_tr_b16 v[152:153], v33 offset:34816
    ds_read_b64_tr_b16 v[154:155], v33 offset:35840
    s_waitcnt lgkmcnt(12)
    v_mfma_f32_32x32x16_bf16 v[92:107], a[56:59], v[160:163], v[92:107]
    v_add_f32 v127, v127, v38
    v_add_f32 v128, v128, v38
    v_add_f32 v129, v129, v38
    v_add_f32 v130, v130, v38
    s_waitcnt vmcnt(8)
    v_cmp_ne_u32 vcc, 1, v10
    s_nop 0
    s_cbranch_vccnz L_slow_f4m
L_ok_f4m:
    buffer_load_dwordx4 v[240:243], v23, s[28:31], 0 offen sc1
    buffer_load_dwordx4 v[244:247], v28, s[28:31], 0 offen sc1
    s_waitcnt lgkmcnt(10)
    v_mfma_f32_32x32x16_bf16 v[76:91], a[60:63], v[164:167], v[76:91]
    ds_read_b64_tr_b16 v[156:157], v30 offset:36864
    ds_read_b64_tr_b16 v[158:159], v30 offset:37888
    ds_read_b64_tr_b16 v[160:161], v33 offset:36864
    ds_read_b64_tr_b16 v[162:163], v33 offset:37888
    s_waitcnt lgkmcnt(12)
    v_mfma_f32_32x32x16_bf16 v[92:107], a[60:63], v[168:171], v[92:107]
    v_add_f32 v131, v131, v38
    v_mul_f32 v44, v124, v40
    v_mul_f32 v45, v125, v40
    v_mul_f32 v46, v126, v40
    s_waitcnt vmcnt(9) lgkmcnt(10)
    v_mfma_f32_32x32x16_bf16 v[76:91], a[0:3], v[140:143], v[76:91]
    ds_read_b64_tr_b16 v[164:165], v30 offset:38912
    ds_read_b64_tr_b16 v[166:167], v30 offset:39936
    ds_read_b64_tr_b16 v[168:169], v33 offset:38912
    ds_read_b64_tr_b16 v[170:171], v33 offset:39936
    s_waitcnt lgkmcnt(12)
    v_mfma_f32_32x32x16_bf16 v[92:107], a[0:3], v[144:147], v[92:107]
    v_mul_f32 v47, v127, v40
    v_mul_f32 v48, v128, v40
    v_mul_f32 v49, v129, v40
    v_mul_f32 v50, v130, v40
    s_waitcnt vmcnt(8) lgkmcnt(10)
    v_mfma_f32_32x32x16_bf16 v[76:91], a[4:7], v[148:151], v[76:91]
    ds_read_b64_tr_b16 v[140:141], v31 offset:0
    ds_read_b64_tr_b16 v[142:143], v31 offset:1024
    ds_read_b64_tr_b16 v[144:145], v34 offset:0
    ds_read_b64_tr_b16 v[146:147], v34 offset:1024
    s_waitcnt lgkmcnt(12)
    v_mfma_f32_32x32x16_bf16 v[92:107], a[4:7], v[152:155], v[92:107]
    v_mul_f32 v51, v131, v40
    v_exp_f32_e64 v44, v44
    v_exp_f32 v45, v45
    s_waitcnt vmcnt(7) lgkmcnt(10)
    v_mfma_f32_32x32x16_bf16 v[76:91], a[8:11], v[156:159], v[76:91]
    ds_read_b64_tr_b16 v[148:149], v31 offset:2048
    ds_read_b64_tr_b16 v[150:151], v31 offset:3072
    ds_read_b64_tr_b16 v[152:153], v34 offset:2048
    ds_read_b64_tr_b16 v[154:155], v34 offset:3072
    s_waitcnt lgkmcnt(12)
    v_mfma_f32_32x32x16_bf16 v[92:107], a[8:11], v[160:163], v[92:107]
    v_exp_f32 v46, v46
    v_exp_f32 v47, v47
    s_waitcnt vmcnt(6) lgkmcnt(10)
    v_mfma_f32_32x32x16_bf16 v[76:91], a[12:15], v[164:167], v[76:91]
    ds_read_b64_tr_b16 v[156:157], v31 offset:4096
    ds_read_b64_tr_b16 v[158:159], v31 offset:5120
    ds_read_b64_tr_b16 v[160:161], v34 offset:4096
    ds_read_b64_tr_b16 v[162:163], v34 offset:5120
    s_waitcnt lgkmcnt(12)
    v_mfma_f32_32x32x16_bf16 v[92:107], a[12:15], v[168:171], v[92:107]
    v_exp_f32 v48, v48
    v_exp_f32 v49, v49
    s_waitcnt vmcnt(5) lgkmcnt(10)
    v_mfma_f32_32x32x16_bf16 v[76:91], a[16:19], v[140:143], v[76:91]
    ds_read_b64_tr_b16 v[164:165], v31 offset:6144
    ds_read_b64_tr_b16 v[166:167], v31 offset:7168
    ds_read_b64_tr_b16 v[168:169], v34 offset:6144
    ds_read_b64_tr_b16 v[170:171], v34 offset:7168
    s_waitcnt lgkmcnt(12)
    v_mfma_f32_32x32x16_bf16 v[92:107], a[16:19], v[144:147], v[92:107]
    v_exp_f32 v50, v50
    v_exp_f32 v51, v51
    s_waitcnt vmcnt(4) lgkmcnt(10)
    v_mfma_f32_32x32x16_bf16 v[76:91], a[20:23], v[148:151], v[76:91]
    v_add_f32 v44, v44, v42
    v_add_f32 v45, v45, v42
    v_add_f32_e64 v46, v46, v42
    v_add_f32 v47, v47, v42
    s_waitcnt lgkmcnt(8)
    v_mfma_f32_32x32x16_bf16 v[92:107], a[20:23], v[152:155], v[92:107]
    v_add_f32 v48, v48, v42
    v_add_f32 v49, v49, v42
    v_add_f32_e64 v50, v50, v42
    v_add_f32 v51, v51, v42
    s_waitcnt vmcnt(3) lgkmcnt(6)
    v_mfma_f32_32x32x16_bf16 v[76:91], a[24:27], v[156:159], v[76:91]
    v_rcp_f32_e64 v44, v44
    v_rcp_f32 v45, v45
    s_waitcnt lgkmcnt(4)
    v_mfma_f32_32x32x16_bf16 v[92:107], a[24:27], v[160:163], v[92:107]
    v_rcp_f32_e64 v46, v46
    v_rcp_f32 v47, v47
    s_waitcnt vmcnt(2) lgkmcnt(2)
    v_mfma_f32_32x32x16_bf16 v[76:91], a[28:31], v[164:167], v[76:91]
    v_rcp_f32_e64 v48, v48
    v_rcp_f32 v49, v49
    s_waitcnt lgkmcnt(0)
    v_mfma_f32_32x32x16_bf16 v[92:107], a[28:31], v[168:171], v[92:107]
    v_rcp_f32 v50, v50
    v_rcp_f32 v51, v51
    v_mul_f32 v124, v124, v44
    v_mul_f32 v125, v125, v45
    v_mul_f32 v126, v126, v46
    v_mul_f32 v127, v127, v47
    v_mul_f32 v128, v128, v48
    s_nop 0
    ds_write_b128 v14, v[76:79] offset:32768
    v_mul_f32 v129, v129, v49
    v_mul_f32 v130, v130, v50
    v_mul_f32 v131, v131, v51
    s_waitcnt vmcnt(1)
    v_lshlrev_b32_e64 v140, 16, v240
    v_and_b32 v141, 0xffff0000, v240
    ds_write_b128 v15, v[80:83] offset:32768
    v_lshlrev_b32_e64 v142, 16, v241
    v_and_b32 v143, 0xffff0000, v241
    v_lshlrev_b32_e64 v144, 16, v242
    v_and_b32 v145, 0xffff0000, v242
    v_lshlrev_b32_e64 v146, 16, v243
    ds_write_b128 v16, v[84:87] offset:32768
    v_and_b32 v147, 0xffff0000, v243
    s_waitcnt vmcnt(0)
    v_lshlrev_b32 v148, 16, v244
    v_and_b32 v149, 0xffff0000, v244
    v_lshlrev_b32_e64 v150, 16, v245
    v_and_b32 v151, 0xffff0000, v245
    ds_write_b128 v17, v[88:91] offset:32768
    v_lshlrev_b32_e64 v152, 16, v246
    v_and_b32 v153, 0xffff0000, v246
    v_lshlrev_b32_e64 v154, 16, v247
    v_and_b32 v155, 0xffff0000, v247
    v_pk_fma_f32 v[124:125], v[124:125], v[140:141], v[108:109]
    ds_write_b128 v14, v[92:95] offset:36864
    v_pk_fma_f32 v[126:127], v[126:127], v[142:143], v[110:111]
    v_pk_fma_f32 v[128:129], v[128:129], v[144:145], v[112:113]
    v_pk_fma_f32 v[130:131], v[130:131], v[146:147], v[114:115]
    v_cvt_pk_bf16_f32 v248, v124, v125
    v_cvt_pk_bf16_f32 v249, v126, v127
    ds_write_b128 v15, v[96:99] offset:36864
    v_cvt_pk_bf16_f32 v250, v128, v129
    v_cvt_pk_bf16_f32 v251, v130, v131
    buffer_store_dwordx4 v[248:251], v6, s[32:35], 0 offen offset:0
    ds_write_b128 v16, v[100:103] offset:36864
    ds_write_b128 v17, v[104:107] offset:36864
    s_waitcnt lgkmcnt(0)
    s_barrier
    ds_read_b128 v[172:175], v18 offset:32768
    ds_read_b128 v[176:179], v26 offset:32768
    ds_read_b128 v[180:183], v18 offset:40960
    ds_read_b128 v[184:187], v26 offset:40960
    ds_read_b128 v[188:191], v18 offset:49152
    ds_read_b128 v[192:195], v26 offset:49152
    ds_read_b128 v[196:199], v18 offset:57344
    ds_read_b128 v[200:203], v26 offset:57344
    s_waitcnt lgkmcnt(5)
    v_pk_add_f32 v[172:173], v[172:173], v[180:181]
    s_waitcnt lgkmcnt(1)
    v_pk_add_f32 v[188:189], v[188:189], v[196:197]
    v_pk_add_f32 v[174:175], v[174:175], v[182:183]
    v_pk_add_f32 v[190:191], v[190:191], v[198:199]
    v_pk_add_f32 v[176:177], v[176:177], v[184:185]
    s_waitcnt lgkmcnt(0)
    v_pk_add_f32 v[192:193], v[192:193], v[200:201]
    v_pk_add_f32 v[178:179], v[178:179], v[186:187]
    v_pk_add_f32 v[194:195], v[194:195], v[202:203]
    v_pk_add_f32 v[132:133], v[172:173], v[188:189]
    v_pk_add_f32 v[134:135], v[174:175], v[190:191]
    v_pk_add_f32 v[136:137], v[176:177], v[192:193]
    v_pk_add_f32 v[138:139], v[178:179], v[194:195]
    v_pk_add_f32 v[132:133], v[132:133], v[38:39] op_sel:[0,0] op_sel_hi:[1,0]
    v_pk_add_f32 v[134:135], v[134:135], v[38:39] op_sel:[0,0] op_sel_hi:[1,0]
    v_pk_add_f32 v[136:137], v[136:137], v[38:39] op_sel:[0,0] op_sel_hi:[1,0]
    v_pk_add_f32 v[138:139], v[138:139], v[38:39] op_sel:[0,0] op_sel_hi:[1,0]
    v_pk_mul_f32 v[172:173], v[132:133], v[40:41] op_sel:[0,0] op_sel_hi:[1,0]
    v_pk_mul_f32 v[174:175], v[134:135], v[40:41] op_sel:[0,0] op_sel_hi:[1,0]
    v_pk_mul_f32 v[176:177], v[136:137], v[40:41] op_sel:[0,0] op_sel_hi:[1,0]
    v_pk_mul_f32 v[178:179], v[138:139], v[40:41] op_sel:[0,0] op_sel_hi:[1,0]
    v_exp_f32 v172, v172
    v_exp_f32 v173, v173
    v_exp_f32 v174, v174
    v_exp_f32 v175, v175
    v_exp_f32 v176, v176
    v_exp_f32 v177, v177
    v_exp_f32 v178, v178
    v_exp_f32_e64 v179, v179
    v_pk_add_f32 v[172:173], v[172:173], v[42:43] op_sel:[0,0] op_sel_hi:[1,0]
    v_pk_add_f32 v[174:175], v[174:175], v[42:43] op_sel:[0,0] op_sel_hi:[1,0]
    v_pk_add_f32 v[176:177], v[176:177], v[42:43] op_sel:[0,0] op_sel_hi:[1,0]
    v_pk_add_f32 v[178:179], v[178:179], v[42:43] op_sel:[0,0] op_sel_hi:[1,0]
    v_rcp_f32 v172, v172
    v_rcp_f32 v173, v173
    v_rcp_f32 v174, v174
    v_rcp_f32 v175, v175
    v_rcp_f32 v176, v176
    v_rcp_f32 v177, v177
    v_rcp_f32 v178, v178
    v_rcp_f32 v179, v179
    v_pk_mul_f32 v[132:133], v[132:133], v[172:173]
    v_pk_mul_f32 v[134:135], v[134:135], v[174:175]
    v_pk_mul_f32 v[136:137], v[136:137], v[176:177]
    v_pk_mul_f32 v[138:139], v[138:139], v[178:179]
    v_pk_fma_f32 v[132:133], v[132:133], v[148:149], v[116:117]
    v_pk_fma_f32 v[134:135], v[134:135], v[150:151], v[118:119]
    v_pk_fma_f32 v[136:137], v[136:137], v[152:153], v[120:121]
    v_pk_fma_f32 v[138:139], v[138:139], v[154:155], v[122:123]
    v_cvt_pk_bf16_f32 v252, v132, v133
    v_cvt_pk_bf16_f32 v253, v134, v135
    v_cvt_pk_bf16_f32 v254, v136, v137
    v_cvt_pk_bf16_f32 v255, v138, v139
    buffer_store_dwordx4 v[252:255], v6, s[32:35], 0 offen offset:64
L_dump:
L_end:
    s_endpgm
    s_nop 0
L_roleA:
    s_bfe_u32 s61, s67, 0x30004
    s_mul_i32 s63, s61, 196608
    s_lshl_b32 s62, s61, 7
    s_add_u32 m0, s65, 0xa000
    s_nop 0
    buffer_load_dwordx4 v30, s[12:15], s63 offen offset:0 lds
    buffer_load_dwordx4 v18, s[12:15], s63 offen offset:1024 lds
    buffer_load_dwordx4 v18, s[12:15], s63 offen offset:2048 lds
    s_and_b32 s56, s48, 1
    s_lshr_b32 s57, s48, 1
    v_bfe_u32 v4, v1, 1, 3
    v_xor_b32 v4, v4, v3
    v_lshlrev_b32 v4, 4, v4
    v_lshl_add_u32 v4, v2, 7, v4
    s_mul_i32 s58, s56, 8224
    v_xor_b32 v20, s58, v4
    v_xor_b32 v21, 32, v20
    v_xor_b32_e64 v22, 64, v20
    v_xor_b32 v23, 96, v20
    v_bfe_u32 v4, v1, 2, 2
    v_lshlrev_b32_e64 v4, 7, v4
    v_mul_u32_u24 v5, 3072, v3
    v_add_u32_e64 v4, v4, v5
    v_bfe_u32 v5, v1, 4, 1
    v_lshl_add_u32 v4, v5, 5, v4
    v_and_b32_e64 v5, 3, v1
    v_lshl_add_u32 v4, v5, 3, v4
    v_bfe_u32 v5, v1, 3, 1
    v_xor_b32_e64 v5, s57, v5
    v_lshl_add_u32 v4, v5, 6, v4
    s_mul_i32 s58, s56, 6144
    s_add_u32 s59, s58, 16384
    v_add_u32_e64 v24, s59, v4
    s_sub_u32 s59, 16384, s58
    v_add_u32 v25, s59, v4
    v_lshrrev_b32 v4, 2, v1
    v_xor_b32 v4, v4, v1
    v_and_b32 v4, 4, v4
    v_cmp_eq_u32_e64 vcc, 0, v4
    v_mov_b32 v5, 0x3f803f80
    s_nop 0
    v_cndmask_b32 v152, 0, v5, vcc
    v_mov_b32 v153, v152
    v_mov_b32 v154, v152
    v_mov_b32 v155, v152
    s_lshr_b32 s57, s2, 3
    s_mul_i32 s57, s57, 57344
    s_mul_i32 s56, s48, 1835008
    s_add_u32 s56, s56, s57
    s_and_b32 s57, s54, 28
    s_lshl_b32 s57, s57, 7
    s_add_u32 s56, s56, s57
    v_lshrrev_b32 v4, 2, v1
    v_min_u32 v4, 13, v4
    v_lshl_add_u32 v4, v4, 12, s56
    v_and_b32_e64 v5, 3, v1
    v_lshl_add_u32 v26, v5, 7, v4
    s_lshr_b32 s56, s2, 3
    s_lshl_b32 s56, s56, 2
    s_add_u32 s56, s56, s48
    s_lshl_b32 s56, s56, 12
    v_lshl_add_u32 v27, v2, 7, s56
    s_lshr_b32 s56, s48, 1
    s_lshl_b32 s56, s56, 14
    s_lshl_b32 s57, s3, 1
    s_and_b32 s58, s48, 1
    s_add_u32 s57, s57, s58
    s_lshl_b32 s57, s57, 7
    s_add_u32 s56, s56, s57
    v_lshrrev_b32 v4, 3, v1
    v_mul_u32_u24 v4, 1024, v4
    v_add3_u32 v28, v4, v13, s56
    v_add_u32 v29, 0x1c00, v28
    s_add_u32 m0, s71, 0xa000
    s_nop 0
    buffer_load_dwordx4 v14, s[8:11], s62 offen offset:0 lds
    buffer_load_dwordx4 v15, s[8:11], s62 offen offset:1024 lds
    s_add_u32 m0, s65, 0xac00
    s_nop 0
    buffer_load_dwordx4 v31, s[12:15], s63 offen offset:0 lds
    buffer_load_dwordx4 v19, s[12:15], s63 offen offset:1024 lds
    buffer_load_dwordx4 v19, s[12:15], s63 offen offset:2048 lds
    s_waitcnt vmcnt(11)
    s_barrier
    ds_read_b64_tr_b16 a[8:9], v24 offset:0
    ds_read_b64_tr_b16 a[10:11], v24 offset:512
    ds_read_b128 a[0:3], v20 offset:0
    ds_read_b128 a[4:7], v20 offset:4096
    ds_read_b64_tr_b16 a[12:13], v24 offset:1024
    ds_read_b64_tr_b16 a[14:15], v24 offset:1536
    ds_read_b64_tr_b16 a[16:17], v24 offset:2048
    ds_read_b64_tr_b16 a[18:19], v24 offset:2560
    s_waitcnt lgkmcnt(5)
    v_mfma_f32_32x32x16_bf16 v[44:59], a[8:11], a[0:3], 0
    ds_read_b64_tr_b16 a[28:29], v25 offset:6144
    ds_read_b64_tr_b16 a[30:31], v25 offset:6656
    ds_read_b128 a[20:23], v21 offset:0
    s_waitcnt lgkmcnt(7)
    v_mfma_f32_32x32x16_bf16 v[60:75], a[8:11], a[4:7], 0
    s_add_u32 m0, s71, 0xa000
    s_nop 0
    buffer_load_dwordx4 v16, s[8:11], s62 offen offset:2048 lds
    s_waitcnt lgkmcnt(5)
    v_mfma_f32_32x32x16_bf16 v[76:91], a[0:3], a[12:15], 0
    ds_read_b128 a[24:27], v21 offset:4096
    ds_read_b64_tr_b16 a[32:33], v25 offset:7168
    ds_read_b64_tr_b16 a[34:35], v25 offset:7680
    v_mfma_f32_32x32x16_bf16 v[92:107], a[4:7], a[12:15], 0
    buffer_load_dwordx4 v17, s[8:11], s62 offen offset:3072 lds
    s_waitcnt lgkmcnt(6)
    v_mfma_f32_32x32x16_bf16 v[108:123], a[0:3], a[16:19], 0
    ds_read_b64_tr_b16 a[36:37], v25 offset:8192
    ds_read_b64_tr_b16 a[38:39], v25 offset:8704
    v_mfma_f32_32x32x16_bf16 v[124:139], a[4:7], a[16:19], 0
    buffer_load_dword v10, v11, s[36:39], 0 offen sc1
    v_mfma_f32_16x16x32_bf16 v[140:143], v[152:155], a[8:11], 0
    s_bfe_u32 s61, s67, 0x30008
    s_mul_i32 s63, s61, 196608
    s_lshl_b32 s62, s61, 7
    s_add_u32 m0, s65, 0x14000
    s_nop 0
    buffer_load_dwordx4 v30, s[12:15], s63 offen offset:0 lds
    v_mfma_f32_16x16x32_bf16 v[144:147], v[152:155], a[12:15], 0
    v_mfma_f32_16x16x32_bf16 v[148:151], v[152:155], a[16:19], 0
    s_waitcnt lgkmcnt(5)
    v_mfma_f32_32x32x16_bf16 v[44:59], a[28:31], a[20:23], v[44:59]
    ds_read_b64_tr_b16 a[8:9], v24 offset:12288
    ds_read_b64_tr_b16 a[10:11], v24 offset:12800
    ds_read_b128 a[0:3], v22 offset:0
    s_waitcnt lgkmcnt(7)
    v_mfma_f32_32x32x16_bf16 v[60:75], a[28:31], a[24:27], v[60:75]
    buffer_load_dwordx4 v18, s[12:15], s63 offen offset:1024 lds
    s_waitcnt lgkmcnt(5)
    v_mfma_f32_32x32x16_bf16 v[76:91], a[20:23], a[32:35], v[76:91]
    ds_read_b128 a[4:7], v22 offset:4096
    ds_read_b64_tr_b16 a[12:13], v24 offset:13312
    ds_read_b64_tr_b16 a[14:15], v24 offset:13824
    v_mfma_f32_32x32x16_bf16 v[92:107], a[24:27], a[32:35], v[92:107]
    buffer_load_dwordx4 v18, s[12:15], s63 offen offset:2048 lds
    s_waitcnt lgkmcnt(6)
    v_mfma_f32_32x32x16_bf16 v[108:123], a[20:23], a[36:39], v[108:123]
    ds_read_b64_tr_b16 a[16:17], v24 offset:14336
    ds_read_b64_tr_b16 a[18:19], v24 offset:14848
    v_mfma_f32_32x32x16_bf16 v[124:139], a[24:27], a[36:39], v[124:139]
    s_add_u32 m0, s71, 0x14000
    s_nop 0
    buffer_load_dwordx4 v14, s[8:11], s62 offen offset:0 lds
    v_mfma_f32_16x16x32_bf16 v[140:143], v[152:155], a[28:31], v[140:143]
    buffer_load_dwordx4 v15, s[8:11], s62 offen offset:1024 lds
    v_mfma_f32_16x16x32_bf16 v[144:147], v[152:155], a[32:35], v[144:147]
    v_mfma_f32_16x16x32_bf16 v[148:151], v[152:155], a[36:39], v[148:151]
    s_waitcnt lgkmcnt(5)
    v_mfma_f32_32x32x16_bf16 v[44:59], a[8:11], a[0:3], v[44:59]
    ds_read_b64_tr_b16 a[28:29], v25 offset:18432
    ds_read_b64_tr_b16 a[30:31], v25 offset:18944
    ds_read_b128 a[20:23], v23 offset:0
    s_waitcnt lgkmcnt(7)
    v_mfma_f32_32x32x16_bf16 v[60:75], a[8:11], a[4:7], v[60:75]
    s_add_u32 m0, s65, 0x14c00
    s_nop 0
    buffer_load_dwordx4 v31, s[12:15], s63 offen offset:0 lds
    s_waitcnt lgkmcnt(5)
    v_mfma_f32_32x32x16_bf16 v[76:91], a[0:3], a[12:15], v[76:91]
    ds_read_b128 a[24:27], v23 offset:4096
    ds_read_b64_tr_b16 a[32:33], v25 offset:19456
    ds_read_b64_tr_b16 a[34:35], v25 offset:19968
    v_mfma_f32_32x32x16_bf16 v[92:107], a[4:7], a[12:15], v[92:107]
    buffer_load_dwordx4 v19, s[12:15], s63 offen offset:1024 lds
    s_waitcnt lgkmcnt(6)
    v_mfma_f32_32x32x16_bf16 v[108:123], a[0:3], a[16:19], v[108:123]
    ds_read_b64_tr_b16 a[36:37], v25 offset:20480
    ds_read_b64_tr_b16 a[38:39], v25 offset:20992
    v_mfma_f32_32x32x16_bf16 v[124:139], a[4:7], a[16:19], v[124:139]
    buffer_load_dwordx4 v19, s[12:15], s63 offen offset:2048 lds
    v_mfma_f32_16x16x32_bf16 v[140:143], v[152:155], a[8:11], v[140:143]
    s_add_u32 m0, s71, 0x14000
    s_nop 0
    buffer_load_dwordx4 v16, s[8:11], s62 offen offset:2048 lds
    v_mfma_f32_16x16x32_bf16 v[144:147], v[152:155], a[12:15], v[144:147]
    v_mfma_f32_16x16x32_bf16 v[148:151], v[152:155], a[16:19], v[148:151]
    s_waitcnt vmcnt(9)
    v_mov_b32 v10, v10
    s_cmp_lg_u32 s48, 0
    s_cbranch_scc1 L_ok_rdya
    v_cmp_ne_u32 vcc, 1, v10
    s_nop 0
    s_cbranch_vccnz L_slow_rdya
L_ok_rdya:
    v_lshlrev_b32 v11, 4, v0
    v_add_u32 v11, 0x620000, v11
    s_waitcnt lgkmcnt(5)
    v_mfma_f32_32x32x16_bf16 v[44:59], a[28:31], a[20:23], v[44:59]
    v_add_u32 v20, 0xa000, v20
    v_add_u32 v21, 0xa000, v21
    v_add_u32 v22, 0xa000, v22
    s_waitcnt lgkmcnt(4)
    v_mfma_f32_32x32x16_bf16 v[60:75], a[28:31], a[24:27], v[60:75]
    v_add_u32 v23, 0xa000, v23
    v_add_u32 v24, 0xa000, v24
    v_add_u32 v25, 0xa000, v25
    s_waitcnt lgkmcnt(0)
    s_barrier
    s_cmp_lg_u32 s48, 0
    s_cbranch_scc1 L_nf_f1a
    buffer_store_dword v12, v9, s[28:31], 0 offen sc1
L_nf_f1a:
    ds_read_b64_tr_b16 a[8:9], v24 offset:0
    ds_read_b64_tr_b16 a[10:11], v24 offset:512
    ds_read_b128 a[0:3], v20 offset:0
    v_mfma_f32_32x32x16_bf16 v[76:91], a[20:23], a[32:35], v[76:91]
    buffer_load_dwordx4 v17, s[8:11], s62 offen offset:3072 lds
    v_mfma_f32_32x32x16_bf16 v[92:107], a[24:27], a[32:35], v[92:107]
    ds_read_b128 a[4:7], v20 offset:4096
    ds_read_b64_tr_b16 a[12:13], v24 offset:1024
    ds_read_b64_tr_b16 a[14:15], v24 offset:1536
    v_mfma_f32_32x32x16_bf16 v[108:123], a[20:23], a[36:39], v[108:123]
    ds_read_b64_tr_b16 a[16:17], v24 offset:2048
    ds_read_b64_tr_b16 a[18:19], v24 offset:2560
    v_mfma_f32_32x32x16_bf16 v[124:139], a[24:27], a[36:39], v[124:139]
    s_bfe_u32 s61, s67, 0x3000c
    s_mul_i32 s63, s61, 196608
    s_lshl_b32 s62, s61, 7
    s_add_u32 m0, s65, 0x0
    s_nop 0
    buffer_load_dwordx4 v30, s[12:15], s63 offen offset:0 lds
    v_mfma_f32_16x16x32_bf16 v[140:143], v[152:155], a[28:31], v[140:143]
    buffer_load_dwordx4 v18, s[12:15], s63 offen offset:1024 lds
    v_mfma_f32_16x16x32_bf16 v[144:147], v[152:155], a[32:35], v[144:147]
    v_mfma_f32_16x16x32_bf16 v[148:151], v[152:155], a[36:39], v[148:151]
    s_waitcnt lgkmcnt(5)
    v_mfma_f32_32x32x16_bf16 v[44:59], a[8:11], a[0:3], v[44:59]
    ds_read_b64_tr_b16 a[28:29], v25 offset:6144
    ds_read_b64_tr_b16 a[30:31], v25 offset:6656
    ds_read_b128 a[20:23], v21 offset:0
    s_and_b32 s56, s48, 1
    s_lshr_b32 s57, s48, 1
    s_waitcnt lgkmcnt(7)
    v_mfma_f32_32x32x16_bf16 v[60:75], a[8:11], a[4:7], v[60:75]
    buffer_load_dwordx4 v18, s[12:15], s63 offen offset:2048 lds
    s_waitcnt lgkmcnt(5)
    v_mfma_f32_32x32x16_bf16 v[76:91], a[0:3], a[12:15], v[76:91]
    ds_read_b128 a[24:27], v21 offset:4096
    ds_read_b64_tr_b16 a[32:33], v25 offset:7168
    ds_read_b64_tr_b16 a[34:35], v25 offset:7680
    s_lshl_b32 s58, s50, 1
    s_add_u32 s58, s58, s57
    v_mfma_f32_32x32x16_bf16 v[92:107], a[4:7], a[12:15], v[92:107]
    s_add_u32 m0, s71, 0x0
    s_nop 0
    buffer_load_dwordx4 v14, s[8:11], s62 offen offset:0 lds
    s_waitcnt lgkmcnt(6)
    v_mfma_f32_32x32x16_bf16 v[108:123], a[0:3], a[16:19], v[108:123]
    ds_read_b64_tr_b16 a[36:37], v25 offset:8192
    ds_read_b64_tr_b16 a[38:39], v25 offset:8704
    s_lshl_b32 s58, s58, 12
    s_add_u32 s58, s58, 0x640000
    v_mfma_f32_32x32x16_bf16 v[124:139], a[4:7], a[16:19], v[124:139]
    buffer_load_dwordx4 v15, s[8:11], s62 offen offset:1024 lds
    s_waitcnt lgkmcnt(5)
    v_mfma_f32_32x32x16_bf16 v[44:59], a[28:31], a[20:23], v[44:59]
    ds_read_b64_tr_b16 a[8:9], v24 offset:12288
    ds_read_b64_tr_b16 a[10:11], v24 offset:12800
    ds_read_b128 a[0:3], v22 offset:0
    v_lshl_add_u32 v152, v2, 4, s58
    s_lshr_b32 s59, s49, 3
    s_waitcnt lgkmcnt(7)
    v_mfma_f32_32x32x16_bf16 v[60:75], a[28:31], a[24:27], v[60:75]
    s_add_u32 m0, s65, 0xc00
    s_nop 0
    buffer_load_dwordx4 v31, s[12:15], s63 offen offset:0 lds
    s_waitcnt lgkmcnt(5)
    v_mfma_f32_32x32x16_bf16 v[76:91], a[20:23], a[32:35], v[76:91]
    ds_read_b128 a[4:7], v22 offset:4096
    ds_read_b64_tr_b16 a[12:13], v24 offset:13312
    ds_read_b64_tr_b16 a[14:15], v24 offset:13824
    s_or_b32 s58, s59, s56
    v_or_b32 v153, s58, v3
    v_mfma_f32_32x32x16_bf16 v[92:107], a[24:27], a[32:35], v[92:107]
    buffer_load_dwordx4 v19, s[12:15], s63 offen offset:1024 lds
    s_waitcnt lgkmcnt(6)
    v_mfma_f32_32x32x16_bf16 v[108:123], a[20:23], a[36:39], v[108:123]
    ds_read_b64_tr_b16 a[16:17], v24 offset:14336
    ds_read_b64_tr_b16 a[18:19], v24 offset:14848
    v_lshl_add_u32 v153, v153, 31, v152
    s_lshl_b32 s58, s49, 9
    v_mfma_f32_32x32x16_bf16 v[124:139], a[24:27], a[36:39], v[124:139]
    buffer_load_dwordx4 v19, s[12:15], s63 offen offset:2048 lds
    s_waitcnt lgkmcnt(5)
    v_mfma_f32_32x32x16_bf16 v[44:59], a[8:11], a[0:3], v[44:59]
    ds_read_b64_tr_b16 a[28:29], v25 offset:18432
    ds_read_b64_tr_b16 a[30:31], v25 offset:18944
    ds_read_b128 a[20:23], v23 offset:0
    v_mov_b32_e64 v145, v148
    buffer_store_dwordx4 v[142:145], v153, s[28:31], s58 offen sc1
    s_waitcnt lgkmcnt(7)
    v_mfma_f32_32x32x16_bf16 v[60:75], a[8:11], a[4:7], v[60:75]
    s_add_u32 m0, s71, 0x0
    s_nop 0
    buffer_load_dwordx4 v16, s[8:11], s62 offen offset:2048 lds
    s_waitcnt lgkmcnt(5)
    v_mfma_f32_32x32x16_bf16 v[76:91], a[0:3], a[12:15], v[76:91]
    ds_read_b128 a[24:27], v23 offset:4096
    ds_read_b64_tr_b16 a[32:33], v25 offset:19456
    ds_read_b64_tr_b16 a[34:35], v25 offset:19968
    v_lshl_add_u32 v152, v3, 11, v152
    s_lshl_b32 s58, s50, 9
    v_mfma_f32_32x32x16_bf16 v[92:107], a[4:7], a[12:15], v[92:107]
    buffer_load_dwordx4 v17, s[8:11], s62 offen offset:3072 lds
    s_waitcnt lgkmcnt(6)
    v_mfma_f32_32x32x16_bf16 v[108:123], a[0:3], a[16:19], v[108:123]
    ds_read_b64_tr_b16 a[36:37], v25 offset:20480
    ds_read_b64_tr_b16 a[38:39], v25 offset:20992
    s_add_u32 s58, s58, 0x621000
    v_and_b32 v154, 7, v1
    v_mfma_f32_32x32x16_bf16 v[124:139], a[4:7], a[16:19], v[124:139]
    s_waitcnt lgkmcnt(5)
    v_mfma_f32_32x32x16_bf16 v[44:59], a[28:31], a[20:23], v[44:59]
    v_add_u32 v20, 0xa000, v20
    v_add_u32 v21, 0xa000, v21
    v_add_u32 v22, 0xa000, v22
    s_waitcnt lgkmcnt(4)
    v_mfma_f32_32x32x16_bf16 v[60:75], a[28:31], a[24:27], v[60:75]
    v_add_u32 v23, 0xa000, v23
    v_add_u32 v24, 0xa000, v24
    v_add_u32 v25, 0xa000, v25
    s_waitcnt vmcnt(11)
    s_waitcnt lgkmcnt(0)
    s_barrier
    ds_read_b64_tr_b16 a[8:9], v24 offset:0
    ds_read_b64_tr_b16 a[10:11], v24 offset:512
    ds_read_b128 a[0:3], v20 offset:0
    v_mfma_f32_32x32x16_bf16 v[76:91], a[20:23], a[32:35], v[76:91]
    s_bfe_u32 s61, s67, 0x30010
    s_mul_i32 s63, s61, 196608
    s_lshl_b32 s62, s61, 7
    s_add_u32 m0, s65, 0xa000
    s_nop 0
    buffer_load_dwordx4 v30, s[12:15], s63 offen offset:0 lds
    v_mfma_f32_32x32x16_bf16 v[92:107], a[24:27], a[32:35], v[92:107]
    ds_read_b128 a[4:7], v20 offset:4096
    ds_read_b64_tr_b16 a[12:13], v24 offset:1024
    ds_read_b64_tr_b16 a[14:15], v24 offset:1536
    v_lshl_add_u32 v154, v154, 6, s58
    s_lshl_b32 s59, s59, 31
    v_mfma_f32_32x32x16_bf16 v[108:123], a[20:23], a[36:39], v[108:123]
    ds_read_b64_tr_b16 a[16:17], v24 offset:2048
    ds_read_b64_tr_b16 a[18:19], v24 offset:2560
    s_add_u32 s58, s58, s59
    s_lshl_b32 s59, s49, 6
    v_mfma_f32_32x32x16_bf16 v[124:139], a[24:27], a[36:39], v[124:139]
    buffer_load_dwordx4 v18, s[12:15], s63 offen offset:1024 lds
    s_waitcnt lgkmcnt(5)
    v_mfma_f32_32x32x16_bf16 v[44:59], a[8:11], a[0:3], v[44:59]
    ds_read_b64_tr_b16 a[28:29], v25 offset:6144
    ds_read_b64_tr_b16 a[30:31], v25 offset:6656
    ds_read_b128 a[20:23], v21 offset:0
    s_add_u32 s58, s58, s59
    v_mov_b32_e64 v9, s58
    s_waitcnt lgkmcnt(7)
    v_mfma_f32_32x32x16_bf16 v[60:75], a[8:11], a[4:7], v[60:75]
    buffer_load_dwordx4 v18, s[12:15], s63 offen offset:2048 lds
    s_waitcnt lgkmcnt(5)
    v_mfma_f32_32x32x16_bf16 v[76:91], a[0:3], a[12:15], v[76:91]
    ds_read_b128 a[24:27], v21 offset:4096
    ds_read_b64_tr_b16 a[32:33], v25 offset:7168
    ds_read_b64_tr_b16 a[34:35], v25 offset:7680
    s_lshl_b32 s58, s56, 9
    s_lshl_b32 s59, s49, 10
    v_mfma_f32_32x32x16_bf16 v[92:107], a[4:7], a[12:15], v[92:107]
    s_add_u32 m0, s71, 0xa000
    s_nop 0
    buffer_load_dwordx4 v14, s[8:11], s62 offen offset:0 lds
    s_waitcnt lgkmcnt(6)
    v_mfma_f32_32x32x16_bf16 v[108:123], a[0:3], a[16:19], v[108:123]
    ds_read_b64_tr_b16 a[36:37], v25 offset:8192
    ds_read_b64_tr_b16 a[38:39], v25 offset:8704
    s_add_u32 s58, s58, s59
    s_add_u32 s58, s58, 0x610000
    v_mfma_f32_32x32x16_bf16 v[124:139], a[4:7], a[16:19], v[124:139]
    buffer_load_dwordx4 v15, s[8:11], s62 offen offset:1024 lds
    s_waitcnt lgkmcnt(5)
    v_mfma_f32_32x32x16_bf16 v[44:59], a[28:31], a[20:23], v[44:59]
    ds_read_b64_tr_b16 a[8:9], v24 offset:12288
    ds_read_b64_tr_b16 a[10:11], v24 offset:12800
    ds_read_b128 a[0:3], v22 offset:0
    v_lshl_add_u32 v156, v1, 3, s58
    s_lshl_b32 s58, s56, 12
    s_waitcnt lgkmcnt(7)
    v_mfma_f32_32x32x16_bf16 v[60:75], a[28:31], a[24:27], v[60:75]
    s_add_u32 m0, s65, 0xac00
    s_nop 0
    buffer_load_dwordx4 v31, s[12:15], s63 offen offset:0 lds
    s_waitcnt lgkmcnt(5)
    v_mfma_f32_32x32x16_bf16 v[76:91], a[20:23], a[32:35], v[76:91]
    ds_read_b128 a[4:7], v22 offset:4096
    ds_read_b64_tr_b16 a[12:13], v24 offset:13312
    ds_read_b64_tr_b16 a[14:15], v24 offset:13824
    s_lshl_b32 s59, s57, 11
    s_add_u32 s58, s58, s59
    v_mfma_f32_32x32x16_bf16 v[92:107], a[24:27], a[32:35], v[92:107]
    buffer_load_dwordx4 v19, s[12:15], s63 offen offset:1024 lds
    s_waitcnt lgkmcnt(6)
    v_mfma_f32_32x32x16_bf16 v[108:123], a[20:23], a[36:39], v[108:123]
    ds_read_b64_tr_b16 a[16:17], v24 offset:14336
    ds_read_b64_tr_b16 a[18:19], v24 offset:14848
    s_add_u32 s58, s58, 0x24000
    v_lshl_add_u32 v250, v1, 4, s58
    v_mfma_f32_32x32x16_bf16 v[124:139], a[24:27], a[36:39], v[124:139]
    buffer_load_dwordx4 v19, s[12:15], s63 offen offset:2048 lds
    s_waitcnt lgkmcnt(5)
    v_mfma_f32_32x32x16_bf16 v[44:59], a[8:11], a[0:3], v[44:59]
    ds_read_b64_tr_b16 a[28:29], v25 offset:18432
    ds_read_b64_tr_b16 a[30:31], v25 offset:18944
    ds_read_b128 a[20:23], v23 offset:0
    s_lshl_b32 s58, s56, 9
    s_lshl_b32 s59, s57, 7
    s_waitcnt lgkmcnt(7)
    v_mfma_f32_32x32x16_bf16 v[60:75], a[8:11], a[4:7], v[60:75]
    s_add_u32 m0, s71, 0xa000
    s_nop 0
    buffer_load_dwordx4 v16, s[8:11], s62 offen offset:2048 lds
    s_waitcnt lgkmcnt(5)
    v_mfma_f32_32x32x16_bf16 v[76:91], a[0:3], a[12:15], v[76:91]
    ds_read_b128 a[24:27], v23 offset:4096
    ds_read_b64_tr_b16 a[32:33], v25 offset:19456
    ds_read_b64_tr_b16 a[34:35], v25 offset:19968
    s_add_u32 s58, s58, s59
    s_add_u32 s58, s58, 0x26000
    v_mfma_f32_32x32x16_bf16 v[92:107], a[4:7], a[12:15], v[92:107]
    buffer_load_dwordx4 v17, s[8:11], s62 offen offset:3072 lds
    s_waitcnt lgkmcnt(6)
    v_mfma_f32_32x32x16_bf16 v[108:123], a[0:3], a[16:19], v[108:123]
    ds_read_b64_tr_b16 a[36:37], v25 offset:20480
    ds_read_b64_tr_b16 a[38:39], v25 offset:20992
    v_lshl_add_u32 v251, v2, 2, s58
    v_lshl_add_u32 v251, v3, 8, v251
    v_mfma_f32_32x32x16_bf16 v[124:139], a[4:7], a[16:19], v[124:139]
    s_waitcnt vmcnt(12)
    s_waitcnt lgkmcnt(5)
    v_mfma_f32_32x32x16_bf16 v[44:59], a[28:31], a[20:23], v[44:59]
    v_add_u32 v20, 0xfffec000, v20
    v_add_u32 v21, 0xfffec000, v21
    v_add_u32 v22, 0xfffec000, v22
    s_waitcnt lgkmcnt(4)
    v_mfma_f32_32x32x16_bf16 v[60:75], a[28:31], a[24:27], v[60:75]
    v_add_u32 v23, 0xfffec000, v23
    v_add_u32 v24, 0xfffec000, v24
    v_add_u32 v25, 0xfffec000, v25
    s_waitcnt vmcnt(10)
    s_waitcnt lgkmcnt(0)
    s_barrier
    s_cmp_lg_u32 s48, 0
    s_cbranch_scc1 L_nf_f5
    buffer_store_dword v12, v9, s[28:31], 0 offen sc1
L_nf_f5:
    ds_read_b64_tr_b16 a[8:9], v24 offset:0
    ds_read_b64_tr_b16 a[10:11], v24 offset:512
    ds_read_b128 a[0:3], v20 offset:0
    v_mfma_f32_32x32x16_bf16 v[76:91], a[20:23], a[32:35], v[76:91]
    s_bfe_u32 s61, s67, 0x30014
    s_mul_i32 s63, s61, 196608
    s_lshl_b32 s62, s61, 7
    s_add_u32 m0, s65, 0x14000
    s_nop 0
    buffer_load_dwordx4 v30, s[12:15], s63 offen offset:0 lds
    v_mfma_f32_32x32x16_bf16 v[92:107], a[24:27], a[32:35], v[92:107]
    ds_read_b128 a[4:7], v20 offset:4096
    ds_read_b64_tr_b16 a[12:13], v24 offset:1024
    ds_read_b64_tr_b16 a[14:15], v24 offset:1536
    v_lshlrev_b32_e64 v254, 2, v0
    v_add_u32 v252, 0x24000, v254
    v_mfma_f32_32x32x16_bf16 v[108:123], a[20:23], a[36:39], v[108:123]
    ds_read_b64_tr_b16 a[16:17], v24 offset:2048
    ds_read_b64_tr_b16 a[18:19], v24 offset:2560
    v_lshlrev_b32_e64 v255, 2, v1
    v_add_u32 v253, 0x26000, v255
    v_mfma_f32_32x32x16_bf16 v[124:139], a[24:27], a[36:39], v[124:139]
    buffer_load_dwordx4 v18, s[12:15], s63 offen offset:1024 lds
    s_waitcnt lgkmcnt(5)
    v_mfma_f32_32x32x16_bf16 v[44:59], a[8:11], a[0:3], v[44:59]
    ds_read_b64_tr_b16 a[28:29], v25 offset:6144
    ds_read_b64_tr_b16 a[30:31], v25 offset:6656
    ds_read_b128 a[20:23], v21 offset:0
    s_lshl_b32 s58, s50, 12
    s_add_u32 s58, s58, 0x600000
    s_waitcnt lgkmcnt(7)
    v_mfma_f32_32x32x16_bf16 v[60:75], a[8:11], a[4:7], v[60:75]
    buffer_load_dwordx4 v18, s[12:15], s63 offen offset:2048 lds
    s_waitcnt lgkmcnt(5)
    v_mfma_f32_32x32x16_bf16 v[76:91], a[0:3], a[12:15], v[76:91]
    ds_read_b128 a[24:27], v21 offset:4096
    ds_read_b64_tr_b16 a[32:33], v25 offset:7168
    ds_read_b64_tr_b16 a[34:35], v25 offset:7680
    v_add_u32 v254, s58, v254
    s_lshl_b32 s58, s50, 8
    v_mfma_f32_32x32x16_bf16 v[92:107], a[4:7], a[12:15], v[92:107]
    s_add_u32 m0, s71, 0x14000
    s_nop 0
    buffer_load_dwordx4 v14, s[8:11], s62 offen offset:0 lds
    s_waitcnt lgkmcnt(6)
    v_mfma_f32_32x32x16_bf16 v[108:123], a[0:3], a[16:19], v[108:123]
    ds_read_b64_tr_b16 a[36:37], v25 offset:8192
    ds_read_b64_tr_b16 a[38:39], v25 offset:8704
    s_add_u32 s58, s58, 0x608000
    s_cmp_eq_u32 s48, 0
    s_cselect_b32 s58, s58, 0x80000000
    v_mfma_f32_32x32x16_bf16 v[124:139], a[4:7], a[16:19], v[124:139]
    buffer_load_dwordx4 v15, s[8:11], s62 offen offset:1024 lds
    s_waitcnt lgkmcnt(5)
    v_mfma_f32_32x32x16_bf16 v[44:59], a[28:31], a[20:23], v[44:59]
    ds_read_b64_tr_b16 a[8:9], v24 offset:12288
    ds_read_b64_tr_b16 a[10:11], v24 offset:12800
    ds_read_b128 a[0:3], v22 offset:0
    v_add_u32 v255, s58, v255
    s_lshl_b32 s58, s49, 17
    s_waitcnt lgkmcnt(7)
    v_mfma_f32_32x32x16_bf16 v[60:75], a[28:31], a[24:27], v[60:75]
    s_add_u32 m0, s65, 0x14c00
    s_nop 0
    buffer_load_dwordx4 v31, s[12:15], s63 offen offset:0 lds
    s_waitcnt lgkmcnt(5)
    v_mfma_f32_32x32x16_bf16 v[76:91], a[20:23], a[32:35], v[76:91]
    ds_read_b128 a[4:7], v22 offset:4096
    ds_read_b64_tr_b16 a[12:13], v24 offset:13312
    ds_read_b64_tr_b16 a[14:15], v24 offset:13824
    s_lshl_b32 s59, s56, 16
    s_add_u32 s58, s58, s59
    v_mfma_f32_32x32x16_bf16 v[92:107], a[24:27], a[32:35], v[92:107]
    buffer_load_dwordx4 v19, s[12:15], s63 offen offset:1024 lds
    s_waitcnt lgkmcnt(6)
    v_mfma_f32_32x32x16_bf16 v[108:123], a[20:23], a[36:39], v[108:123]
    ds_read_b64_tr_b16 a[16:17], v24 offset:14336
    ds_read_b64_tr_b16 a[18:19], v24 offset:14848
    s_xor_b32 s59, s50, 1
    s_lshl_b32 s59, s59, 13
    v_mfma_f32_32x32x16_bf16 v[124:139], a[24:27], a[36:39], v[124:139]
    buffer_load_dwordx4 v19, s[12:15], s63 offen offset:2048 lds
    buffer_load_dword v10, v11, s[28:31], 0 offen sc1
    s_waitcnt lgkmcnt(5)
    v_mfma_f32_32x32x16_bf16 v[44:59], a[8:11], a[0:3], v[44:59]
    ds_read_b64_tr_b16 a[28:29], v25 offset:18432
    ds_read_b64_tr_b16 a[30:31], v25 offset:18944
    ds_read_b128 a[20:23], v23 offset:0
    s_add_u32 s58, s58, s59
    s_lshl_b32 s59, s57, 12
    s_waitcnt lgkmcnt(7)
    v_mfma_f32_32x32x16_bf16 v[60:75], a[8:11], a[4:7], v[60:75]
    s_add_u32 m0, s71, 0x14000
    s_nop 0
    buffer_load_dwordx4 v16, s[8:11], s62 offen offset:2048 lds
    s_waitcnt lgkmcnt(5)
    v_mfma_f32_32x32x16_bf16 v[76:91], a[0:3], a[12:15], v[76:91]
    ds_read_b128 a[24:27], v23 offset:4096
    ds_read_b64_tr_b16 a[32:33], v25 offset:19456
    ds_read_b64_tr_b16 a[34:35], v25 offset:19968
    s_add_u32 s58, s58, s59
    s_add_u32 s58, s58, 0x400000
    v_mfma_f32_32x32x16_bf16 v[92:107], a[4:7], a[12:15], v[92:107]
    buffer_load_dwordx4 v17, s[8:11], s62 offen offset:3072 lds
    s_waitcnt lgkmcnt(6)
    v_mfma_f32_32x32x16_bf16 v[108:123], a[0:3], a[16:19], v[108:123]
    ds_read_b64_tr_b16 a[36:37], v25 offset:20480
    ds_read_b64_tr_b16 a[38:39], v25 offset:20992
    v_lshl_add_u32 v6, v1, 4, s58
    v_mov_b32 v36, 0x358637bd
    v_mfma_f32_32x32x16_bf16 v[124:139], a[4:7], a[16:19], v[124:139]
    s_waitcnt lgkmcnt(5)
    v_mfma_f32_32x32x16_bf16 v[44:59], a[28:31], a[20:23], v[44:59]
    v_add_u32 v20, 0xa000, v20
    v_add_u32 v21, 0xa000, v21
    v_add_u32 v22, 0xa000, v22
    s_waitcnt lgkmcnt(4)
    v_mfma_f32_32x32x16_bf16 v[60:75], a[28:31], a[24:27], v[60:75]
    v_add_u32 v23, 0xa000, v23
    v_add_u32 v24, 0xa000, v24
    v_add_u32 v25, 0xa000, v25
    s_waitcnt vmcnt(11)
    s_waitcnt lgkmcnt(0)
    s_barrier
    ds_read_b64_tr_b16 a[8:9], v24 offset:0
    ds_read_b64_tr_b16 a[10:11], v24 offset:512
    ds_read_b128 a[0:3], v20 offset:0
    v_mfma_f32_32x32x16_bf16 v[76:91], a[20:23], a[32:35], v[76:91]
    s_bfe_u32 s61, s67, 0x30018
    s_mul_i32 s63, s61, 196608
    s_lshl_b32 s62, s61, 7
    s_add_u32 m0, s65, 0x0
    s_nop 0
    buffer_load_dwordx4 v30, s[12:15], s63 offen offset:0 lds
    v_mfma_f32_32x32x16_bf16 v[92:107], a[24:27], a[32:35], v[92:107]
    ds_read_b128 a[4:7], v20 offset:4096
    ds_read_b64_tr_b16 a[12:13], v24 offset:1024
    ds_read_b64_tr_b16 a[14:15], v24 offset:1536
    v_mov_b32 v37, 0x35c1a2a0
    v_mov_b32 v38, 0x3f317218
    v_mfma_f32_32x32x16_bf16 v[108:123], a[20:23], a[36:39], v[108:123]
    ds_read_b64_tr_b16 a[16:17], v24 offset:2048
    ds_read_b64_tr_b16 a[18:19], v24 offset:2560
    v_mfma_f32_32x32x16_bf16 v[124:139], a[24:27], a[36:39], v[124:139]
    buffer_load_dwordx4 v18, s[12:15], s63 offen offset:1024 lds
    s_waitcnt lgkmcnt(5)
    v_mfma_f32_32x32x16_bf16 v[44:59], a[8:11], a[0:3], v[44:59]
    ds_read_b64_tr_b16 a[28:29], v25 offset:6144
    ds_read_b64_tr_b16 a[30:31], v25 offset:6656
    ds_read_b128 a[20:23], v21 offset:0
    s_waitcnt lgkmcnt(7)
    v_mfma_f32_32x32x16_bf16 v[60:75], a[8:11], a[4:7], v[60:75]
    buffer_load_dwordx4 v18, s[12:15], s63 offen offset:2048 lds
    s_waitcnt lgkmcnt(5)
    v_mfma_f32_32x32x16_bf16 v[76:91], a[0:3], a[12:15], v[76:91]
    ds_read_b128 a[24:27], v21 offset:4096
    ds_read_b64_tr_b16 a[32:33], v25 offset:7168
    ds_read_b64_tr_b16 a[34:35], v25 offset:7680
    v_mfma_f32_32x32x16_bf16 v[92:107], a[4:7], a[12:15], v[92:107]
    s_add_u32 m0, s71, 0x0
    s_nop 0
    buffer_load_dwordx4 v14, s[8:11], s62 offen offset:0 lds
    s_waitcnt lgkmcnt(6)
    v_mfma_f32_32x32x16_bf16 v[108:123], a[0:3], a[16:19], v[108:123]
    ds_read_b64_tr_b16 a[36:37], v25 offset:8192
    ds_read_b64_tr_b16 a[38:39], v25 offset:8704
    v_mfma_f32_32x32x16_bf16 v[124:139], a[4:7], a[16:19], v[124:139]
    buffer_load_dwordx4 v15, s[8:11], s62 offen offset:1024 lds
    s_waitcnt lgkmcnt(5)
    v_mfma_f32_32x32x16_bf16 v[44:59], a[28:31], a[20:23], v[44:59]
    ds_read_b64_tr_b16 a[8:9], v24 offset:12288
    ds_read_b64_tr_b16 a[10:11], v24 offset:12800
    ds_read_b128 a[0:3], v22 offset:0
    s_waitcnt lgkmcnt(7)
    v_mfma_f32_32x32x16_bf16 v[60:75], a[28:31], a[24:27], v[60:75]
    s_add_u32 m0, s65, 0xc00
    s_nop 0
    buffer_load_dwordx4 v31, s[12:15], s63 offen offset:0 lds
    s_waitcnt lgkmcnt(5)
    v_mfma_f32_32x32x16_bf16 v[76:91], a[20:23], a[32:35], v[76:91]
    ds_read_b128 a[4:7], v22 offset:4096
    ds_read_b64_tr_b16 a[12:13], v24 offset:13312
    ds_read_b64_tr_b16 a[14:15], v24 offset:13824
    v_mfma_f32_32x32x16_bf16 v[92:107], a[24:27], a[32:35], v[92:107]
    buffer_load_dwordx4 v19, s[12:15], s63 offen offset:1024 lds
    s_waitcnt lgkmcnt(6)
    v_mfma_f32_32x32x16_bf16 v[108:123], a[20:23], a[36:39], v[108:123]
    ds_read_b64_tr_b16 a[16:17], v24 offset:14336
    ds_read_b64_tr_b16 a[18:19], v24 offset:14848
    v_mfma_f32_32x32x16_bf16 v[124:139], a[24:27], a[36:39], v[124:139]
    buffer_load_dwordx4 v19, s[12:15], s63 offen offset:2048 lds
    s_waitcnt lgkmcnt(5)
    v_mfma_f32_32x32x16_bf16 v[44:59], a[8:11], a[0:3], v[44:59]
    ds_read_b64_tr_b16 a[28:29], v25 offset:18432
    ds_read_b64_tr_b16 a[30:31], v25 offset:18944
    ds_read_b128 a[20:23], v23 offset:0
    s_waitcnt lgkmcnt(7)
    v_mfma_f32_32x32x16_bf16 v[60:75], a[8:11], a[4:7], v[60:75]
    s_add_u32 m0, s71, 0x0
    s_nop 0
    buffer_load_dwordx4 v16, s[8:11], s62 offen offset:2048 lds
    s_waitcnt lgkmcnt(5)
    v_mfma_f32_32x32x16_bf16 v[76:91], a[0:3], a[12:15], v[76:91]
    ds_read_b128 a[24:27], v23 offset:4096
    ds_read_b64_tr_b16 a[32:33], v25 offset:19456
    ds_read_b64_tr_b16 a[34:35], v25 offset:19968
    v_mfma_f32_32x32x16_bf16 v[92:107], a[4:7], a[12:15], v[92:107]
    buffer_load_dwordx4 v17, s[8:11], s62 offen offset:3072 lds
    s_waitcnt lgkmcnt(6)
    v_mfma_f32_32x32x16_bf16 v[108:123], a[0:3], a[16:19], v[108:123]
    ds_read_b64_tr_b16 a[36:37], v25 offset:20480
    ds_read_b64_tr_b16 a[38:39], v25 offset:20992
    v_mfma_f32_32x32x16_bf16 v[124:139], a[4:7], a[16:19], v[124:139]
    s_waitcnt vmcnt(12)
    v_cmp_ne_u32 vcc, 1, v10
    s_nop 0
    s_cbranch_vccnz L_slow_f1a
L_ok_f1a:
    s_waitcnt lgkmcnt(5)
    v_mfma_f32_32x32x16_bf16 v[44:59], a[28:31], a[20:23], v[44:59]
    v_add_u32 v20, 0xa000, v20
    v_add_u32 v21, 0xa000, v21
    v_add_u32 v22, 0xa000, v22
    s_waitcnt lgkmcnt(4)
    v_mfma_f32_32x32x16_bf16 v[60:75], a[28:31], a[24:27], v[60:75]
    v_add_u32 v23, 0xa000, v23
    v_add_u32 v24, 0xa000, v24
    v_add_u32 v25, 0xa000, v25
    s_waitcnt vmcnt(10)
    s_waitcnt lgkmcnt(0)
    s_barrier
    v_mov_b32_e64 v11, v154
    buffer_load_dword v10, v11, s[28:31], 0 offen sc1
    buffer_load_dwordx2 v[156:157], v156, s[28:31], 0 offen sc1
    ds_read_b64_tr_b16 a[8:9], v24 offset:0
    ds_read_b64_tr_b16 a[10:11], v24 offset:512
    ds_read_b128 a[0:3], v20 offset:0
    v_mfma_f32_32x32x16_bf16 v[76:91], a[20:23], a[32:35], v[76:91]
    s_bfe_u32 s61, s67, 0x3001c
    s_mul_i32 s63, s61, 196608
    s_lshl_b32 s62, s61, 7
    s_add_u32 m0, s65, 0xa000
    s_nop 0
    buffer_load_dwordx4 v30, s[12:15], s63 offen offset:0 lds
    v_mfma_f32_32x32x16_bf16 v[92:107], a[24:27], a[32:35], v[92:107]
    ds_read_b128 a[4:7], v20 offset:4096
    ds_read_b64_tr_b16 a[12:13], v24 offset:1024
    ds_read_b64_tr_b16 a[14:15], v24 offset:1536
    v_mfma_f32_32x32x16_bf16 v[108:123], a[20:23], a[36:39], v[108:123]
    ds_read_b64_tr_b16 a[16:17], v24 offset:2048
    ds_read_b64_tr_b16 a[18:19], v24 offset:2560
    v_mfma_f32_32x32x16_bf16 v[124:139], a[24:27], a[36:39], v[124:139]
    buffer_load_dwordx4 v18, s[12:15], s63 offen offset:1024 lds
    s_waitcnt lgkmcnt(5)
    v_mfma_f32_32x32x16_bf16 v[44:59], a[8:11], a[0:3], v[44:59]
    ds_read_b64_tr_b16 a[28:29], v25 offset:6144
    ds_read_b64_tr_b16 a[30:31], v25 offset:6656
    ds_read_b128 a[20:23], v21 offset:0
    s_waitcnt lgkmcnt(7)
    v_mfma_f32_32x32x16_bf16 v[60:75], a[8:11], a[4:7], v[60:75]
    buffer_load_dwordx4 v18, s[12:15], s63 offen offset:2048 lds
    s_waitcnt lgkmcnt(5)
    v_mfma_f32_32x32x16_bf16 v[76:91], a[0:3], a[12:15], v[76:91]
    ds_read_b128 a[24:27], v21 offset:4096
    ds_read_b64_tr_b16 a[32:33], v25 offset:7168
    ds_read_b64_tr_b16 a[34:35], v25 offset:7680
    v_mfma_f32_32x32x16_bf16 v[92:107], a[4:7], a[12:15], v[92:107]
    s_add_u32 m0, s71, 0xa000
    s_nop 0
    buffer_load_dwordx4 v14, s[8:11], s62 offen offset:0 lds
    s_waitcnt lgkmcnt(6)
    v_mfma_f32_32x32x16_bf16 v[108:123], a[0:3], a[16:19], v[108:123]
    ds_read_b64_tr_b16 a[36:37], v25 offset:8192
    ds_read_b64_tr_b16 a[38:39], v25 offset:8704
    v_mfma_f32_32x32x16_bf16 v[124:139], a[4:7], a[16:19], v[124:139]
    buffer_load_dwordx4 v15, s[8:11], s62 offen offset:1024 lds
    s_waitcnt lgkmcnt(5)
    v_mfma_f32_32x32x16_bf16 v[44:59], a[28:31], a[20:23], v[44:59]
    ds_read_b64_tr_b16 a[8:9], v24 offset:12288
    ds_read_b64_tr_b16 a[10:11], v24 offset:12800
    ds_read_b128 a[0:3], v22 offset:0
    s_waitcnt lgkmcnt(7)
    v_mfma_f32_32x32x16_bf16 v[60:75], a[28:31], a[24:27], v[60:75]
    s_add_u32 m0, s65, 0xac00
    s_nop 0
    buffer_load_dwordx4 v31, s[12:15], s63 offen offset:0 lds
    s_waitcnt lgkmcnt(5)
    v_mfma_f32_32x32x16_bf16 v[76:91], a[20:23], a[32:35], v[76:91]
    ds_read_b128 a[4:7], v22 offset:4096
    ds_read_b64_tr_b16 a[12:13], v24 offset:13312
    ds_read_b64_tr_b16 a[14:15], v24 offset:13824
    v_mfma_f32_32x32x16_bf16 v[92:107], a[24:27], a[32:35], v[92:107]
    buffer_load_dwordx4 v19, s[12:15], s63 offen offset:1024 lds
    s_waitcnt lgkmcnt(6)
    v_mfma_f32_32x32x16_bf16 v[108:123], a[20:23], a[36:39], v[108:123]
    ds_read_b64_tr_b16 a[16:17], v24 offset:14336
    ds_read_b64_tr_b16 a[18:19], v24 offset:14848
    v_mfma_f32_32x32x16_bf16 v[124:139], a[24:27], a[36:39], v[124:139]
    buffer_load_dwordx4 v19, s[12:15], s63 offen offset:2048 lds
    s_waitcnt lgkmcnt(5)
    v_mfma_f32_32x32x16_bf16 v[44:59], a[8:11], a[0:3], v[44:59]
    ds_read_b64_tr_b16 a[28:29], v25 offset:18432
    ds_read_b64_tr_b16 a[30:31], v25 offset:18944
    ds_read_b128 a[20:23], v23 offset:0
    s_waitcnt lgkmcnt(7)
    v_mfma_f32_32x32x16_bf16 v[60:75], a[8:11], a[4:7], v[60:75]
    s_add_u32 m0, s71, 0xa000
    s_nop 0
    buffer_load_dwordx4 v16, s[8:11], s62 offen offset:2048 lds
    s_waitcnt lgkmcnt(5)
    v_mfma_f32_32x32x16_bf16 v[76:91], a[0:3], a[12:15], v[76:91]
    ds_read_b128 a[24:27], v23 offset:4096
    ds_read_b64_tr_b16 a[32:33], v25 offset:19456
    ds_read_b64_tr_b16 a[34:35], v25 offset:19968
    v_mfma_f32_32x32x16_bf16 v[92:107], a[4:7], a[12:15], v[92:107]
    buffer_load_dwordx4 v17, s[8:11], s62 offen offset:3072 lds
    s_waitcnt lgkmcnt(6)
    v_mfma_f32_32x32x16_bf16 v[108:123], a[0:3], a[16:19], v[108:123]
    ds_read_b64_tr_b16 a[36:37], v25 offset:20480
    ds_read_b64_tr_b16 a[38:39], v25 offset:20992
    v_mfma_f32_32x32x16_bf16 v[124:139], a[4:7], a[16:19], v[124:139]
    s_waitcnt vmcnt(11)
    v_cmp_ne_u32_e64 vcc, 1, v10
    s_nop 0
    s_cbranch_vccnz L_slow_f5
L_ok_f5:
    s_waitcnt lgkmcnt(5)
    v_mfma_f32_32x32x16_bf16 v[44:59], a[28:31], a[20:23], v[44:59]
    v_add_u32 v20, 0xfffec000, v20
    v_add_u32 v21, 0xfffec000, v21
    v_add_u32 v22, 0xfffec000, v22
    s_waitcnt lgkmcnt(4)
    v_mfma_f32_32x32x16_bf16 v[60:75], a[28:31], a[24:27], v[60:75]
    v_add_u32 v23, 0xfffec000, v23
    v_add_u32 v24, 0xfffec000, v24
    v_add_u32 v25, 0xfffec000, v25
    s_waitcnt lgkmcnt(0)
    s_barrier
    ds_read_b64_tr_b16 a[8:9], v24 offset:0
    ds_read_b64_tr_b16 a[10:11], v24 offset:512
    ds_read_b128 a[0:3], v20 offset:0
    v_mfma_f32_32x32x16_bf16 v[76:91], a[20:23], a[32:35], v[76:91]
    buffer_load_dwordx4 v[192:195], v152, s[28:31], 0 offen offset:0 sc1
    v_mfma_f32_32x32x16_bf16 v[92:107], a[24:27], a[32:35], v[92:107]
    ds_read_b128 a[4:7], v20 offset:4096
    ds_read_b64_tr_b16 a[12:13], v24 offset:1024
    ds_read_b64_tr_b16 a[14:15], v24 offset:1536
    v_mfma_f32_32x32x16_bf16 v[108:123], a[20:23], a[36:39], v[108:123]
    ds_read_b64_tr_b16 a[16:17], v24 offset:2048
    ds_read_b64_tr_b16 a[18:19], v24 offset:2560
    v_mfma_f32_32x32x16_bf16 v[124:139], a[24:27], a[36:39], v[124:139]
    buffer_load_dwordx4 v[196:199], v152, s[28:31], 0 offen offset:512 sc1
    s_waitcnt lgkmcnt(5)
    v_mfma_f32_32x32x16_bf16 v[44:59], a[8:11], a[0:3], v[44:59]
    ds_read_b64_tr_b16 a[28:29], v25 offset:6144
    ds_read_b64_tr_b16 a[30:31], v25 offset:6656
    ds_read_b128 a[20:23], v21 offset:0
    s_lshl_b32 s58, s48, 10
    s_add_u32 s58, s58, 0x22800
    s_waitcnt lgkmcnt(7)
    v_mfma_f32_32x32x16_bf16 v[60:75], a[8:11], a[4:7], v[60:75]
    buffer_load_dwordx4 v[200:203], v152, s[28:31], 0 offen offset:1024 sc1
    s_waitcnt lgkmcnt(5)
    v_mfma_f32_32x32x16_bf16 v[76:91], a[0:3], a[12:15], v[76:91]
    ds_read_b128 a[24:27], v21 offset:4096
    ds_read_b64_tr_b16 a[32:33], v25 offset:7168
    ds_read_b64_tr_b16 a[34:35], v25 offset:7680
    v_lshl_add_u32 v18, v1, 2, s58
    s_waitcnt vmcnt(13)
    v_mul_f32 v157, 0x3fb8aa3b, v157
    v_mfma_f32_32x32x16_bf16 v[92:107], a[4:7], a[12:15], v[92:107]
    buffer_load_dwordx4 v[204:207], v152, s[28:31], 0 offen offset:1536 sc1
    s_waitcnt lgkmcnt(6)
    v_mfma_f32_32x32x16_bf16 v[108:123], a[0:3], a[16:19], v[108:123]
    ds_read_b64_tr_b16 a[36:37], v25 offset:8192
    ds_read_b64_tr_b16 a[38:39], v25 offset:8704
    v_lshl_add_u32 v14, v2, 2, s58
    v_lshl_add_u32 v15, v3, 4, s58
    v_mfma_f32_32x32x16_bf16 v[124:139], a[4:7], a[16:19], v[124:139]
    s_add_u32 m0, s64, 0x14000
    s_mov_b32 s62, 0x50000
    buffer_load_dwordx4 v28, s[16:19], s62 offen lds
    s_waitcnt lgkmcnt(5)
    v_mfma_f32_32x32x16_bf16 v[44:59], a[28:31], a[20:23], v[44:59]
    ds_read_b64_tr_b16 a[8:9], v24 offset:12288
    ds_read_b64_tr_b16 a[10:11], v24 offset:12800
    ds_read_b128 a[0:3], v22 offset:0
    ds_write2st64_b32 v18, v156, v157 offset0:0 offset1:1
    ds_read_b128 v[160:163], v15 offset:0
    s_waitcnt lgkmcnt(9)
    v_mfma_f32_32x32x16_bf16 v[60:75], a[28:31], a[24:27], v[60:75]
    buffer_load_dwordx4 v29, s[16:19], s62 offen offset:1024 lds
    s_waitcnt lgkmcnt(7)
    v_mfma_f32_32x32x16_bf16 v[76:91], a[20:23], a[32:35], v[76:91]
    ds_read_b128 a[4:7], v22 offset:4096
    ds_read_b64_tr_b16 a[12:13], v24 offset:13312
    ds_read_b64_tr_b16 a[14:15], v24 offset:13824
    ds_read_b128 v[164:167], v15 offset:32
    ds_read_b128 v[168:171], v15 offset:64
    v_mfma_f32_32x32x16_bf16 v[92:107], a[24:27], a[32:35], v[92:107]
    s_add_u32 m0, s64, 0x16000
    s_mov_b32 s62, 0x58000
    buffer_load_dwordx4 v28, s[16:19], s62 offen lds
    s_waitcnt lgkmcnt(10)
    v_mfma_f32_32x32x16_bf16 v[108:123], a[20:23], a[36:39], v[108:123]
    ds_read_b64_tr_b16 a[16:17], v24 offset:14336
    ds_read_b64_tr_b16 a[18:19], v24 offset:14848
    ds_read_b128 v[172:175], v15 offset:96
    ds_read_b128 v[176:179], v15 offset:256
    v_mfma_f32_32x32x16_bf16 v[124:139], a[24:27], a[36:39], v[124:139]
    buffer_load_dwordx4 v29, s[16:19], s62 offen offset:1024 lds
    s_waitcnt lgkmcnt(11)
    v_mfma_f32_32x32x16_bf16 v[44:59], a[8:11], a[0:3], v[44:59]
    ds_read_b64_tr_b16 a[28:29], v25 offset:18432
    ds_read_b64_tr_b16 a[30:31], v25 offset:18944
    ds_read_b128 a[20:23], v23 offset:0
    ds_read_b128 v[180:183], v15 offset:288
    ds_read_b128 v[184:187], v15 offset:320
    s_waitcnt lgkmcnt(13)
    v_mfma_f32_32x32x16_bf16 v[60:75], a[8:11], a[4:7], v[60:75]
    s_add_u32 m0, s64, 0x18000
    s_mov_b32 s62, 0x60000
    buffer_load_dwordx4 v28, s[16:19], s62 offen lds
    s_waitcnt lgkmcnt(11)
    v_mfma_f32_32x32x16_bf16 v[76:91], a[0:3], a[12:15], v[76:91]
    ds_read_b128 a[24:27], v23 offset:4096
    ds_read_b64_tr_b16 a[32:33], v25 offset:19456
    ds_read_b64_tr_b16 a[34:35], v25 offset:19968
    ds_read_b128 v[188:191], v15 offset:352
    ds_read2_b32 v[246:247], v14 offset0:0 offset1:64
    v_mfma_f32_32x32x16_bf16 v[92:107], a[4:7], a[12:15], v[92:107]
    buffer_load_dwordx4 v29, s[16:19], s62 offen offset:1024 lds
    s_waitcnt lgkmcnt(12)
    v_mfma_f32_32x32x16_bf16 v[108:123], a[0:3], a[16:19], v[108:123]
    ds_read_b64_tr_b16 a[36:37], v25 offset:20480
    ds_read_b64_tr_b16 a[38:39], v25 offset:20992
    ds_read2_b32 v[248:249], v14 offset0:32 offset1:96
    v_bfe_u32 v4, v1, 2, 2
    v_mfma_f32_32x32x16_bf16 v[124:139], a[4:7], a[16:19], v[124:139]
    s_add_u32 m0, s64, 0x1a000
    s_mov_b32 s62, 0x68000
    buffer_load_dwordx4 v28, s[16:19], s62 offen lds
    buffer_load_dwordx4 v29, s[16:19], s62 offen offset:1024 lds
    s_add_u32 m0, s64, 0x1c000
    s_mov_b32 s62, 0x70000
    buffer_load_dwordx4 v28, s[16:19], s62 offen lds
    buffer_load_dwordx4 v29, s[16:19], s62 offen offset:1024 lds
    s_add_u32 m0, s64, 0x1e000
    s_mov_b32 s62, 0x78000
    buffer_load_dwordx4 v28, s[16:19], s62 offen lds
    buffer_load_dwordx4 v29, s[16:19], s62 offen offset:1024 lds
    s_waitcnt lgkmcnt(10)
    v_mfma_f32_32x32x16_bf16 v[44:59], a[28:31], a[20:23], v[44:59]
    v_add_u32 v20, 0xa000, v20
    v_add_u32 v21, 0xa000, v21
    v_add_u32 v22, 0xa000, v22
    s_waitcnt lgkmcnt(7)
    v_mfma_f32_32x32x16_bf16 v[60:75], a[28:31], a[24:27], v[60:75]
    v_add_u32 v23, 0xa000, v23
    v_add_u32 v24, 0xa000, v24
    v_add_u32 v25, 0xa000, v25
    s_waitcnt vmcnt(16)
    s_waitcnt lgkmcnt(0)
    s_barrier
    ds_read_b64_tr_b16 a[8:9], v24 offset:0
    ds_read_b64_tr_b16 a[10:11], v24 offset:512
    ds_read_b128 a[0:3], v20 offset:0
    v_mfma_f32_32x32x16_bf16 v[76:91], a[20:23], a[32:35], v[76:91]
    s_add_u32 m0, s64, 0x0
    s_mov_b32 s62, 0x0
    buffer_load_dwordx4 v28, s[16:19], s62 offen lds
    v_mfma_f32_32x32x16_bf16 v[92:107], a[24:27], a[32:35], v[92:107]
    ds_read_b128 a[4:7], v20 offset:4096
    ds_read_b64_tr_b16 a[12:13], v24 offset:1024
    ds_read_b64_tr_b16 a[14:15], v24 offset:1536
    v_lshlrev_b32 v4, 7, v4
    v_lshl_add_u32 v4, v3, 9, v4
    v_mfma_f32_32x32x16_bf16 v[108:123], a[20:23], a[36:39], v[108:123]
    ds_read_b64_tr_b16 a[16:17], v24 offset:2048
    ds_read_b64_tr_b16 a[18:19], v24 offset:2560
    v_bfe_u32 v5, v1, 4, 1
    v_lshl_add_u32 v4, v5, 5, v4
    v_mfma_f32_32x32x16_bf16 v[124:139], a[24:27], a[36:39], v[124:139]
    buffer_load_dwordx4 v29, s[16:19], s62 offen offset:1024 lds
    s_waitcnt lgkmcnt(5)
    v_mfma_f32_32x32x16_bf16 v[44:59], a[8:11], a[0:3], v[44:59]
    ds_read_b64_tr_b16 a[28:29], v25 offset:6144
    ds_read_b64_tr_b16 a[30:31], v25 offset:6656
    ds_read_b128 a[20:23], v21 offset:0
    v_and_b32 v5, 3, v1
    v_lshl_add_u32 v4, v5, 3, v4
    s_waitcnt lgkmcnt(7)
    v_mfma_f32_32x32x16_bf16 v[60:75], a[8:11], a[4:7], v[60:75]
    s_add_u32 m0, s64, 0x2000
    s_mov_b32 s62, 0x8000
    buffer_load_dwordx4 v28, s[16:19], s62 offen lds
    s_waitcnt lgkmcnt(5)
    v_mfma_f32_32x32x16_bf16 v[76:91], a[0:3], a[12:15], v[76:91]
    ds_read_b128 a[24:27], v21 offset:4096
    ds_read_b64_tr_b16 a[32:33], v25 offset:7168
    ds_read_b64_tr_b16 a[34:35], v25 offset:7680
    v_bfe_u32 v5, v1, 3, 1
    v_lshl_add_u32 v4, v5, 6, v4
    v_mfma_f32_32x32x16_bf16 v[92:107], a[4:7], a[12:15], v[92:107]
    buffer_load_dwordx4 v29, s[16:19], s62 offen offset:1024 lds
    s_waitcnt lgkmcnt(6)
    v_mfma_f32_32x32x16_bf16 v[108:123], a[0:3], a[16:19], v[108:123]
    ds_read_b64_tr_b16 a[36:37], v25 offset:8192
    ds_read_b64_tr_b16 a[38:39], v25 offset:8704
    v_add_u32 v30, s60, v4
    v_xor_b32 v33, 64, v30
    v_mfma_f32_32x32x16_bf16 v[124:139], a[4:7], a[16:19], v[124:139]
    s_add_u32 m0, s64, 0x4000
    s_mov_b32 s62, 0x10000
    buffer_load_dwordx4 v28, s[16:19], s62 offen lds
    s_waitcnt lgkmcnt(5)
    v_mfma_f32_32x32x16_bf16 v[44:59], a[28:31], a[20:23], v[44:59]
    ds_read_b64_tr_b16 a[8:9], v24 offset:12288
    ds_read_b64_tr_b16 a[10:11], v24 offset:12800
    ds_read_b128 a[0:3], v22 offset:0
    v_add_u32 v31, 0x10000, v30
    v_add_u32 v32, 0x20000, v30
    s_waitcnt lgkmcnt(7)
    v_mfma_f32_32x32x16_bf16 v[60:75], a[28:31], a[24:27], v[60:75]
    buffer_load_dwordx4 v29, s[16:19], s62 offen offset:1024 lds
    s_waitcnt lgkmcnt(5)
    v_mfma_f32_32x32x16_bf16 v[76:91], a[20:23], a[32:35], v[76:91]
    ds_read_b128 a[4:7], v22 offset:4096
    ds_read_b64_tr_b16 a[12:13], v24 offset:13312
    ds_read_b64_tr_b16 a[14:15], v24 offset:13824
    v_add_u32 v34, 0x10000, v33
    v_add_u32 v35, 0x20000, v33
    v_mfma_f32_32x32x16_bf16 v[92:107], a[24:27], a[32:35], v[92:107]
    s_add_u32 m0, s64, 0x6000
    s_mov_b32 s62, 0x18000
    buffer_load_dwordx4 v28, s[16:19], s62 offen lds
    s_waitcnt lgkmcnt(6)
    v_mfma_f32_32x32x16_bf16 v[108:123], a[20:23], a[36:39], v[108:123]
    ds_read_b64_tr_b16 a[16:17], v24 offset:14336
    ds_read_b64_tr_b16 a[18:19], v24 offset:14848
    s_lshl_b32 s58, s57, 11
    s_lshl_b32 s59, s56, 6
    v_mfma_f32_32x32x16_bf16 v[124:139], a[24:27], a[36:39], v[124:139]
    buffer_load_dwordx4 v29, s[16:19], s62 offen offset:1024 lds
    s_waitcnt lgkmcnt(5)
    v_mfma_f32_32x32x16_bf16 v[44:59], a[8:11], a[0:3], v[44:59]
    ds_read_b64_tr_b16 a[28:29], v25 offset:18432
    ds_read_b64_tr_b16 a[30:31], v25 offset:18944
    ds_read_b128 a[20:23], v23 offset:0
    s_add_u32 s58, s58, s59
    v_xor_b32 v150, s58, v4
    s_waitcnt lgkmcnt(7)
    v_mfma_f32_32x32x16_bf16 v[60:75], a[8:11], a[4:7], v[60:75]
    s_add_u32 m0, s64, 0x8000
    s_mov_b32 s62, 0x20000
    buffer_load_dwordx4 v28, s[16:19], s62 offen lds
    s_waitcnt lgkmcnt(5)
    v_mfma_f32_32x32x16_bf16 v[76:91], a[0:3], a[12:15], v[76:91]
    ds_read_b128 a[24:27], v23 offset:4096
    ds_read_b64_tr_b16 a[32:33], v25 offset:19456
    ds_read_b64_tr_b16 a[34:35], v25 offset:19968
    v_add_u32 v151, 0x10000, v150
    s_waitcnt vmcnt(23)
    v_add_f32 v193, v193, v197
    v_mfma_f32_32x32x16_bf16 v[92:107], a[4:7], a[12:15], v[92:107]
    buffer_load_dwordx4 v29, s[16:19], s62 offen offset:1024 lds
    s_waitcnt lgkmcnt(6)
    v_mfma_f32_32x32x16_bf16 v[108:123], a[0:3], a[16:19], v[108:123]
    ds_read_b64_tr_b16 a[36:37], v25 offset:20480
    ds_read_b64_tr_b16 a[38:39], v25 offset:20992
    s_waitcnt vmcnt(22)
    v_add_f32 v201, v201, v205
    v_add_f32 v194, v194, v198
    v_mfma_f32_32x32x16_bf16 v[124:139], a[4:7], a[16:19], v[124:139]
    buffer_load_dword v159, v26, s[24:27], 0 offen
    s_waitcnt lgkmcnt(5)
    v_mfma_f32_32x32x16_bf16 v[44:59], a[28:31], a[20:23], v[44:59]
    v_add_f32 v202, v202, v206
    v_add_f32 v195, v195, v199
    v_add_f32 v203, v203, v207
    v_add_f32_e64 v193, v193, v201
    v_add_f32 v194, v194, v202
    s_waitcnt lgkmcnt(4)
    v_mfma_f32_32x32x16_bf16 v[60:75], a[28:31], a[24:27], v[60:75]
    v_add_f32 v195, v195, v203
    v_mov_b32 v197, v193
    v_mov_b32 v198, v194
    v_mov_b32 v199, v195
    v_permlane32_swap_b32 v197, v193
    s_waitcnt lgkmcnt(2)
    v_mfma_f32_32x32x16_bf16 v[76:91], a[20:23], a[32:35], v[76:91]
    v_permlane32_swap_b32 v198, v194
    v_permlane32_swap_b32 v199, v195
    v_add_f32 v242, v193, v197
    v_add_f32 v240, v194, v198
    v_add_f32_e64 v241, v195, v199
    v_mfma_f32_32x32x16_bf16 v[92:107], a[24:27], a[32:35], v[92:107]
    ds_write_b32 v14, v242 offset:512
    s_waitcnt lgkmcnt(1)
    v_mfma_f32_32x32x16_bf16 v[108:123], a[20:23], a[36:39], v[108:123]
    v_mfma_f32_32x32x16_bf16 v[124:139], a[24:27], a[36:39], v[124:139]
    s_nop 1
    v_pk_fma_f32 v[76:77], v[160:161], v[240:241], v[76:77] op_sel:[0,0,0] op_sel_hi:[1,0,1] neg_lo:[1,0,0] neg_hi:[1,0,0]
    v_pk_fma_f32 v[78:79], v[162:163], v[240:241], v[78:79] op_sel:[0,0,0] op_sel_hi:[1,0,1] neg_lo:[1,0,0] neg_hi:[1,0,0]
    v_pk_fma_f32 v[80:81], v[164:165], v[240:241], v[80:81] op_sel:[0,0,0] op_sel_hi:[1,0,1] neg_lo:[1,0,0] neg_hi:[1,0,0]
    v_pk_fma_f32 v[82:83], v[166:167], v[240:241], v[82:83] op_sel:[0,0,0] op_sel_hi:[1,0,1] neg_lo:[1,0,0] neg_hi:[1,0,0]
    v_pk_fma_f32 v[84:85], v[168:169], v[240:241], v[84:85] op_sel:[0,0,0] op_sel_hi:[1,0,1] neg_lo:[1,0,0] neg_hi:[1,0,0]
    v_pk_fma_f32 v[86:87], v[170:171], v[240:241], v[86:87] op_sel:[0,0,0] op_sel_hi:[1,0,1] neg_lo:[1,0,0] neg_hi:[1,0,0]
    v_pk_fma_f32 v[88:89], v[172:173], v[240:241], v[88:89] op_sel:[0,0,0] op_sel_hi:[1,0,1] neg_lo:[1,0,0] neg_hi:[1,0,0]
    v_pk_fma_f32 v[90:91], v[174:175], v[240:241], v[90:91] op_sel:[0,0,0] op_sel_hi:[1,0,1] neg_lo:[1,0,0] neg_hi:[1,0,0]
    v_pk_fma_f32 v[76:77], v[76:77], v[176:177], v[36:37] op_sel:[0,0,1] op_sel_hi:[1,1,1]
    v_pk_fma_f32 v[78:79], v[78:79], v[178:179], v[36:37] op_sel:[0,0,1] op_sel_hi:[1,1,1]
    v_pk_fma_f32 v[80:81], v[80:81], v[180:181], v[36:37] op_sel:[0,0,1] op_sel_hi:[1,1,1]
    v_pk_fma_f32 v[82:83], v[82:83], v[182:183], v[36:37] op_sel:[0,0,1] op_sel_hi:[1,1,1]
    v_pk_fma_f32 v[84:85], v[84:85], v[184:185], v[36:37] op_sel:[0,0,1] op_sel_hi:[1,1,1]
    v_pk_fma_f32 v[86:87], v[86:87], v[186:187], v[36:37] op_sel:[0,0,1] op_sel_hi:[1,1,1]
    v_pk_fma_f32 v[88:89], v[88:89], v[188:189], v[36:37] op_sel:[0,0,1] op_sel_hi:[1,1,1]
    v_pk_fma_f32 v[90:91], v[90:91], v[190:191], v[36:37] op_sel:[0,0,1] op_sel_hi:[1,1,1]
    v_pk_fma_f32 v[108:109], v[160:161], v[240:241], v[108:109] op_sel:[0,1,0] op_sel_hi:[1,1,1] neg_lo:[1,0,0] neg_hi:[1,0,0]
    v_pk_fma_f32 v[110:111], v[162:163], v[240:241], v[110:111] op_sel:[0,1,0] op_sel_hi:[1,1,1] neg_lo:[1,0,0] neg_hi:[1,0,0]
    v_pk_fma_f32 v[112:113], v[164:165], v[240:241], v[112:113] op_sel:[0,1,0] op_sel_hi:[1,1,1] neg_lo:[1,0,0] neg_hi:[1,0,0]
    v_pk_fma_f32 v[114:115], v[166:167], v[240:241], v[114:115] op_sel:[0,1,0] op_sel_hi:[1,1,1] neg_lo:[1,0,0] neg_hi:[1,0,0]
    v_pk_fma_f32 v[116:117], v[168:169], v[240:241], v[116:117] op_sel:[0,1,0] op_sel_hi:[1,1,1] neg_lo:[1,0,0] neg_hi:[1,0,0]
    v_pk_fma_f32 v[118:119], v[170:171], v[240:241], v[118:119] op_sel:[0,1,0] op_sel_hi:[1,1,1] neg_lo:[1,0,0] neg_hi:[1,0,0]
    v_pk_fma_f32 v[120:121], v[172:173], v[240:241], v[120:121] op_sel:[0,1,0] op_sel_hi:[1,1,1] neg_lo:[1,0,0] neg_hi:[1,0,0]
    v_pk_fma_f32 v[122:123], v[174:175], v[240:241], v[122:123] op_sel:[0,1,0] op_sel_hi:[1,1,1] neg_lo:[1,0,0] neg_hi:[1,0,0]
    v_pk_mul_f32 v[108:109], v[108:109], v[176:177]
    v_pk_mul_f32 v[110:111], v[110:111], v[178:179]
    v_pk_mul_f32 v[112:113], v[112:113], v[180:181]
    v_pk_mul_f32 v[114:115], v[114:115], v[182:183]
    v_pk_mul_f32 v[116:117], v[116:117], v[184:185]
    v_pk_mul_f32 v[118:119], v[118:119], v[186:187]
    v_pk_mul_f32 v[120:121], v[120:121], v[188:189]
    v_pk_mul_f32 v[122:123], v[122:123], v[190:191]
    ds_read_b128 v[160:163], v15 offset:128
    ds_read_b128 v[164:167], v15 offset:160
    ds_read_b128 v[168:171], v15 offset:192
    ds_read_b128 v[172:175], v15 offset:224
    ds_read_b128 v[176:179], v15 offset:384
    ds_read_b128 v[180:183], v15 offset:416
    ds_read_b128 v[184:187], v15 offset:448
    ds_read_b128 v[188:191], v15 offset:480
    v_exp_f32 v192, v76 clamp
    v_max_f32_e64 v76, v76, v37
    v_exp_f32 v193, v77 clamp
    v_max_f32_e64 v77, v77, v37
    v_exp_f32 v194, v78 clamp
    v_max_f32_e64 v78, v78, v37
    v_exp_f32 v195, v79 clamp
    v_max_f32_e64 v79, v79, v37
    v_exp_f32 v196, v80 clamp
    v_max_f32_e64 v80, v80, v37
    v_exp_f32 v197, v81 clamp
    v_max_f32_e64 v81, v81, v37
    v_exp_f32 v198, v82 clamp
    v_max_f32_e64 v82, v82, v37
    v_exp_f32 v199, v83 clamp
    v_max_f32_e64 v83, v83, v37
    v_exp_f32 v200, v84 clamp
    v_max_f32_e64 v84, v84, v37
    v_exp_f32 v201, v85 clamp
    v_max_f32_e64 v85, v85, v37
    v_exp_f32 v202, v86 clamp
    v_max_f32_e64 v86, v86, v37
    v_exp_f32 v203, v87 clamp
    v_max_f32_e64 v87, v87, v37
    v_exp_f32 v204, v88 clamp
    v_max_f32_e64 v88, v88, v37
    v_exp_f32 v205, v89 clamp
    v_max_f32_e64 v89, v89, v37
    v_exp_f32 v206, v90 clamp
    v_max_f32_e64 v90, v90, v37
    v_exp_f32 v207, v91 clamp
    v_max_f32_e64 v91, v91, v37
    v_pk_fma_f32 v[76:77], v[76:77], v[38:39], v[192:193] op_sel:[0,0,0] op_sel_hi:[1,0,1]
    v_pk_fma_f32 v[78:79], v[78:79], v[38:39], v[194:195] op_sel:[0,0,0] op_sel_hi:[1,0,1]
    v_pk_fma_f32 v[80:81], v[80:81], v[38:39], v[196:197] op_sel:[0,0,0] op_sel_hi:[1,0,1]
    v_pk_fma_f32 v[82:83], v[82:83], v[38:39], v[198:199] op_sel:[0,0,0] op_sel_hi:[1,0,1]
    v_pk_fma_f32 v[84:85], v[84:85], v[38:39], v[200:201] op_sel:[0,0,0] op_sel_hi:[1,0,1]
    v_pk_fma_f32 v[86:87], v[86:87], v[38:39], v[202:203] op_sel:[0,0,0] op_sel_hi:[1,0,1]
    v_pk_fma_f32 v[88:89], v[88:89], v[38:39], v[204:205] op_sel:[0,0,0] op_sel_hi:[1,0,1]
    v_pk_fma_f32 v[90:91], v[90:91], v[38:39], v[206:207] op_sel:[0,0,0] op_sel_hi:[1,0,1]
    v_cvt_pk_bf16_f32 v208, v76, v77
    v_cvt_pk_bf16_f32 v209, v78, v79
    v_cvt_pk_bf16_f32 v210, v80, v81
    v_cvt_pk_bf16_f32 v211, v82, v83
    v_cvt_pk_bf16_f32 v216, v108, v109
    v_cvt_pk_bf16_f32 v217, v110, v111
    v_cvt_pk_bf16_f32 v218, v112, v113
    v_cvt_pk_bf16_f32 v219, v114, v115
    v_cvt_pk_bf16_f32 v212, v84, v85
    v_cvt_pk_bf16_f32 v213, v86, v87
    v_cvt_pk_bf16_f32 v214, v88, v89
    v_cvt_pk_bf16_f32 v215, v90, v91
    v_cvt_pk_bf16_f32 v220, v116, v117
    v_cvt_pk_bf16_f32 v221, v118, v119
    v_cvt_pk_bf16_f32 v222, v120, v121
    v_cvt_pk_bf16_f32 v223, v122, v123
    s_waitcnt lgkmcnt(7)
    v_pk_fma_f32 v[92:93], v[160:161], v[240:241], v[92:93] op_sel:[0,0,0] op_sel_hi:[1,0,1] neg_lo:[1,0,0] neg_hi:[1,0,0]
    v_pk_fma_f32 v[94:95], v[162:163], v[240:241], v[94:95] op_sel:[0,0,0] op_sel_hi:[1,0,1] neg_lo:[1,0,0] neg_hi:[1,0,0]
    s_waitcnt lgkmcnt(6)
    v_pk_fma_f32 v[96:97], v[164:165], v[240:241], v[96:97] op_sel:[0,0,0] op_sel_hi:[1,0,1] neg_lo:[1,0,0] neg_hi:[1,0,0]
    v_pk_fma_f32 v[98:99], v[166:167], v[240:241], v[98:99] op_sel:[0,0,0] op_sel_hi:[1,0,1] neg_lo:[1,0,0] neg_hi:[1,0,0]
    s_waitcnt lgkmcnt(5)
    v_pk_fma_f32 v[100:101], v[168:169], v[240:241], v[100:101] op_sel:[0,0,0] op_sel_hi:[1,0,1] neg_lo:[1,0,0] neg_hi:[1,0,0]
    v_pk_fma_f32 v[102:103], v[170:171], v[240:241], v[102:103] op_sel:[0,0,0] op_sel_hi:[1,0,1] neg_lo:[1,0,0] neg_hi:[1,0,0]
    s_waitcnt lgkmcnt(4)
    v_pk_fma_f32 v[104:105], v[172:173], v[240:241], v[104:105] op_sel:[0,0,0] op_sel_hi:[1,0,1] neg_lo:[1,0,0] neg_hi:[1,0,0]
    v_pk_fma_f32 v[106:107], v[174:175], v[240:241], v[106:107] op_sel:[0,0,0] op_sel_hi:[1,0,1] neg_lo:[1,0,0] neg_hi:[1,0,0]
    s_waitcnt lgkmcnt(3)
    v_pk_fma_f32 v[92:93], v[92:93], v[176:177], v[36:37] op_sel:[0,0,1] op_sel_hi:[1,1,1]
    v_pk_fma_f32 v[94:95], v[94:95], v[178:179], v[36:37] op_sel:[0,0,1] op_sel_hi:[1,1,1]
    s_waitcnt lgkmcnt(2)
    v_pk_fma_f32 v[96:97], v[96:97], v[180:181], v[36:37] op_sel:[0,0,1] op_sel_hi:[1,1,1]
    v_pk_fma_f32 v[98:99], v[98:99], v[182:183], v[36:37] op_sel:[0,0,1] op_sel_hi:[1,1,1]
    s_waitcnt lgkmcnt(1)
    v_pk_fma_f32 v[100:101], v[100:101], v[184:185], v[36:37] op_sel:[0,0,1] op_sel_hi:[1,1,1]
    v_pk_fma_f32 v[102:103], v[102:103], v[186:187], v[36:37] op_sel:[0,0,1] op_sel_hi:[1,1,1]
    s_waitcnt lgkmcnt(0)
    v_pk_fma_f32 v[104:105], v[104:105], v[188:189], v[36:37] op_sel:[0,0,1] op_sel_hi:[1,1,1]
    v_pk_fma_f32 v[106:107], v[106:107], v[190:191], v[36:37] op_sel:[0,0,1] op_sel_hi:[1,1,1]
    v_pk_fma_f32 v[124:125], v[160:161], v[240:241], v[124:125] op_sel:[0,1,0] op_sel_hi:[1,1,1] neg_lo:[1,0,0] neg_hi:[1,0,0]
    v_pk_fma_f32 v[126:127], v[162:163], v[240:241], v[126:127] op_sel:[0,1,0] op_sel_hi:[1,1,1] neg_lo:[1,0,0] neg_hi:[1,0,0]
    v_pk_fma_f32 v[128:129], v[164:165], v[240:241], v[128:129] op_sel:[0,1,0] op_sel_hi:[1,1,1] neg_lo:[1,0,0] neg_hi:[1,0,0]
    v_pk_fma_f32 v[130:131], v[166:167], v[240:241], v[130:131] op_sel:[0,1,0] op_sel_hi:[1,1,1] neg_lo:[1,0,0] neg_hi:[1,0,0]
    v_pk_fma_f32 v[132:133], v[168:169], v[240:241], v[132:133] op_sel:[0,1,0] op_sel_hi:[1,1,1] neg_lo:[1,0,0] neg_hi:[1,0,0]
    v_pk_fma_f32 v[134:135], v[170:171], v[240:241], v[134:135] op_sel:[0,1,0] op_sel_hi:[1,1,1] neg_lo:[1,0,0] neg_hi:[1,0,0]
    v_pk_fma_f32 v[136:137], v[172:173], v[240:241], v[136:137] op_sel:[0,1,0] op_sel_hi:[1,1,1] neg_lo:[1,0,0] neg_hi:[1,0,0]
    v_pk_fma_f32 v[138:139], v[174:175], v[240:241], v[138:139] op_sel:[0,1,0] op_sel_hi:[1,1,1] neg_lo:[1,0,0] neg_hi:[1,0,0]
    v_pk_mul_f32 v[124:125], v[124:125], v[176:177]
    v_pk_mul_f32 v[126:127], v[126:127], v[178:179]
    v_pk_mul_f32 v[128:129], v[128:129], v[180:181]
    v_pk_mul_f32 v[130:131], v[130:131], v[182:183]
    v_pk_mul_f32 v[132:133], v[132:133], v[184:185]
    v_pk_mul_f32 v[134:135], v[134:135], v[186:187]
    v_pk_mul_f32 v[136:137], v[136:137], v[188:189]
    v_pk_mul_f32 v[138:139], v[138:139], v[190:191]
    ds_read_b128 v[160:163], v15 offset:512
    ds_read_b128 v[164:167], v15 offset:544
    ds_read_b128 v[168:171], v15 offset:576
    ds_read_b128 v[172:175], v15 offset:608
    v_mfma_f32_32x32x16_bf16 v[224:239], v[208:211], v[216:219], 0
    v_exp_f32 v192, v92 clamp
    v_max_f32_e64 v92, v92, v37
    v_exp_f32 v193, v93 clamp
    v_max_f32_e64 v93, v93, v37
    v_mfma_f32_32x32x16_bf16 v[224:239], v[212:215], v[220:223], v[224:239]
    v_exp_f32 v194, v94 clamp
    v_max_f32_e64 v94, v94, v37
    v_exp_f32 v195, v95 clamp
    v_max_f32_e64 v95, v95, v37
    v_exp_f32 v196, v96 clamp
    v_max_f32_e64 v96, v96, v37
    v_exp_f32 v197, v97 clamp
    v_max_f32_e64 v97, v97, v37
    v_exp_f32 v198, v98 clamp
    v_max_f32_e64 v98, v98, v37
    v_exp_f32 v199, v99 clamp
    v_max_f32_e64 v99, v99, v37
    v_exp_f32 v200, v100 clamp
    v_max_f32_e64 v100, v100, v37
    v_exp_f32 v201, v101 clamp
    v_max_f32_e64 v101, v101, v37
    v_exp_f32 v202, v102 clamp
    v_max_f32_e64 v102, v102, v37
    v_exp_f32 v203, v103 clamp
    v_max_f32_e64 v103, v103, v37
    v_exp_f32 v204, v104 clamp
    v_max_f32_e64 v104, v104, v37
    v_exp_f32 v205, v105 clamp
    v_max_f32_e64 v105, v105, v37
    v_exp_f32 v206, v106 clamp
    v_max_f32_e64 v106, v106, v37
    v_exp_f32 v207, v107 clamp
    v_max_f32_e64 v107, v107, v37
    v_pk_fma_f32 v[92:93], v[92:93], v[38:39], v[192:193] op_sel:[0,0,0] op_sel_hi:[1,0,1]
    v_pk_fma_f32 v[94:95], v[94:95], v[38:39], v[194:195] op_sel:[0,0,0] op_sel_hi:[1,0,1]
    v_pk_fma_f32 v[96:97], v[96:97], v[38:39], v[196:197] op_sel:[0,0,0] op_sel_hi:[1,0,1]
    v_pk_fma_f32 v[98:99], v[98:99], v[38:39], v[198:199] op_sel:[0,0,0] op_sel_hi:[1,0,1]
    v_pk_fma_f32 v[100:101], v[100:101], v[38:39], v[200:201] op_sel:[0,0,0] op_sel_hi:[1,0,1]
    v_pk_fma_f32 v[102:103], v[102:103], v[38:39], v[202:203] op_sel:[0,0,0] op_sel_hi:[1,0,1]
    v_pk_fma_f32 v[104:105], v[104:105], v[38:39], v[204:205] op_sel:[0,0,0] op_sel_hi:[1,0,1]
    v_pk_fma_f32 v[106:107], v[106:107], v[38:39], v[206:207] op_sel:[0,0,0] op_sel_hi:[1,0,1]
    v_pk_add_f32 v[244:245], v[76:77], v[78:79]
    v_pk_add_f32 v[244:245], v[244:245], v[80:81]
    v_pk_add_f32 v[244:245], v[244:245], v[82:83]
    v_pk_add_f32 v[244:245], v[244:245], v[84:85]
    v_pk_add_f32 v[244:245], v[244:245], v[86:87]
    v_pk_add_f32 v[244:245], v[244:245], v[88:89]
    v_pk_add_f32 v[244:245], v[244:245], v[90:91]
    v_pk_add_f32 v[244:245], v[244:245], v[92:93]
    v_pk_add_f32 v[244:245], v[244:245], v[94:95]
    v_pk_add_f32 v[244:245], v[244:245], v[96:97]
    v_pk_add_f32 v[244:245], v[244:245], v[98:99]
    v_cvt_pk_bf16_f32 v208, v92, v93
    v_cvt_pk_bf16_f32 v209, v94, v95
    v_cvt_pk_bf16_f32 v210, v96, v97
    v_cvt_pk_bf16_f32 v211, v98, v99
    v_cvt_pk_bf16_f32 v216, v124, v125
    v_cvt_pk_bf16_f32 v217, v126, v127
    v_cvt_pk_bf16_f32 v218, v128, v129
    v_cvt_pk_bf16_f32 v219, v130, v131
    s_nop 1
    v_mfma_f32_32x32x16_bf16 v[224:239], v[208:211], v[216:219], v[224:239]
    v_cvt_pk_bf16_f32 v212, v100, v101
    v_cvt_pk_bf16_f32 v213, v102, v103
    v_cvt_pk_bf16_f32 v214, v104, v105
    v_cvt_pk_bf16_f32 v215, v106, v107
    v_cvt_pk_bf16_f32 v220, v132, v133
    v_cvt_pk_bf16_f32 v221, v134, v135
    v_cvt_pk_bf16_f32 v222, v136, v137
    v_cvt_pk_bf16_f32 v223, v138, v139
    s_nop 1
    v_mfma_f32_32x32x16_bf16 v[224:239], v[212:215], v[220:223], v[224:239]
    v_add_f32 v244, v244, v100
    v_add_f32 v245, v245, v101
    v_add_f32 v244, v244, v102
    v_add_f32 v245, v245, v103
    v_add_f32 v244, v244, v104
    v_add_f32 v245, v245, v105
    v_add_f32 v244, v244, v106
    v_add_f32 v245, v245, v107
    v_add_f32_e64 v244, v244, v245
    ds_write_b32 v251, v244
    s_nop 1
    v_cndmask_b32 v224, v232, v224, s[72:73]
    v_cndmask_b32 v225, v233, v225, s[72:73]
    v_cndmask_b32 v226, v234, v226, s[72:73]
    v_cndmask_b32 v227, v235, v227, s[72:73]
    v_cndmask_b32 v228, v236, v228, s[72:73]
    v_cndmask_b32 v229, v237, v229, s[72:73]
    v_cndmask_b32 v230, v238, v230, s[72:73]
    v_cndmask_b32 v231, v239, v231, s[72:73]
    ds_write_b128 v250, v[224:227]
    ds_write_b128 v250, v[228:231] offset:1024
    s_waitcnt vmcnt(1)
    s_waitcnt lgkmcnt(0)
    s_barrier
    ds_read2st64_b32 v[176:177], v252 offset0:0 offset1:16
    ds_read2st64_b32 v[178:179], v252 offset0:4 offset1:20
    ds_read2st64_b32 v[180:181], v252 offset0:8 offset1:24
    ds_read2st64_b32 v[182:183], v252 offset0:12 offset1:28
    ds_read2st64_b32 v[184:185], v253 offset0:0 offset1:1
    ds_read2st64_b32 v[186:187], v253 offset0:2 offset1:3
    v_pk_fma_f32 v[44:45], v[246:247], v[160:161], v[44:45] op_sel:[0,0,0] op_sel_hi:[0,1,1] neg_lo:[1,0,0] neg_hi:[1,0,0]
    v_pk_fma_f32 v[46:47], v[246:247], v[162:163], v[46:47] op_sel:[0,0,0] op_sel_hi:[0,1,1] neg_lo:[1,0,0] neg_hi:[1,0,0]
    v_pk_fma_f32 v[48:49], v[246:247], v[164:165], v[48:49] op_sel:[0,0,0] op_sel_hi:[0,1,1] neg_lo:[1,0,0] neg_hi:[1,0,0]
    v_pk_fma_f32 v[50:51], v[246:247], v[166:167], v[50:51] op_sel:[0,0,0] op_sel_hi:[0,1,1] neg_lo:[1,0,0] neg_hi:[1,0,0]
    v_pk_fma_f32 v[52:53], v[246:247], v[168:169], v[52:53] op_sel:[0,0,0] op_sel_hi:[0,1,1] neg_lo:[1,0,0] neg_hi:[1,0,0]
    v_pk_fma_f32 v[54:55], v[246:247], v[170:171], v[54:55] op_sel:[0,0,0] op_sel_hi:[0,1,1] neg_lo:[1,0,0] neg_hi:[1,0,0]
    v_pk_fma_f32 v[56:57], v[246:247], v[172:173], v[56:57] op_sel:[0,0,0] op_sel_hi:[0,1,1] neg_lo:[1,0,0] neg_hi:[1,0,0]
    v_pk_fma_f32 v[58:59], v[246:247], v[174:175], v[58:59] op_sel:[0,0,0] op_sel_hi:[0,1,1] neg_lo:[1,0,0] neg_hi:[1,0,0]
    v_pk_fma_f32 v[44:45], v[44:45], v[246:247], v[36:37] op_sel:[0,1,1] op_sel_hi:[1,1,1]
    v_pk_fma_f32 v[46:47], v[46:47], v[246:247], v[36:37] op_sel:[0,1,1] op_sel_hi:[1,1,1]
    v_pk_fma_f32 v[48:49], v[48:49], v[246:247], v[36:37] op_sel:[0,1,1] op_sel_hi:[1,1,1]
    v_pk_fma_f32 v[50:51], v[50:51], v[246:247], v[36:37] op_sel:[0,1,1] op_sel_hi:[1,1,1]
    v_pk_fma_f32 v[52:53], v[52:53], v[246:247], v[36:37] op_sel:[0,1,1] op_sel_hi:[1,1,1]
    v_pk_fma_f32 v[54:55], v[54:55], v[246:247], v[36:37] op_sel:[0,1,1] op_sel_hi:[1,1,1]
    v_pk_fma_f32 v[56:57], v[56:57], v[246:247], v[36:37] op_sel:[0,1,1] op_sel_hi:[1,1,1]
    v_pk_fma_f32 v[58:59], v[58:59], v[246:247], v[36:37] op_sel:[0,1,1] op_sel_hi:[1,1,1]
    s_waitcnt lgkmcnt(5)
    v_add_f32 v176, v176, v177
    v_mul_f32_e64 v176, v176, v38
    buffer_atomic_add_f32 v176, v254, s[28:31], 0 offen offset:0
    s_waitcnt lgkmcnt(4)
    v_add_f32 v178, v178, v179
    v_mul_f32_e64 v178, v178, v38
    buffer_atomic_add_f32 v178, v254, s[28:31], 0 offen offset:1024
    s_waitcnt lgkmcnt(3)
    v_add_f32 v180, v180, v181
    v_mul_f32_e64 v180, v180, v38
    buffer_atomic_add_f32 v180, v254, s[28:31], 0 offen offset:2048
    s_waitcnt lgkmcnt(2)
    v_add_f32 v182, v182, v183
    v_mul_f32 v182, v182, v38
    buffer_atomic_add_f32 v182, v254, s[28:31], 0 offen offset:3072
    s_waitcnt lgkmcnt(0)
    v_pk_add_f32 v[184:185], v[184:185], v[186:187]
    v_add_f32_e64 v184, v184, v185
    s_cmp_lg_u32 s48, 0
    s_cbranch_scc1 L_noz
    buffer_atomic_add_f32 v184, v255, s[28:31], 0 offen
L_noz:
    v_exp_f32 v192, v44 clamp
    v_max_f32_e64 v44, v44, v37
    v_exp_f32 v193, v45 clamp
    v_max_f32_e64 v45, v45, v37
    v_exp_f32 v194, v46 clamp
    v_max_f32_e64 v46, v46, v37
    v_exp_f32 v195, v47 clamp
    v_max_f32_e64 v47, v47, v37
    v_exp_f32 v196, v48 clamp
    v_max_f32_e64 v48, v48, v37
    v_exp_f32 v197, v49 clamp
    v_max_f32_e64 v49, v49, v37
    v_exp_f32 v198, v50 clamp
    v_max_f32_e64 v50, v50, v37
    v_exp_f32 v199, v51 clamp
    v_max_f32_e64 v51, v51, v37
    v_exp_f32 v200, v52 clamp
    v_max_f32_e64 v52, v52, v37
    v_exp_f32 v201, v53 clamp
    v_max_f32_e64 v53, v53, v37
    v_exp_f32 v202, v54 clamp
    v_max_f32_e64 v54, v54, v37
    v_exp_f32 v203, v55 clamp
    v_max_f32_e64 v55, v55, v37
    v_exp_f32 v204, v56 clamp
    v_max_f32_e64 v56, v56, v37
    v_exp_f32 v205, v57 clamp
    v_max_f32_e64 v57, v57, v37
    v_exp_f32 v206, v58 clamp
    v_max_f32_e64 v58, v58, v37
    v_exp_f32 v207, v59 clamp
    v_max_f32_e64 v59, v59, v37
    v_pk_fma_f32 v[44:45], v[44:45], v[38:39], v[192:193] op_sel:[0,0,0] op_sel_hi:[1,0,1]
    v_pk_fma_f32 v[46:47], v[46:47], v[38:39], v[194:195] op_sel:[0,0,0] op_sel_hi:[1,0,1]
    v_pk_fma_f32 v[48:49], v[48:49], v[38:39], v[196:197] op_sel:[0,0,0] op_sel_hi:[1,0,1]
    v_pk_fma_f32 v[50:51], v[50:51], v[38:39], v[198:199] op_sel:[0,0,0] op_sel_hi:[1,0,1]
    v_pk_fma_f32 v[52:53], v[52:53], v[38:39], v[200:201] op_sel:[0,0,0] op_sel_hi:[1,0,1]
    v_pk_fma_f32 v[54:55], v[54:55], v[38:39], v[202:203] op_sel:[0,0,0] op_sel_hi:[1,0,1]
    v_pk_fma_f32 v[56:57], v[56:57], v[38:39], v[204:205] op_sel:[0,0,0] op_sel_hi:[1,0,1]
    v_pk_fma_f32 v[58:59], v[58:59], v[38:39], v[206:207] op_sel:[0,0,0] op_sel_hi:[1,0,1]
    v_cvt_pk_bf16_f32 v208, v44, v45
    v_cvt_pk_bf16_f32 v209, v46, v47
    v_cvt_pk_bf16_f32 v210, v48, v49
    v_cvt_pk_bf16_f32 v211, v50, v51
    v_cvt_pk_bf16_f32 v212, v52, v53
    v_cvt_pk_bf16_f32 v213, v54, v55
    v_cvt_pk_bf16_f32 v214, v56, v57
    v_cvt_pk_bf16_f32 v215, v58, v59
    buffer_store_dwordx4 v[208:211], v6, s[28:31], 0 offen offset:0 sc1
    buffer_store_dwordx4 v[212:215], v6, s[28:31], 0 offen offset:2048 sc1
    v_pk_fma_f32 v[60:61], v[248:249], v[160:161], v[60:61] op_sel:[0,0,0] op_sel_hi:[0,1,1] neg_lo:[1,0,0] neg_hi:[1,0,0]
    v_pk_fma_f32 v[62:63], v[248:249], v[162:163], v[62:63] op_sel:[0,0,0] op_sel_hi:[0,1,1] neg_lo:[1,0,0] neg_hi:[1,0,0]
    v_pk_fma_f32 v[64:65], v[248:249], v[164:165], v[64:65] op_sel:[0,0,0] op_sel_hi:[0,1,1] neg_lo:[1,0,0] neg_hi:[1,0,0]
    v_pk_fma_f32 v[66:67], v[248:249], v[166:167], v[66:67] op_sel:[0,0,0] op_sel_hi:[0,1,1] neg_lo:[1,0,0] neg_hi:[1,0,0]
    v_pk_fma_f32 v[68:69], v[248:249], v[168:169], v[68:69] op_sel:[0,0,0] op_sel_hi:[0,1,1] neg_lo:[1,0,0] neg_hi:[1,0,0]
    v_pk_fma_f32 v[70:71], v[248:249], v[170:171], v[70:71] op_sel:[0,0,0] op_sel_hi:[0,1,1] neg_lo:[1,0,0] neg_hi:[1,0,0]
    v_pk_fma_f32 v[72:73], v[248:249], v[172:173], v[72:73] op_sel:[0,0,0] op_sel_hi:[0,1,1] neg_lo:[1,0,0] neg_hi:[1,0,0]
    v_pk_fma_f32 v[74:75], v[248:249], v[174:175], v[74:75] op_sel:[0,0,0] op_sel_hi:[0,1,1] neg_lo:[1,0,0] neg_hi:[1,0,0]
    v_pk_fma_f32 v[60:61], v[60:61], v[248:249], v[36:37] op_sel:[0,1,1] op_sel_hi:[1,1,1]
    v_pk_fma_f32 v[62:63], v[62:63], v[248:249], v[36:37] op_sel:[0,1,1] op_sel_hi:[1,1,1]
    v_pk_fma_f32 v[64:65], v[64:65], v[248:249], v[36:37] op_sel:[0,1,1] op_sel_hi:[1,1,1]
    v_pk_fma_f32 v[66:67], v[66:67], v[248:249], v[36:37] op_sel:[0,1,1] op_sel_hi:[1,1,1]
    v_pk_fma_f32 v[68:69], v[68:69], v[248:249], v[36:37] op_sel:[0,1,1] op_sel_hi:[1,1,1]
    v_pk_fma_f32 v[70:71], v[70:71], v[248:249], v[36:37] op_sel:[0,1,1] op_sel_hi:[1,1,1]
    v_pk_fma_f32 v[72:73], v[72:73], v[248:249], v[36:37] op_sel:[0,1,1] op_sel_hi:[1,1,1]
    v_pk_fma_f32 v[74:75], v[74:75], v[248:249], v[36:37] op_sel:[0,1,1] op_sel_hi:[1,1,1]
    v_exp_f32 v192, v60 clamp
    v_max_f32_e64 v60, v60, v37
    v_exp_f32 v193, v61 clamp
    v_max_f32_e64 v61, v61, v37
    v_exp_f32 v194, v62 clamp
    v_max_f32_e64 v62, v62, v37
    v_exp_f32 v195, v63 clamp
    v_max_f32_e64 v63, v63, v37
    v_exp_f32 v196, v64 clamp
    v_max_f32_e64 v64, v64, v37
    v_exp_f32 v197, v65 clamp
    v_max_f32_e64 v65, v65, v37
    v_exp_f32 v198, v66 clamp
    v_max_f32_e64 v66, v66, v37
    v_exp_f32 v199, v67 clamp
    v_max_f32_e64 v67, v67, v37
    v_exp_f32 v200, v68 clamp
    v_max_f32_e64 v68, v68, v37
    v_exp_f32 v201, v69 clamp
    v_max_f32_e64 v69, v69, v37
    v_exp_f32 v202, v70 clamp
    v_max_f32_e64 v70, v70, v37
    v_exp_f32 v203, v71 clamp
    v_max_f32_e64 v71, v71, v37
    v_exp_f32 v204, v72 clamp
    v_max_f32_e64 v72, v72, v37
    v_exp_f32 v205, v73 clamp
    v_max_f32_e64 v73, v73, v37
    v_exp_f32 v206, v74 clamp
    v_max_f32_e64 v74, v74, v37
    v_exp_f32 v207, v75 clamp
    v_max_f32_e64 v75, v75, v37
    v_pk_fma_f32 v[60:61], v[60:61], v[38:39], v[192:193] op_sel:[0,0,0] op_sel_hi:[1,0,1]
    v_pk_fma_f32 v[62:63], v[62:63], v[38:39], v[194:195] op_sel:[0,0,0] op_sel_hi:[1,0,1]
    v_pk_fma_f32 v[64:65], v[64:65], v[38:39], v[196:197] op_sel:[0,0,0] op_sel_hi:[1,0,1]
    v_pk_fma_f32 v[66:67], v[66:67], v[38:39], v[198:199] op_sel:[0,0,0] op_sel_hi:[1,0,1]
    v_pk_fma_f32 v[68:69], v[68:69], v[38:39], v[200:201] op_sel:[0,0,0] op_sel_hi:[1,0,1]
    v_pk_fma_f32 v[70:71], v[70:71], v[38:39], v[202:203] op_sel:[0,0,0] op_sel_hi:[1,0,1]
    v_pk_fma_f32 v[72:73], v[72:73], v[38:39], v[204:205] op_sel:[0,0,0] op_sel_hi:[1,0,1]
    v_pk_fma_f32 v[74:75], v[74:75], v[38:39], v[206:207] op_sel:[0,0,0] op_sel_hi:[1,0,1]
    v_cvt_pk_bf16_f32 v216, v60, v61
    v_cvt_pk_bf16_f32 v217, v62, v63
    v_cvt_pk_bf16_f32 v218, v64, v65
    v_cvt_pk_bf16_f32 v219, v66, v67
    v_cvt_pk_bf16_f32 v220, v68, v69
    v_cvt_pk_bf16_f32 v221, v70, v71
    v_cvt_pk_bf16_f32 v222, v72, v73
    v_cvt_pk_bf16_f32 v223, v74, v75
    buffer_store_dwordx4 v[216:219], v6, s[28:31], 0 offen offset:1024 sc1
    buffer_store_dwordx4 v[220:223], v6, s[28:31], 0 offen offset:3072 sc1
    s_add_u32 m0, s64, 0xa000
    s_mov_b32 s62, 0x28000
    buffer_load_dwordx4 v28, s[16:19], s62 offen lds
    ds_read_b64_tr_b16 a[128:129], v150 offset:0
    ds_read_b64_tr_b16 a[130:131], v150 offset:1024
    ds_read_b64_tr_b16 a[132:133], v150 offset:4096
    ds_read_b64_tr_b16 a[134:135], v150 offset:5120
    buffer_load_dwordx4 v29, s[16:19], s62 offen offset:1024 lds
    ds_read_b64_tr_b16 a[136:137], v150 offset:8192
    ds_read_b64_tr_b16 a[138:139], v150 offset:9216
    ds_read_b64_tr_b16 a[140:141], v150 offset:12288
    ds_read_b64_tr_b16 a[142:143], v150 offset:13312
    s_add_u32 m0, s64, 0xc000
    s_mov_b32 s62, 0x30000
    buffer_load_dwordx4 v28, s[16:19], s62 offen lds
    ds_read_b64_tr_b16 a[144:145], v150 offset:16384
    ds_read_b64_tr_b16 a[146:147], v150 offset:17408
    ds_read_b64_tr_b16 a[148:149], v150 offset:20480
    ds_read_b64_tr_b16 a[150:151], v150 offset:21504
    buffer_load_dwordx4 v29, s[16:19], s62 offen offset:1024 lds
    ds_read_b64_tr_b16 a[152:153], v150 offset:24576
    ds_read_b64_tr_b16 a[154:155], v150 offset:25600
    ds_read_b64_tr_b16 a[156:157], v150 offset:28672
    ds_read_b64_tr_b16 a[158:159], v150 offset:29696
    s_add_u32 m0, s64, 0xe000
    s_mov_b32 s62, 0x38000
    buffer_load_dwordx4 v28, s[16:19], s62 offen lds
    ds_read_b64_tr_b16 a[160:161], v150 offset:32768
    ds_read_b64_tr_b16 a[162:163], v150 offset:33792
    ds_read_b64_tr_b16 a[164:165], v150 offset:36864
    ds_read_b64_tr_b16 a[166:167], v150 offset:37888
    buffer_load_dwordx4 v29, s[16:19], s62 offen offset:1024 lds
    ds_read_b64_tr_b16 a[208:209], v151 offset:16384
    ds_read_b64_tr_b16 a[210:211], v151 offset:17408
    ds_read_b64_tr_b16 a[212:213], v151 offset:20480
    ds_read_b64_tr_b16 a[214:215], v151 offset:21504
    s_add_u32 m0, s64, 0x10000
    s_mov_b32 s62, 0x40000
    buffer_load_dwordx4 v28, s[16:19], s62 offen lds
    ds_read_b64_tr_b16 a[216:217], v151 offset:24576
    ds_read_b64_tr_b16 a[218:219], v151 offset:25600
    ds_read_b64_tr_b16 a[220:221], v151 offset:28672
    ds_read_b64_tr_b16 a[222:223], v151 offset:29696
    buffer_load_dwordx4 v29, s[16:19], s62 offen offset:1024 lds
    ds_read_b64_tr_b16 a[224:225], v151 offset:32768
    ds_read_b64_tr_b16 a[226:227], v151 offset:33792
    ds_read_b64_tr_b16 a[228:229], v151 offset:36864
    ds_read_b64_tr_b16 a[230:231], v151 offset:37888
    s_add_u32 m0, s64, 0x12000
    s_mov_b32 s62, 0x48000
    buffer_load_dwordx4 v28, s[16:19], s62 offen lds
    ds_read_b64_tr_b16 a[232:233], v151 offset:40960
    ds_read_b64_tr_b16 a[234:235], v151 offset:41984
    ds_read_b64_tr_b16 a[236:237], v151 offset:45056
    ds_read_b64_tr_b16 a[238:239], v151 offset:46080
    buffer_load_dwordx4 v29, s[16:19], s62 offen offset:1024 lds
    ds_read_b64_tr_b16 a[240:241], v151 offset:49152
    ds_read_b64_tr_b16 a[242:243], v151 offset:50176
    ds_read_b64_tr_b16 a[244:245], v151 offset:53248
    ds_read_b64_tr_b16 a[246:247], v151 offset:54272
    ds_read_b64_tr_b16 a[248:249], v151 offset:57344
    ds_read_b64_tr_b16 a[250:251], v151 offset:58368
    ds_read_b64_tr_b16 a[252:253], v151 offset:61440
    ds_read_b64_tr_b16 a[254:255], v151 offset:62464
    s_lshl_b32 s56, s50, 4
    s_add_u32 s56, s56, s49
    s_lshl_b32 s56, s56, 6
    s_add_u32 s56, s56, 0x630000
    v_mov_b32 v9, s56
    s_mul_i32 s56, s48, 1835008
    s_lshl_b32 s57, s54, 7
    s_add_u32 s56, s56, s57
    v_lshrrev_b32_e64 v4, 3, v1
    v_mul_u32_u24 v4, 4096, v4
    v_add3_u32 v19, v4, v13, s56
    v_add_u32 v20, 0x7c00, v19
    s_waitcnt vmcnt(10)
    s_waitcnt lgkmcnt(0)
    s_barrier
    s_cmp_lg_u32 s48, 0
    s_cbranch_scc1 L_nf_f3
    buffer_store_dword v12, v9, s[28:31], 0 offen sc1
L_nf_f3:
    s_lshl_b32 s56, s48, 11
    s_add_u32 s56, s56, 0x630000
    v_lshl_add_u32 v11, v2, 6, s56
    v_bfe_u32 v4, v1, 1, 2
    v_and_b32_e64 v5, 1, v1
    v_lshl_or_b32 v4, v5, 2, v4
    s_add_u32 m0, s60, 0x18000
    s_mov_b32 s68, 0x0
    buffer_load_dwordx4 v19, s[24:27], s68 offen lds
    v_xor_b32 v4, v4, v3
    v_lshlrev_b32_e64 v4, 4, v4
    v_lshl_add_u32 v4, v2, 7, v4
    buffer_load_dwordx4 v20, s[24:27], s68 offen offset:1024 lds
    s_add_u32 s56, s60, 0x18000
    v_add_u32 v14, s56, v4
    v_xor_b32 v15, 32, v14
    v_xor_b32_e64 v16, 64, v14
    v_xor_b32 v17, 96, v14
    s_add_u32 m0, s60, 0x18800
    s_mov_b32 s68, 0x10000
    buffer_load_dwordx4 v19, s[24:27], s68 offen lds
    v_bfe_u32 v4, v1, 3, 2
    v_and_or_b32 v4, v1, 4, v4
    v_and_b32_e64 v5, 3, v1
    buffer_load_dwordx4 v20, s[24:27], s68 offen offset:1024 lds
    v_lshlrev_b32 v5, 1, v5
    v_xor_b32 v4, v4, v5
    v_lshlrev_b32 v4, 4, v4
    v_lshrrev_b32 v5, 2, v1
    v_lshl_add_u32 v4, v5, 7, v4
    s_add_u32 m0, s60, 0x19000
    s_mov_b32 s68, 0x20000
    buffer_load_dwordx4 v19, s[24:27], s68 offen lds
    s_add_u32 s56, s64, 0x18000
    v_add_u32 v18, s56, v4
    v_xor_b32 v26, 16, v18
    buffer_load_dwordx4 v20, s[24:27], s68 offen offset:1024 lds
    v_mov_b32 v42, 1.0
    s_lshl_b32 s56, s54, 3
    s_add_u32 s56, s56, s53
    s_lshl_b32 s56, s56, 13
    s_add_u32 s56, s56, 0x800000
    s_add_u32 m0, s60, 0x19800
    s_mov_b32 s68, 0x30000
    buffer_load_dwordx4 v19, s[24:27], s68 offen lds
    v_lshl_add_u32 v23, v0, 4, s56
    v_add_u32 v28, 0x1000, v23
    s_lshl_b32 s56, s54, 6
    buffer_load_dwordx4 v20, s[24:27], s68 offen offset:1024 lds
    v_lshrrev_b32 v4, 2, v0
    v_add_u32 v4, s56, v4
    v_and_b32 v5, 3, v1
    v_lshlrev_b32_e64 v5, 4, v5
    v_lshl_add_u32 v5, v4, 10, v5
    s_add_u32 m0, s60, 0x20000
    s_mov_b32 s68, 0x40000
    buffer_load_dwordx4 v19, s[24:27], s68 offen lds
    s_lshl_b32 s56, s53, 7
    v_add_u32 v6, s56, v5
    buffer_load_dwordx4 v[248:251], v6, s[8:11], 0 offen
    buffer_load_dwordx4 v20, s[24:27], s68 offen offset:1024 lds
    buffer_load_dwordx4 v[252:255], v6, s[8:11], 0 offen offset:64
    s_mul_i32 s56, s53, 229376
    s_mul_i32 s57, s48, 57344
    s_add_u32 s56, s56, s57
    s_add_u32 s56, s56, 0x200000
    s_add_u32 m0, s60, 0x20800
    s_mov_b32 s68, 0x50000
    buffer_load_dwordx4 v19, s[24:27], s68 offen lds
    v_lshl_add_u32 v29, v1, 4, s56
    s_lshl_b32 s56, s53, 4
    s_mul_i32 s57, s48, 7
    buffer_load_dwordx4 v20, s[24:27], s68 offen offset:1024 lds
    s_lshr_b32 s57, s57, 1
    s_add_u32 s56, s56, s57
    s_lshl_b32 s56, s56, 6
    s_add_u32 s56, s56, 0x628000
    v_lshrrev_b32 v4, 4, v1
    s_add_u32 m0, s60, 0x21000
    s_mov_b32 s68, 0x60000
    buffer_load_dwordx4 v19, s[24:27], s68 offen lds
    v_lshl_add_u32 v7, v4, 6, s56
    s_lshl_b32 s49, s7, 3
    s_add_u32 s49, s49, s4
    buffer_load_dwordx4 v20, s[24:27], s68 offen offset:1024 lds
    s_lshl_b32 s56, s49, 16
    s_lshl_b32 s57, s48, 14
    s_add_u32 s56, s56, s57
    s_add_u32 s56, s56, 0x400000
    v_lshl_add_u32 v21, v1, 4, s56
    s_waitcnt vmcnt(16)
    s_barrier
    ds_read_b64_tr_b16 a[168:169], v150 offset:40960
    ds_read_b64_tr_b16 a[170:171], v150 offset:41984
    ds_read_b64_tr_b16 a[172:173], v150 offset:45056
    ds_read_b64_tr_b16 a[174:175], v150 offset:46080
    ds_read_b64_tr_b16 a[176:177], v150 offset:49152
    ds_read_b64_tr_b16 a[178:179], v150 offset:50176
    ds_read_b64_tr_b16 a[180:181], v150 offset:53248
    ds_read_b64_tr_b16 a[182:183], v150 offset:54272
    ds_read_b64_tr_b16 a[184:185], v150 offset:57344
    ds_read_b64_tr_b16 a[186:187], v150 offset:58368
    ds_read_b64_tr_b16 a[188:189], v150 offset:61440
    ds_read_b64_tr_b16 a[190:191], v150 offset:62464
    ds_read_b64_tr_b16 a[192:193], v151 offset:0
    ds_read_b64_tr_b16 a[194:195], v151 offset:1024
    ds_read_b64_tr_b16 a[196:197], v151 offset:4096
    ds_read_b64_tr_b16 a[198:199], v151 offset:5120
    ds_read_b64_tr_b16 a[200:201], v151 offset:8192
    ds_read_b64_tr_b16 a[202:203], v151 offset:9216
    ds_read_b64_tr_b16 a[204:205], v151 offset:12288
    ds_read_b64_tr_b16 a[206:207], v151 offset:13312
    s_waitcnt vmcnt(14)
    ds_read_b64_tr_b16 a[64:65], v31 offset:32768
    ds_read_b64_tr_b16 a[66:67], v31 offset:33792
    ds_read_b64_tr_b16 a[68:69], v34 offset:32768
    ds_read_b64_tr_b16 a[70:71], v34 offset:33792
    s_add_u32 m0, s60, 0x21800
    s_mov_b32 s68, 0x70000
    buffer_load_dwordx4 v19, s[24:27], s68 offen lds
    s_add_u32 s56, s60, 0x600000
    buffer_load_dwordx4 v20, s[24:27], s68 offen offset:1024 lds
    s_waitcnt vmcnt(14)
    ds_read_b64_tr_b16 a[72:73], v31 offset:34816
    ds_read_b64_tr_b16 a[74:75], v31 offset:35840
    ds_read_b64_tr_b16 a[76:77], v34 offset:34816
    ds_read_b64_tr_b16 a[78:79], v34 offset:35840
    s_add_u32 m0, s60, 0x18000
    s_mov_b32 s68, 0x80000
    s_waitcnt lgkmcnt(4)
    buffer_load_dwordx4 v19, s[24:27], s68 offen lds
    v_lshl_add_u32 v22, v1, 4, s56
    buffer_load_dwordx4 v20, s[24:27], s68 offen offset:1024 lds
    s_waitcnt vmcnt(14)
    ds_read_b64_tr_b16 a[80:81], v31 offset:36864
    ds_read_b64_tr_b16 a[82:83], v31 offset:37888
    ds_read_b64_tr_b16 a[84:85], v34 offset:36864
    ds_read_b64_tr_b16 a[86:87], v34 offset:37888
    s_add_u32 m0, s60, 0x18800
    s_mov_b32 s68, 0x90000
    s_waitcnt lgkmcnt(4)
    buffer_load_dwordx4 v19, s[24:27], s68 offen lds
    s_lshl_b32 s56, s48, 9
    buffer_load_dwordx4 v20, s[24:27], s68 offen offset:1024 lds
    s_waitcnt vmcnt(14)
    ds_read_b64_tr_b16 a[88:89], v31 offset:38912
    ds_read_b64_tr_b16 a[90:91], v31 offset:39936
    ds_read_b64_tr_b16 a[92:93], v34 offset:38912
    ds_read_b64_tr_b16 a[94:95], v34 offset:39936
    s_add_u32 m0, s60, 0x19000
    s_mov_b32 s68, 0xa0000
    s_waitcnt lgkmcnt(4)
    buffer_load_dwordx4 v19, s[24:27], s68 offen lds
    s_add_u32 s56, s56, 0x608000
    buffer_load_dwordx4 v20, s[24:27], s68 offen offset:1024 lds
    s_waitcnt vmcnt(13)
    ds_read_b64_tr_b16 a[96:97], v32 offset:0
    ds_read_b64_tr_b16 a[98:99], v32 offset:1024
    ds_read_b64_tr_b16 a[100:101], v35 offset:0
    ds_read_b64_tr_b16 a[102:103], v35 offset:1024
    s_add_u32 m0, s60, 0x19800
    s_mov_b32 s68, 0xb0000
    s_waitcnt lgkmcnt(4)
    buffer_load_dwordx4 v19, s[24:27], s68 offen lds
    v_lshl_add_u32 v24, v1, 3, s56
    buffer_load_dwordx4 v20, s[24:27], s68 offen offset:1024 lds
    s_waitcnt vmcnt(12)
    ds_read_b64_tr_b16 a[104:105], v32 offset:2048
    ds_read_b64_tr_b16 a[106:107], v32 offset:3072
    ds_read_b64_tr_b16 a[108:109], v35 offset:2048
    ds_read_b64_tr_b16 a[110:111], v35 offset:3072
    s_add_u32 m0, s60, 0x20000
    s_mov_b32 s68, 0xc0000
    s_waitcnt lgkmcnt(4)
    buffer_load_dwordx4 v19, s[24:27], s68 offen lds
    v_lshlrev_b32_e64 v165, 4, v1
    buffer_load_dwordx4 v20, s[24:27], s68 offen offset:1024 lds
    v_add_u32 v165, 0x18000, v165
    v_add_u32_e64 v164, s60, v165
    s_add_u32 s56, s60, 0x20000
    v_lshl_add_u32 v167, v1, 2, s56
    v_bfe_u32 v4, v1, 4, 1
    v_xor_b32 v4, 1, v4
    v_lshlrev_b32 v4, 5, v4
    v_lshl_add_u32 v4, v3, 3, v4
    v_add_u32_e64 v166, s56, v4
    v_bfe_u32 v4, v1, 1, 2
    v_lshlrev_b32_e64 v4, 4, v4
    v_lshl_add_u32 v4, v2, 6, v4
    v_lshl_add_u32 v4, v3, 3, v4
    s_add_u32 s56, s60, 0x18000
    v_add_u32 v168, s56, v4
    v_xor_b32 v169, 16, v168
    v_xor_b32 v170, 32, v168
    v_xor_b32 v171, 48, v168
    v_bfe_u32 v4, v1, 3, 2
    v_xor_b32_e64 v4, v4, v1
    s_lshl_b32 s56, s49, 2
    s_add_u32 s56, s56, s3
    s_lshl_b32 s57, s56, 2
    s_add_u32 s57, s57, s48
    s_lshl_b32 s57, s57, 12
    s_add_u32 s57, s57, 0x800000
    v_lshl_add_u32 v25, v4, 4, s57
    s_lshl_b32 s56, s56, 6
    s_add_u32 s56, s56, 0x638000
    v_mov_b32 v9, s56
    buffer_load_dword v10, v11, s[28:31], 0 offen sc1
    s_waitcnt vmcnt(13)
    ds_read_b64_tr_b16 a[112:113], v32 offset:4096
    ds_read_b64_tr_b16 a[114:115], v32 offset:5120
    ds_read_b64_tr_b16 a[116:117], v35 offset:4096
    ds_read_b64_tr_b16 a[118:119], v35 offset:5120
    s_add_u32 m0, s60, 0x20800
    s_mov_b32 s68, 0xd0000
    s_waitcnt lgkmcnt(4)
    buffer_load_dwordx4 v19, s[24:27], s68 offen lds
    buffer_load_dwordx4 v20, s[24:27], s68 offen offset:1024 lds
    s_waitcnt vmcnt(13)
    ds_read_b64_tr_b16 a[120:121], v32 offset:6144
    ds_read_b64_tr_b16 a[122:123], v32 offset:7168
    ds_read_b64_tr_b16 a[124:125], v35 offset:6144
    ds_read_b64_tr_b16 a[126:127], v35 offset:7168
    s_add_u32 m0, s60, 0x21000
    s_mov_b32 s68, 0xe0000
    s_waitcnt lgkmcnt(4)
    buffer_load_dwordx4 v19, s[24:27], s68 offen lds
    buffer_load_dwordx4 v20, s[24:27], s68 offen offset:1024 lds
    s_waitcnt vmcnt(13)
    ds_read_b64_tr_b16 v[172:173], v31 offset:32768
    ds_read_b64_tr_b16 v[174:175], v31 offset:33792
    ds_read_b64_tr_b16 v[176:177], v34 offset:32768
    ds_read_b64_tr_b16 v[178:179], v34 offset:33792
    s_add_u32 m0, s60, 0x21800
    s_mov_b32 s68, 0xf0000
    s_waitcnt lgkmcnt(4)
    buffer_load_dwordx4 v19, s[24:27], s68 offen lds
    buffer_load_dwordx4 v20, s[24:27], s68 offen offset:1024 lds
    s_barrier
    s_waitcnt vmcnt(13)
    ds_read_b64_tr_b16 v[180:181], v31 offset:34816
    ds_read_b64_tr_b16 v[182:183], v31 offset:35840
    ds_read_b64_tr_b16 v[184:185], v34 offset:34816
    ds_read_b64_tr_b16 v[186:187], v34 offset:35840
    s_add_u32 m0, s60, 0x0
    s_mov_b32 s68, 0x100000
    buffer_load_dwordx4 v19, s[24:27], s68 offen lds
    buffer_load_dwordx4 v20, s[24:27], s68 offen offset:1024 lds
    s_waitcnt vmcnt(13)
    ds_read_b64_tr_b16 v[188:189], v31 offset:36864
    ds_read_b64_tr_b16 v[190:191], v31 offset:37888
    ds_read_b64_tr_b16 v[192:193], v34 offset:36864
    ds_read_b64_tr_b16 v[194:195], v34 offset:37888
    s_add_u32 m0, s60, 0x800
    s_mov_b32 s68, 0x110000
    buffer_load_dwordx4 v19, s[24:27], s68 offen lds
    buffer_load_dwordx4 v20, s[24:27], s68 offen offset:1024 lds
    s_waitcnt vmcnt(10)
    v_cmp_ne_u32_e64 vcc, 1, v10
    s_nop 0
    s_cbranch_vccnz L_slow_f3a
L_ok_f3a:
    buffer_load_dwordx2 v[240:241], v24, s[28:31], 0 offen sc1
    s_mov_b32 s63, 0x0
    buffer_load_dwordx4 v[76:79], v22, s[28:31], s63 offen offset:0 sc1
    s_mov_b32 s63, 0x0
    buffer_load_dwordx4 v[80:83], v22, s[28:31], s63 offen offset:1024 sc1
    s_mov_b32 s63, 0x0
    buffer_load_dwordx4 a[0:3], v21, s[28:31], s63 offen offset:0 sc1
    s_mov_b32 s63, 0x0
    buffer_load_dwordx4 a[8:11], v21, s[28:31], s63 offen offset:2048 sc1
    s_mov_b32 s63, 0x0
    buffer_load_dwordx4 v[84:87], v22, s[28:31], s63 offen offset:2048 sc1
    s_mov_b32 s63, 0x0
    buffer_load_dwordx4 v[88:91], v22, s[28:31], s63 offen offset:3072 sc1
    s_mov_b32 s63, 0x1000
    buffer_load_dwordx4 a[16:19], v21, s[28:31], s63 offen offset:0 sc1
    s_mov_b32 s63, 0x1000
    buffer_load_dwordx4 a[24:27], v21, s[28:31], s63 offen offset:2048 sc1
    s_mov_b32 s63, 0x1000
    buffer_load_dwordx4 v[92:95], v22, s[28:31], s63 offen offset:0 sc1
    s_mov_b32 s63, 0x1000
    buffer_load_dwordx4 v[96:99], v22, s[28:31], s63 offen offset:1024 sc1
    s_mov_b32 s63, 0x2000
    buffer_load_dwordx4 a[32:35], v21, s[28:31], s63 offen offset:0 sc1
    s_mov_b32 s63, 0x2000
    buffer_load_dwordx4 a[40:43], v21, s[28:31], s63 offen offset:2048 sc1
    ds_read_b64_tr_b16 v[196:197], v31 offset:38912
    ds_read_b64_tr_b16 v[198:199], v31 offset:39936
    ds_read_b64_tr_b16 v[200:201], v34 offset:38912
    ds_read_b64_tr_b16 v[202:203], v34 offset:39936
    ds_read_b64_tr_b16 v[204:205], v32 offset:0
    ds_read_b64_tr_b16 v[206:207], v32 offset:1024
    ds_read_b64_tr_b16 v[208:209], v35 offset:0
    ds_read_b64_tr_b16 v[210:211], v35 offset:1024
    s_waitcnt vmcnt(21)
    ds_read_b64_tr_b16 v[212:213], v32 offset:2048
    ds_read_b64_tr_b16 v[214:215], v32 offset:3072
    ds_read_b64_tr_b16 v[216:217], v35 offset:2048
    ds_read_b64_tr_b16 v[218:219], v35 offset:3072
    s_waitcnt vmcnt(19)
    ds_read_b64_tr_b16 v[220:221], v32 offset:4096
    ds_read_b64_tr_b16 v[222:223], v32 offset:5120
    ds_read_b64_tr_b16 v[224:225], v35 offset:4096
    ds_read_b64_tr_b16 v[226:227], v35 offset:5120
    s_waitcnt vmcnt(17)
    ds_read_b64_tr_b16 v[228:229], v32 offset:6144
    ds_read_b64_tr_b16 v[230:231], v32 offset:7168
    ds_read_b64_tr_b16 v[232:233], v35 offset:6144
    ds_read_b64_tr_b16 v[234:235], v35 offset:7168
    s_getpc_b64 s[0:1]
L_ct_b:
    s_lshr_b32 s70, s2, 3
    s_lshl_b32 s70, s70, 9
    s_min_u32 s70, s70, L_last - L_ct_b - 520
    v_and_b32 v8, 0xc0, v0
    v_lshl_add_u32 v8, v8, 1, s70
    global_load_dword v8, v8, s[0:1]
    v_mov_b32 v11, v7
    s_waitcnt vmcnt(13)
    v_cvt_pk_bf16_f32 v240, v240, v241
    ds_write_b32 v167, v240
    ds_read2_b64 v[108:111], v166 offset0:0 offset1:2
    ds_read2_b64 v[112:115], v166 offset0:8 offset1:10
    ds_read2_b64 v[116:119], v166 offset0:16 offset1:18
    ds_read2_b64 v[120:123], v166 offset0:24 offset1:26
    s_waitcnt vmcnt(12)
    v_cvt_pk_bf16_f32 v76, v76, v77
    v_cvt_pk_bf16_f32 v77, v78, v79
    s_waitcnt vmcnt(11)
    v_cvt_pk_bf16_f32 v78, v80, v81
    v_cvt_pk_bf16_f32 v79, v82, v83
    s_waitcnt lgkmcnt(3)
    v_cndmask_b32 v44, v108, v76, s[72:73]
    v_cndmask_b32 v45, v109, v77, s[72:73]
    v_cndmask_b32 v46, v110, v78, s[72:73]
    v_cndmask_b32 v47, v111, v79, s[72:73]
    v_cndmask_b32 v48, v76, v108, s[72:73]
    v_cndmask_b32 v49, v77, v109, s[72:73]
    v_cndmask_b32 v50, v78, v110, s[72:73]
    v_cndmask_b32 v51, v79, v111, s[72:73]
    s_waitcnt vmcnt(10)
    v_mfma_f32_32x32x16_bf16 v[124:139], v[44:47], a[0:3], 0
    s_waitcnt vmcnt(9)
    v_mfma_f32_32x32x16_bf16 v[140:155], v[48:51], a[8:11], 0
    s_mov_b32 s63, 0x1000
    buffer_load_dwordx4 v[100:103], v22, s[28:31], s63 offen offset:2048 sc1
    s_mov_b32 s63, 0x1000
    buffer_load_dwordx4 v[104:107], v22, s[28:31], s63 offen offset:3072 sc1
    s_mov_b32 s63, 0x3000
    buffer_load_dwordx4 a[48:51], v21, s[28:31], s63 offen offset:0 sc1
    s_waitcnt vmcnt(11)
    v_cvt_pk_bf16_f32 v84, v84, v85
    v_cvt_pk_bf16_f32 v85, v86, v87
    s_waitcnt vmcnt(10)
    v_cvt_pk_bf16_f32 v86, v88, v89
    v_cvt_pk_bf16_f32 v87, v90, v91
    s_waitcnt lgkmcnt(2)
    v_cndmask_b32 v52, v112, v84, s[72:73]
    v_cndmask_b32 v53, v113, v85, s[72:73]
    v_cndmask_b32 v54, v114, v86, s[72:73]
    v_cndmask_b32 v55, v115, v87, s[72:73]
    v_cndmask_b32 v56, v84, v112, s[72:73]
    v_cndmask_b32 v57, v85, v113, s[72:73]
    v_cndmask_b32 v58, v86, v114, s[72:73]
    v_cndmask_b32 v59, v87, v115, s[72:73]
    v_add_f32_e64 v132, v36, v132
    v_rcp_f32 v132, v132
    s_nop 0
    v_pk_mul_f32 v[124:125], v[124:125], v[132:133] op_sel:[0,0] op_sel_hi:[1,0]
    v_pk_mul_f32 v[126:127], v[126:127], v[132:133] op_sel:[0,0] op_sel_hi:[1,0]
    v_pk_mul_f32 v[128:129], v[128:129], v[132:133] op_sel:[0,0] op_sel_hi:[1,0]
    v_pk_mul_f32 v[130:131], v[130:131], v[132:133] op_sel:[0,0] op_sel_hi:[1,0]
    v_cvt_pk_bf16_f32 v156, v124, v125
    v_cvt_pk_bf16_f32 v157, v126, v127
    v_cvt_pk_bf16_f32 v158, v128, v129
    v_cvt_pk_bf16_f32 v159, v130, v131
    s_waitcnt vmcnt(9)
    v_mfma_f32_32x32x16_bf16 v[124:139], v[52:55], a[16:19], 0
    s_mov_b32 s63, 0x3000
    buffer_load_dwordx4 a[56:59], v21, s[28:31], s63 offen offset:2048 sc1
    s_mov_b32 s63, 0x0
    buffer_load_dwordx4 a[4:7], v21, s[28:31], s63 offen offset:1024 sc1
    ds_write_b128 v164, v[156:159] offset:0
    v_add_f32_e64 v140, v36, v140
    v_rcp_f32 v140, v140
    s_nop 0
    v_pk_mul_f32 v[148:149], v[148:149], v[140:141] op_sel:[0,0] op_sel_hi:[1,0]
    v_pk_mul_f32 v[150:151], v[150:151], v[140:141] op_sel:[0,0] op_sel_hi:[1,0]
    v_pk_mul_f32 v[152:153], v[152:153], v[140:141] op_sel:[0,0] op_sel_hi:[1,0]
    v_pk_mul_f32 v[154:155], v[154:155], v[140:141] op_sel:[0,0] op_sel_hi:[1,0]
    v_cvt_pk_bf16_f32 v160, v148, v149
    v_cvt_pk_bf16_f32 v161, v150, v151
    v_cvt_pk_bf16_f32 v162, v152, v153
    v_cvt_pk_bf16_f32 v163, v154, v155
    s_waitcnt vmcnt(10)
    v_mfma_f32_32x32x16_bf16 v[140:155], v[56:59], a[24:27], 0
    s_mov_b32 s63, 0x0
    buffer_load_dwordx4 a[12:15], v21, s[28:31], s63 offen offset:3072 sc1
    s_mov_b32 s63, 0x1000
    buffer_load_dwordx4 a[20:23], v21, s[28:31], s63 offen offset:1024 sc1
    ds_write_b128 v164, v[160:163] offset:1024
    s_waitcnt vmcnt(11)
    v_cvt_pk_bf16_f32 v92, v92, v93
    v_cvt_pk_bf16_f32 v93, v94, v95
    s_waitcnt vmcnt(10)
    v_cvt_pk_bf16_f32 v94, v96, v97
    v_cvt_pk_bf16_f32 v95, v98, v99
    s_waitcnt lgkmcnt(3)
    v_cndmask_b32 v60, v116, v92, s[72:73]
    v_cndmask_b32 v61, v117, v93, s[72:73]
    v_cndmask_b32 v62, v118, v94, s[72:73]
    v_cndmask_b32 v63, v119, v95, s[72:73]
    v_cndmask_b32 v64, v92, v116, s[72:73]
    v_cndmask_b32 v65, v93, v117, s[72:73]
    v_cndmask_b32 v66, v94, v118, s[72:73]
    v_cndmask_b32 v67, v95, v119, s[72:73]
    v_add_f32 v132, v36, v132
    v_rcp_f32 v132, v132
    s_nop 0
    v_pk_mul_f32 v[124:125], v[124:125], v[132:133] op_sel:[0,0] op_sel_hi:[1,0]
    v_pk_mul_f32 v[126:127], v[126:127], v[132:133] op_sel:[0,0] op_sel_hi:[1,0]
    v_pk_mul_f32 v[128:129], v[128:129], v[132:133] op_sel:[0,0] op_sel_hi:[1,0]
    v_pk_mul_f32 v[130:131], v[130:131], v[132:133] op_sel:[0,0] op_sel_hi:[1,0]
    v_cvt_pk_bf16_f32 v156, v124, v125
    v_cvt_pk_bf16_f32 v157, v126, v127
    v_cvt_pk_bf16_f32 v158, v128, v129
    v_cvt_pk_bf16_f32 v159, v130, v131
    s_waitcnt vmcnt(9)
    v_mfma_f32_32x32x16_bf16 v[124:139], v[60:63], a[32:35], 0
    s_mov_b32 s63, 0x1000
    buffer_load_dwordx4 a[28:31], v21, s[28:31], s63 offen offset:3072 sc1
    s_mov_b32 s63, 0x2000
    buffer_load_dwordx4 a[36:39], v21, s[28:31], s63 offen offset:1024 sc1
    ds_write_b128 v164, v[156:159] offset:2048
    v_add_f32 v140, v36, v140
    v_rcp_f32 v140, v140
    s_nop 0
    v_pk_mul_f32 v[148:149], v[148:149], v[140:141] op_sel:[0,0] op_sel_hi:[1,0]
    v_pk_mul_f32 v[150:151], v[150:151], v[140:141] op_sel:[0,0] op_sel_hi:[1,0]
    v_pk_mul_f32 v[152:153], v[152:153], v[140:141] op_sel:[0,0] op_sel_hi:[1,0]
    v_pk_mul_f32 v[154:155], v[154:155], v[140:141] op_sel:[0,0] op_sel_hi:[1,0]
    v_cvt_pk_bf16_f32 v160, v148, v149
    v_cvt_pk_bf16_f32 v161, v150, v151
    v_cvt_pk_bf16_f32 v162, v152, v153
    v_cvt_pk_bf16_f32 v163, v154, v155
    s_waitcnt vmcnt(10)
    v_mfma_f32_32x32x16_bf16 v[140:155], v[64:67], a[40:43], 0
    s_mov_b32 s63, 0x2000
    buffer_load_dwordx4 a[44:47], v21, s[28:31], s63 offen offset:3072 sc1
    s_mov_b32 s63, 0x3000
    buffer_load_dwordx4 a[52:55], v21, s[28:31], s63 offen offset:1024 sc1
    ds_write_b128 v164, v[160:163] offset:3072
    s_waitcnt vmcnt(10)
    v_cvt_pk_bf16_f32 v100, v100, v101
    v_cvt_pk_bf16_f32 v101, v102, v103
    s_waitcnt vmcnt(9)
    v_cvt_pk_bf16_f32 v102, v104, v105
    v_cvt_pk_bf16_f32 v103, v106, v107
    s_waitcnt lgkmcnt(4)
    v_cndmask_b32 v68, v120, v100, s[72:73]
    v_cndmask_b32 v69, v121, v101, s[72:73]
    v_cndmask_b32 v70, v122, v102, s[72:73]
    v_cndmask_b32 v71, v123, v103, s[72:73]
    v_cndmask_b32 v72, v100, v120, s[72:73]
    v_cndmask_b32 v73, v101, v121, s[72:73]
    v_cndmask_b32 v74, v102, v122, s[72:73]
    v_cndmask_b32 v75, v103, v123, s[72:73]
    v_add_f32_e64 v132, v36, v132
    v_rcp_f32 v132, v132
    s_nop 0
    v_pk_mul_f32 v[124:125], v[124:125], v[132:133] op_sel:[0,0] op_sel_hi:[1,0]
    v_pk_mul_f32 v[126:127], v[126:127], v[132:133] op_sel:[0,0] op_sel_hi:[1,0]
    v_pk_mul_f32 v[128:129], v[128:129], v[132:133] op_sel:[0,0] op_sel_hi:[1,0]
    v_pk_mul_f32 v[130:131], v[130:131], v[132:133] op_sel:[0,0] op_sel_hi:[1,0]
    v_cvt_pk_bf16_f32 v156, v124, v125
    v_cvt_pk_bf16_f32 v157, v126, v127
    v_cvt_pk_bf16_f32 v158, v128, v129
    v_cvt_pk_bf16_f32 v159, v130, v131
    s_waitcnt vmcnt(8)
    v_mfma_f32_32x32x16_bf16 v[124:139], v[68:71], a[48:51], 0
    s_mov_b32 s63, 0x3000
    buffer_load_dwordx4 a[60:63], v21, s[28:31], s63 offen offset:3072 sc1
    ds_write_b128 v164, v[156:159] offset:4096
    v_add_f32 v140, v36, v140
    v_rcp_f32 v140, v140
    s_nop 0
    v_pk_mul_f32 v[148:149], v[148:149], v[140:141] op_sel:[0,0] op_sel_hi:[1,0]
    v_pk_mul_f32 v[150:151], v[150:151], v[140:141] op_sel:[0,0] op_sel_hi:[1,0]
    v_pk_mul_f32 v[152:153], v[152:153], v[140:141] op_sel:[0,0] op_sel_hi:[1,0]
    v_pk_mul_f32 v[154:155], v[154:155], v[140:141] op_sel:[0,0] op_sel_hi:[1,0]
    v_cvt_pk_bf16_f32 v160, v148, v149
    v_cvt_pk_bf16_f32 v161, v150, v151
    v_cvt_pk_bf16_f32 v162, v152, v153
    v_cvt_pk_bf16_f32 v163, v154, v155
    s_waitcnt vmcnt(8)
    v_mfma_f32_32x32x16_bf16 v[140:155], v[72:75], a[56:59], 0
    ds_write_b128 v164, v[160:163] offset:5120
    v_add_f32 v132, v36, v132
    v_rcp_f32 v132, v132
    s_nop 0
    v_pk_mul_f32 v[124:125], v[124:125], v[132:133] op_sel:[0,0] op_sel_hi:[1,0]
    v_pk_mul_f32 v[126:127], v[126:127], v[132:133] op_sel:[0,0] op_sel_hi:[1,0]
    v_pk_mul_f32 v[128:129], v[128:129], v[132:133] op_sel:[0,0] op_sel_hi:[1,0]
    v_pk_mul_f32 v[130:131], v[130:131], v[132:133] op_sel:[0,0] op_sel_hi:[1,0]
    v_cvt_pk_bf16_f32 v156, v124, v125
    v_cvt_pk_bf16_f32 v157, v126, v127
    v_cvt_pk_bf16_f32 v158, v128, v129
    v_cvt_pk_bf16_f32 v159, v130, v131
    s_waitcnt vmcnt(7)
    v_mfma_f32_32x32x16_bf16 v[124:139], v[44:47], a[4:7], 0
    ds_write_b128 v164, v[156:159] offset:6144
    v_add_f32 v140, v36, v140
    v_rcp_f32 v140, v140
    s_nop 0
    v_pk_mul_f32 v[148:149], v[148:149], v[140:141] op_sel:[0,0] op_sel_hi:[1,0]
    v_pk_mul_f32 v[150:151], v[150:151], v[140:141] op_sel:[0,0] op_sel_hi:[1,0]
    v_pk_mul_f32 v[152:153], v[152:153], v[140:141] op_sel:[0,0] op_sel_hi:[1,0]
    v_pk_mul_f32 v[154:155], v[154:155], v[140:141] op_sel:[0,0] op_sel_hi:[1,0]
    v_cvt_pk_bf16_f32 v160, v148, v149
    v_cvt_pk_bf16_f32 v161, v150, v151
    v_cvt_pk_bf16_f32 v162, v152, v153
    v_cvt_pk_bf16_f32 v163, v154, v155
    s_waitcnt vmcnt(6)
    v_mfma_f32_32x32x16_bf16 v[140:155], v[48:51], a[12:15], 0
    ds_write_b128 v164, v[160:163] offset:7168
    s_waitcnt lgkmcnt(0)
    s_barrier
    ds_read_b128 v[92:95], v165 offset:0
    ds_read_b128 v[96:99], v165 offset:1024
    ds_read_b128 v[100:103], v165 offset:2048
    ds_read_b128 v[104:107], v165 offset:3072
    ds_read_b128 v[108:111], v165 offset:4096
    ds_read_b128 v[112:115], v165 offset:5120
    ds_read_b128 v[116:119], v165 offset:6144
    s_waitcnt lgkmcnt(6)
    v_mfma_f32_32x32x16_bf16 v[76:91], a[128:131], v[92:95], 0
    ds_read_b128 v[120:123], v165 offset:7168
    v_add_f32_e64 v132, v36, v132
    v_rcp_f32 v132, v132
    s_nop 0
    v_mul_f32 v124, v124, v132
    s_waitcnt lgkmcnt(6)
    v_mfma_f32_32x32x16_bf16 v[76:91], a[132:135], v[96:99], v[76:91]
    ds_read_b128 v[92:95], v165 offset:8192
    v_mul_f32 v125, v125, v132
    v_mul_f32 v126, v126, v132
    v_mul_f32_e64 v127, v127, v132
    v_mul_f32 v128, v128, v132
    s_waitcnt lgkmcnt(6)
    v_mfma_f32_32x32x16_bf16 v[76:91], a[136:139], v[100:103], v[76:91]
    ds_read_b128 v[96:99], v165 offset:9216
    v_mul_f32 v129, v129, v132
    v_mul_f32 v130, v130, v132
    v_mul_f32_e64 v131, v131, v132
    v_cvt_pk_bf16_f32 v156, v124, v125
    s_waitcnt lgkmcnt(6)
    v_mfma_f32_32x32x16_bf16 v[76:91], a[140:143], v[104:107], v[76:91]
    ds_read_b128 v[100:103], v165 offset:10240
    s_add_u32 m0, s60, 0x1000
    s_mov_b32 s68, 0x120000
    buffer_load_dwordx4 v19, s[24:27], s68 offen lds
    s_waitcnt lgkmcnt(6)
    v_mfma_f32_32x32x16_bf16 v[76:91], a[144:147], v[108:111], v[76:91]
    ds_read_b128 v[104:107], v165 offset:11264
    v_cvt_pk_bf16_f32 v157, v126, v127
    v_cvt_pk_bf16_f32 v158, v128, v129
    v_cvt_pk_bf16_f32 v159, v130, v131
    s_waitcnt vmcnt(6)
    v_mfma_f32_32x32x16_bf16 v[124:139], v[52:55], a[20:23], 0
    ds_write_b128 v164, v[156:159] offset:32768
    s_waitcnt lgkmcnt(7)
    v_mfma_f32_32x32x16_bf16 v[76:91], a[148:151], v[112:115], v[76:91]
    ds_read_b128 v[108:111], v165 offset:12288
    v_add_f32_e64 v140, v36, v140
    v_rcp_f32 v140, v140
    s_nop 0
    v_mul_f32 v148, v148, v140
    s_waitcnt lgkmcnt(7)
    v_mfma_f32_32x32x16_bf16 v[76:91], a[152:155], v[116:119], v[76:91]
    ds_read_b128 v[112:115], v165 offset:13312
    v_mul_f32 v149, v149, v140
    v_mul_f32 v150, v150, v140
    v_mul_f32_e64 v151, v151, v140
    v_mul_f32 v152, v152, v140
    s_waitcnt lgkmcnt(7)
    v_mfma_f32_32x32x16_bf16 v[76:91], a[156:159], v[120:123], v[76:91]
    ds_read_b128 v[116:119], v165 offset:14336
    buffer_load_dwordx4 v20, s[24:27], s68 offen offset:1024 lds
    s_waitcnt lgkmcnt(7)
    v_mfma_f32_32x32x16_bf16 v[76:91], a[160:163], v[92:95], v[76:91]
    ds_read_b128 v[120:123], v165 offset:15360
    v_mul_f32 v153, v153, v140
    v_mul_f32_e64 v154, v154, v140
    v_mul_f32 v155, v155, v140
    v_cvt_pk_bf16_f32 v160, v148, v149
    s_waitcnt lgkmcnt(7)
    v_mfma_f32_32x32x16_bf16 v[76:91], a[164:167], v[96:99], v[76:91]
    ds_read_b128 v[92:95], v165 offset:16384
    v_cvt_pk_bf16_f32 v161, v150, v151
    v_cvt_pk_bf16_f32 v162, v152, v153
    v_cvt_pk_bf16_f32 v163, v154, v155
    s_waitcnt vmcnt(6)
    v_mfma_f32_32x32x16_bf16 v[140:155], v[56:59], a[28:31], 0
    ds_write_b128 v164, v[160:163] offset:33792
    s_waitcnt lgkmcnt(8)
    v_mfma_f32_32x32x16_bf16 v[76:91], a[168:171], v[100:103], v[76:91]
    ds_read_b128 v[96:99], v165 offset:17408
    v_add_f32_e64 v132, v36, v132
    v_rcp_f32 v132, v132
    s_nop 0
    v_mul_f32 v124, v124, v132
    s_waitcnt lgkmcnt(8)
    v_mfma_f32_32x32x16_bf16 v[76:91], a[172:175], v[104:107], v[76:91]
    ds_read_b128 v[100:103], v165 offset:18432
    s_add_u32 m0, s60, 0x1800
    s_mov_b32 s68, 0x130000
    buffer_load_dwordx4 v19, s[24:27], s68 offen lds
    s_waitcnt lgkmcnt(7)
    v_mfma_f32_32x32x16_bf16 v[76:91], a[176:179], v[108:111], v[76:91]
    ds_read_b128 v[104:107], v165 offset:19456
    v_mul_f32 v125, v125, v132
    v_mul_f32 v126, v126, v132
    v_mul_f32 v127, v127, v132
    v_mul_f32 v128, v128, v132
    s_waitcnt lgkmcnt(7)
    v_mfma_f32_32x32x16_bf16 v[76:91], a[180:183], v[112:115], v[76:91]
    ds_read_b128 v[108:111], v165 offset:20480
    v_mul_f32 v129, v129, v132
    v_mul_f32 v130, v130, v132
    v_mul_f32 v131, v131, v132
    v_cvt_pk_bf16_f32 v156, v124, v125
    s_waitcnt lgkmcnt(7)
    v_mfma_f32_32x32x16_bf16 v[76:91], a[184:187], v[116:119], v[76:91]
    ds_read_b128 v[112:115], v165 offset:21504
    v_cvt_pk_bf16_f32 v157, v126, v127
    v_cvt_pk_bf16_f32 v158, v128, v129
    v_cvt_pk_bf16_f32 v159, v130, v131
    s_waitcnt vmcnt(6)
    v_mfma_f32_32x32x16_bf16 v[124:139], v[60:63], a[36:39], 0
    ds_write_b128 v164, v[156:159] offset:34816
    s_waitcnt lgkmcnt(8)
    v_mfma_f32_32x32x16_bf16 v[76:91], a[188:191], v[120:123], v[76:91]
    ds_read_b128 v[116:119], v165 offset:22528
    buffer_load_dwordx4 v20, s[24:27], s68 offen offset:1024 lds
    s_waitcnt lgkmcnt(8)
    v_mfma_f32_32x32x16_bf16 v[76:91], a[192:195], v[92:95], v[76:91]
    ds_read_b128 v[120:123], v165 offset:23552
    v_add_f32 v140, v36, v140
    v_rcp_f32 v140, v140
    s_nop 0
    v_mul_f32 v148, v148, v140
    s_waitcnt lgkmcnt(7)
    v_mfma_f32_32x32x16_bf16 v[76:91], a[196:199], v[96:99], v[76:91]
    ds_read_b128 v[92:95], v165 offset:24576
    v_mul_f32 v149, v149, v140
    v_mul_f32 v150, v150, v140
    v_mul_f32_e64 v151, v151, v140
    v_mul_f32 v152, v152, v140
    s_waitcnt lgkmcnt(7)
    v_mfma_f32_32x32x16_bf16 v[76:91], a[200:203], v[100:103], v[76:91]
    ds_read_b128 v[96:99], v165 offset:25600
    v_mul_f32 v153, v153, v140
    v_mul_f32 v154, v154, v140
    v_mul_f32_e64 v155, v155, v140
    v_cvt_pk_bf16_f32 v160, v148, v149
    s_waitcnt lgkmcnt(7)
    v_mfma_f32_32x32x16_bf16 v[76:91], a[204:207], v[104:107], v[76:91]
    ds_read_b128 v[100:103], v165 offset:26624
    s_add_u32 m0, s60, 0x8000
    s_mov_b32 s68, 0x140000
    buffer_load_dwordx4 v19, s[24:27], s68 offen lds
    s_waitcnt lgkmcnt(7)
    v_mfma_f32_32x32x16_bf16 v[76:91], a[208:211], v[108:111], v[76:91]
    ds_read_b128 v[104:107], v165 offset:27648
    v_cvt_pk_bf16_f32 v161, v150, v151
    v_cvt_pk_bf16_f32 v162, v152, v153
    v_cvt_pk_bf16_f32 v163, v154, v155
    s_waitcnt vmcnt(7)
    v_mfma_f32_32x32x16_bf16 v[140:155], v[64:67], a[44:47], 0
    ds_write_b128 v164, v[160:163] offset:35840
    s_waitcnt lgkmcnt(8)
    v_mfma_f32_32x32x16_bf16 v[76:91], a[212:215], v[112:115], v[76:91]
    ds_read_b128 v[108:111], v165 offset:28672
    v_add_f32_e64 v132, v36, v132
    v_rcp_f32 v132, v132
    s_nop 0
    v_mul_f32 v124, v124, v132
    s_waitcnt lgkmcnt(7)
    v_mfma_f32_32x32x16_bf16 v[76:91], a[216:219], v[116:119], v[76:91]
    ds_read_b128 v[112:115], v165 offset:29696
    v_mul_f32 v125, v125, v132
    v_mul_f32 v126, v126, v132
    v_mul_f32_e64 v127, v127, v132
    v_mul_f32 v128, v128, v132
    s_waitcnt lgkmcnt(7)
    v_mfma_f32_32x32x16_bf16 v[76:91], a[220:223], v[120:123], v[76:91]
    ds_read_b128 v[116:119], v165 offset:30720
    buffer_load_dwordx4 v20, s[24:27], s68 offen offset:1024 lds
    s_waitcnt lgkmcnt(7)
    v_mfma_f32_32x32x16_bf16 v[76:91], a[224:227], v[92:95], v[76:91]
    ds_read_b128 v[120:123], v165 offset:31744
    v_mul_f32 v129, v129, v132
    v_mul_f32_e64 v130, v130, v132
    v_mul_f32 v131, v131, v132
    v_cvt_pk_bf16_f32 v156, v124, v125
    s_waitcnt lgkmcnt(7)
    v_mfma_f32_32x32x16_bf16 v[76:91], a[228:231], v[96:99], v[76:91]
    v_cvt_pk_bf16_f32 v157, v126, v127
    v_cvt_pk_bf16_f32 v158, v128, v129
    v_cvt_pk_bf16_f32 v159, v130, v131
    s_waitcnt vmcnt(7)
    v_mfma_f32_32x32x16_bf16 v[124:139], v[68:71], a[52:55], 0
    ds_write_b128 v164, v[156:159] offset:36864
    s_waitcnt lgkmcnt(7)
    v_mfma_f32_32x32x16_bf16 v[76:91], a[232:235], v[100:103], v[76:91]
    v_add_f32_e64 v140, v36, v140
    v_rcp_f32 v140, v140
    s_nop 0
    v_mul_f32 v148, v148, v140
    s_waitcnt lgkmcnt(6)
    v_mfma_f32_32x32x16_bf16 v[76:91], a[236:239], v[104:107], v[76:91]
    s_add_u32 m0, s60, 0x8800
    s_mov_b32 s68, 0x150000
    buffer_load_dwordx4 v19, s[24:27], s68 offen lds
    s_waitcnt lgkmcnt(4)
    v_mfma_f32_32x32x16_bf16 v[76:91], a[240:243], v[108:111], v[76:91]
    v_mul_f32 v149, v149, v140
    v_mul_f32 v150, v150, v140
    v_mul_f32 v151, v151, v140
    v_mul_f32 v152, v152, v140
    s_waitcnt lgkmcnt(3)
    v_mfma_f32_32x32x16_bf16 v[76:91], a[244:247], v[112:115], v[76:91]
    v_mul_f32 v153, v153, v140
    v_mul_f32 v154, v154, v140
    v_mul_f32 v155, v155, v140
    v_cvt_pk_bf16_f32 v160, v148, v149
    s_waitcnt lgkmcnt(2)
    v_mfma_f32_32x32x16_bf16 v[76:91], a[248:251], v[116:119], v[76:91]
    v_cvt_pk_bf16_f32 v161, v150, v151
    v_cvt_pk_bf16_f32 v162, v152, v153
    v_cvt_pk_bf16_f32 v163, v154, v155
    s_waitcnt vmcnt(7)
    v_mfma_f32_32x32x16_bf16 v[140:155], v[72:75], a[60:63], 0
    ds_write_b128 v164, v[160:163] offset:37888
    s_waitcnt lgkmcnt(2)
    v_mfma_f32_32x32x16_bf16 v[76:91], a[252:255], v[120:123], v[76:91]
    buffer_load_dwordx4 v20, s[24:27], s68 offen offset:1024 lds
    v_add_f32 v132, v36, v132
    v_rcp_f32 v132, v132
    s_nop 0
    v_mul_f32 v124, v124, v132
    v_mul_f32 v125, v125, v132
    v_mul_f32 v126, v126, v132
    v_mul_f32 v127, v127, v132
    v_mul_f32 v128, v128, v132
    v_mul_f32 v129, v129, v132
    v_mul_f32 v130, v130, v132
    v_mul_f32_e64 v131, v131, v132
    v_cvt_pk_bf16_f32 v156, v124, v125
    v_cvt_pk_bf16_f32 v157, v126, v127
    v_cvt_pk_bf16_f32 v158, v128, v129
    v_cvt_pk_bf16_f32 v159, v130, v131
    ds_write_b128 v164, v[156:159] offset:38912
    v_add_f32 v140, v36, v140
    v_rcp_f32 v140, v140
    s_nop 0
    v_mul_f32 v148, v148, v140
    v_mul_f32 v149, v149, v140
    v_mul_f32 v150, v150, v140
    v_mul_f32 v151, v151, v140
    v_mul_f32 v152, v152, v140
    v_mul_f32 v153, v153, v140
    v_mul_f32 v154, v154, v140
    v_mul_f32_e64 v155, v155, v140
    v_cvt_pk_bf16_f32 v160, v148, v149
    v_cvt_pk_bf16_f32 v161, v150, v151
    v_cvt_pk_bf16_f32 v162, v152, v153
    v_cvt_pk_bf16_f32 v163, v154, v155
    ds_write_b128 v164, v[160:163] offset:39936
    s_waitcnt lgkmcnt(0)
    s_barrier
    ds_read_b128 v[92:95], v165 offset:32768
    ds_read_b128 v[96:99], v165 offset:33792
    ds_read_b128 v[100:103], v165 offset:34816
    ds_read_b128 v[104:107], v165 offset:35840
    ds_read_b128 v[108:111], v165 offset:36864
    ds_read_b128 v[112:115], v165 offset:37888
    ds_read_b128 v[116:119], v165 offset:38912
    s_waitcnt lgkmcnt(6)
    v_mfma_f32_32x32x16_bf16 v[44:59], a[128:131], v[92:95], 0
    ds_read_b128 v[120:123], v165 offset:39936
    v_cvt_pk_bf16_f32 v140, v76, v77
    v_cvt_pk_bf16_f32 v141, v78, v79
    v_cvt_pk_bf16_f32 v142, v80, v81
    v_cvt_pk_bf16_f32 v143, v82, v83
    s_waitcnt lgkmcnt(6)
    v_mfma_f32_32x32x16_bf16 v[44:59], a[132:135], v[96:99], v[44:59]
    ds_read_b128 v[92:95], v165 offset:40960
    s_add_u32 m0, s60, 0x9000
    s_mov_b32 s68, 0x160000
    buffer_load_dwordx4 v19, s[24:27], s68 offen lds
    s_waitcnt lgkmcnt(6)
    v_mfma_f32_32x32x16_bf16 v[44:59], a[136:139], v[100:103], v[44:59]
    ds_read_b128 v[96:99], v165 offset:41984
    v_cvt_pk_bf16_f32 v144, v84, v85
    v_cvt_pk_bf16_f32 v145, v86, v87
    v_cvt_pk_bf16_f32 v146, v88, v89
    v_cvt_pk_bf16_f32 v147, v90, v91
    s_waitcnt lgkmcnt(6)
    v_mfma_f32_32x32x16_bf16 v[44:59], a[140:143], v[104:107], v[44:59]
    ds_read_b128 v[100:103], v165 offset:43008
    buffer_load_dwordx4 v20, s[24:27], s68 offen offset:1024 lds
    s_waitcnt lgkmcnt(6)
    v_mfma_f32_32x32x16_bf16 v[44:59], a[144:147], v[108:111], v[44:59]
    ds_read_b128 v[104:107], v165 offset:44032
    ds_write_b64 v168, v[140:141] offset:0
    ds_write_b64 v169, v[142:143] offset:0
    ds_write_b64 v170, v[144:145] offset:0
    ds_write_b64 v171, v[146:147] offset:0
    s_waitcnt lgkmcnt(10)
    v_mfma_f32_32x32x16_bf16 v[44:59], a[148:151], v[112:115], v[44:59]
    ds_read_b128 v[108:111], v165 offset:45056
    s_add_u32 m0, s60, 0x9800
    s_mov_b32 s68, 0x170000
    buffer_load_dwordx4 v19, s[24:27], s68 offen lds
    s_waitcnt lgkmcnt(10)
    v_mfma_f32_32x32x16_bf16 v[44:59], a[152:155], v[116:119], v[44:59]
    ds_read_b128 v[112:115], v165 offset:46080
    ds_read_b128 v[124:127], v164 offset:0
    ds_read_b128 v[128:131], v164 offset:1024
    s_waitcnt lgkmcnt(12)
    v_mfma_f32_32x32x16_bf16 v[44:59], a[156:159], v[120:123], v[44:59]
    ds_read_b128 v[116:119], v165 offset:47104
    buffer_load_dwordx4 v20, s[24:27], s68 offen offset:1024 lds
    s_waitcnt lgkmcnt(12)
    v_mfma_f32_32x32x16_bf16 v[44:59], a[160:163], v[92:95], v[44:59]
    ds_read_b128 v[120:123], v165 offset:48128
    s_waitcnt lgkmcnt(12)
    v_mfma_f32_32x32x16_bf16 v[44:59], a[164:167], v[96:99], v[44:59]
    ds_read_b128 v[92:95], v165 offset:49152
    s_add_u32 m0, s60, 0x10000
    s_mov_b32 s68, 0x180000
    buffer_load_dwordx4 v19, s[24:27], s68 offen lds
    s_waitcnt lgkmcnt(12)
    v_mfma_f32_32x32x16_bf16 v[44:59], a[168:171], v[100:103], v[44:59]
    ds_read_b128 v[96:99], v165 offset:50176
    s_waitcnt lgkmcnt(12)
    v_mfma_f32_32x32x16_bf16 v[44:59], a[172:175], v[104:107], v[44:59]
    ds_read_b128 v[100:103], v165 offset:51200
    buffer_load_dwordx4 v20, s[24:27], s68 offen offset:1024 lds
    s_waitcnt lgkmcnt(8)
    v_mfma_f32_32x32x16_bf16 v[44:59], a[176:179], v[108:111], v[44:59]
    ds_read_b128 v[104:107], v165 offset:52224
    s_waitcnt lgkmcnt(8)
    v_mfma_f32_32x32x16_bf16 v[44:59], a[180:183], v[112:115], v[44:59]
    ds_read_b128 v[108:111], v165 offset:53248
    s_waitcnt lgkmcnt(8)
    buffer_store_dwordx4 v[124:127], v25, s[28:31], 0 offen offset:0 sc1
    s_waitcnt lgkmcnt(6)
    v_mfma_f32_32x32x16_bf16 v[44:59], a[184:187], v[116:119], v[44:59]
    ds_read_b128 v[112:115], v165 offset:54272
    s_waitcnt lgkmcnt(6)
    v_mfma_f32_32x32x16_bf16 v[44:59], a[188:191], v[120:123], v[44:59]
    ds_read_b128 v[116:119], v165 offset:55296
    buffer_store_dwordx4 v[128:131], v25, s[28:31], 0 offen offset:1024 sc1
    s_waitcnt lgkmcnt(6)
    v_mfma_f32_32x32x16_bf16 v[44:59], a[192:195], v[92:95], v[44:59]
    ds_read_b128 v[120:123], v165 offset:56320
    s_waitcnt lgkmcnt(6)
    v_mfma_f32_32x32x16_bf16 v[44:59], a[196:199], v[96:99], v[44:59]
    ds_read_b128 v[92:95], v165 offset:57344
    s_add_u32 m0, s60, 0x10800
    s_mov_b32 s68, 0x190000
    buffer_load_dwordx4 v19, s[24:27], s68 offen lds
    s_waitcnt lgkmcnt(6)
    v_mfma_f32_32x32x16_bf16 v[44:59], a[200:203], v[100:103], v[44:59]
    ds_read_b128 v[96:99], v165 offset:58368
    s_waitcnt lgkmcnt(6)
    v_mfma_f32_32x32x16_bf16 v[44:59], a[204:207], v[104:107], v[44:59]
    ds_read_b128 v[100:103], v165 offset:59392
    buffer_load_dwordx4 v20, s[24:27], s68 offen offset:1024 lds
    s_waitcnt lgkmcnt(6)
    v_mfma_f32_32x32x16_bf16 v[44:59], a[208:211], v[108:111], v[44:59]
    ds_read_b128 v[104:107], v165 offset:60416
    s_waitcnt lgkmcnt(6)
    v_mfma_f32_32x32x16_bf16 v[44:59], a[212:215], v[112:115], v[44:59]
    ds_read_b128 v[108:111], v165 offset:61440
    s_add_u32 m0, s60, 0x11000
    s_mov_b32 s68, 0x1a0000
    buffer_load_dwordx4 v19, s[24:27], s68 offen lds
    s_waitcnt lgkmcnt(6)
    v_mfma_f32_32x32x16_bf16 v[44:59], a[216:219], v[116:119], v[44:59]
    ds_read_b128 v[112:115], v165 offset:62464
    s_waitcnt lgkmcnt(6)
    v_mfma_f32_32x32x16_bf16 v[44:59], a[220:223], v[120:123], v[44:59]
    ds_read_b128 v[116:119], v165 offset:63488
    buffer_load_dwordx4 v20, s[24:27], s68 offen offset:1024 lds
    s_waitcnt lgkmcnt(6)
    v_mfma_f32_32x32x16_bf16 v[44:59], a[224:227], v[92:95], v[44:59]
    ds_read_b128 v[120:123], v165 offset:64512
    buffer_load_dword v10, v11, s[28:31], 0 offen sc1
    s_waitcnt lgkmcnt(6)
    v_mfma_f32_32x32x16_bf16 v[44:59], a[228:231], v[96:99], v[44:59]
    s_add_u32 m0, s60, 0x11800
    s_mov_b32 s68, 0x1b0000
    buffer_load_dwordx4 v19, s[24:27], s68 offen lds
    s_waitcnt lgkmcnt(5)
    v_mfma_f32_32x32x16_bf16 v[44:59], a[232:235], v[100:103], v[44:59]
    s_waitcnt lgkmcnt(4)
    v_mfma_f32_32x32x16_bf16 v[44:59], a[236:239], v[104:107], v[44:59]
    buffer_load_dwordx4 v20, s[24:27], s68 offen offset:1024 lds
    s_waitcnt lgkmcnt(3)
    v_mfma_f32_32x32x16_bf16 v[44:59], a[240:243], v[108:111], v[44:59]
    s_waitcnt lgkmcnt(2)
    v_mfma_f32_32x32x16_bf16 v[44:59], a[244:247], v[112:115], v[44:59]
    s_waitcnt lgkmcnt(1)
    v_mfma_f32_32x32x16_bf16 v[44:59], a[248:251], v[116:119], v[44:59]
    s_waitcnt lgkmcnt(0)
    v_mfma_f32_32x32x16_bf16 v[44:59], a[252:255], v[120:123], v[44:59]
    s_nop 11
    v_cvt_pk_bf16_f32 v140, v44, v45
    v_cvt_pk_bf16_f32 v141, v46, v47
    v_cvt_pk_bf16_f32 v142, v48, v49
    v_cvt_pk_bf16_f32 v143, v50, v51
    v_cvt_pk_bf16_f32 v144, v52, v53
    v_cvt_pk_bf16_f32 v145, v54, v55
    v_cvt_pk_bf16_f32 v146, v56, v57
    v_cvt_pk_bf16_f32 v147, v58, v59
    ds_write_b64 v168, v[140:141] offset:2048
    ds_write_b64 v169, v[142:143] offset:2048
    ds_write_b64 v170, v[144:145] offset:2048
    ds_write_b64 v171, v[146:147] offset:2048
    ds_read_b128 v[132:135], v164 offset:2048
    ds_read_b128 v[136:139], v164 offset:3072
    s_waitcnt lgkmcnt(1)
    buffer_store_dwordx4 v[132:135], v25, s[28:31], 0 offen offset:2048 sc1
    s_waitcnt lgkmcnt(0)
    buffer_store_dwordx4 v[136:139], v25, s[28:31], 0 offen offset:3072 sc1
    s_waitcnt vmcnt(4)
    v_cmp_ne_u32 vcc, 1, v10
    s_nop 0
    s_cbranch_vccnz L_slow_f2a
L_ok_f2a:
    buffer_load_dwordx4 a[0:3], v29, s[28:31], s69 offen offset:0 sc1
    s_mov_b32 s69, 2048
    buffer_load_dwordx4 a[4:7], v29, s[28:31], s69 offen offset:0 sc1
    s_mov_b32 s69, 4096
    buffer_load_dwordx4 a[8:11], v29, s[28:31], s69 offen offset:0 sc1
    s_mov_b32 s69, 6144
    buffer_load_dwordx4 a[12:15], v29, s[28:31], s69 offen offset:0 sc1
    s_mov_b32 s69, 8192
    buffer_load_dwordx4 a[16:19], v29, s[28:31], s69 offen offset:0 sc1
    s_mov_b32 s69, 10240
    buffer_load_dwordx4 a[20:23], v29, s[28:31], s69 offen offset:0 sc1
    s_mov_b32 s69, 12288
    buffer_load_dwordx4 a[24:27], v29, s[28:31], s69 offen offset:0 sc1
    s_mov_b32 s69, 14336
    buffer_load_dwordx4 a[28:31], v29, s[28:31], s69 offen offset:0 sc1
    s_mov_b32 s69, 16384
    buffer_load_dwordx4 a[32:35], v29, s[28:31], s69 offen offset:0 sc1
    s_mov_b32 s69, 18432
    buffer_load_dwordx4 a[36:39], v29, s[28:31], s69 offen offset:0 sc1
    s_mov_b32 s69, 20480
    buffer_load_dwordx4 a[40:43], v29, s[28:31], s69 offen offset:0 sc1
    s_mov_b32 s69, 22528
    s_waitcnt vmcnt(10)
    v_mfma_f32_32x32x16_bf16 v[44:59], a[0:3], a[64:67], 0
    v_mfma_f32_32x32x16_bf16 v[60:75], a[0:3], a[68:71], 0
    buffer_load_dwordx4 a[44:47], v29, s[28:31], s69 offen offset:0 sc1
    s_mov_b32 s69, 24576
    s_waitcnt vmcnt(10)
    v_mfma_f32_32x32x16_bf16 v[44:59], a[4:7], a[72:75], v[44:59]
    v_mfma_f32_32x32x16_bf16 v[60:75], a[4:7], a[76:79], v[60:75]
    buffer_load_dwordx4 a[48:51], v29, s[28:31], s69 offen offset:0 sc1
    s_mov_b32 s69, 26624
    s_barrier
    s_cmp_lg_u32 s48, 0
    s_cbranch_scc1 L_nf_f4
    buffer_store_dword v12, v9, s[28:31], 0 offen sc1
L_nf_f4:
    s_waitcnt vmcnt(10)
    v_mfma_f32_32x32x16_bf16 v[44:59], a[8:11], a[80:83], v[44:59]
    v_mfma_f32_32x32x16_bf16 v[60:75], a[8:11], a[84:87], v[60:75]
    buffer_load_dwordx4 a[52:55], v29, s[28:31], s69 offen offset:0 sc1
    s_mov_b32 s69, 28672
    s_waitcnt vmcnt(10)
    v_mfma_f32_32x32x16_bf16 v[44:59], a[12:15], a[88:91], v[44:59]
    v_mov_b32 v40, 0xbfb8aa3b
    v_lshlrev_b32 v38, 16, v43
    v_lshlrev_b32_e64 v108, 16, v248
    v_mfma_f32_32x32x16_bf16 v[60:75], a[12:15], a[92:95], v[60:75]
    buffer_load_dwordx4 a[56:59], v29, s[28:31], s69 offen offset:0 sc1
    s_mov_b32 s69, 30720
    s_waitcnt vmcnt(10)
    v_mfma_f32_32x32x16_bf16 v[44:59], a[16:19], a[96:99], v[44:59]
    v_and_b32 v109, 0xffff0000, v248
    v_lshlrev_b32 v110, 16, v249
    v_and_b32 v111, 0xffff0000, v249
    v_mfma_f32_32x32x16_bf16 v[60:75], a[16:19], a[100:103], v[60:75]
    buffer_load_dwordx4 a[60:63], v29, s[28:31], s69 offen offset:0 sc1
    s_mov_b32 s69, 32768
    s_waitcnt vmcnt(10)
    v_mfma_f32_32x32x16_bf16 v[44:59], a[20:23], a[104:107], v[44:59]
    v_lshlrev_b32 v112, 16, v250
    v_and_b32 v113, 0xffff0000, v250
    v_lshlrev_b32_e64 v114, 16, v251
    v_mfma_f32_32x32x16_bf16 v[60:75], a[20:23], a[108:111], v[60:75]
    buffer_load_dwordx4 a[0:3], v29, s[28:31], s69 offen offset:0 sc1
    s_mov_b32 s69, 34816
    s_waitcnt vmcnt(10)
    v_mfma_f32_32x32x16_bf16 v[44:59], a[24:27], a[112:115], v[44:59]
    v_and_b32 v115, 0xffff0000, v251
    v_lshlrev_b32 v116, 16, v252
    v_and_b32 v117, 0xffff0000, v252
    v_mfma_f32_32x32x16_bf16 v[60:75], a[24:27], a[116:119], v[60:75]
    buffer_load_dwordx4 a[4:7], v29, s[28:31], s69 offen offset:0 sc1
    s_mov_b32 s69, 36864
    s_waitcnt vmcnt(10)
    v_mfma_f32_32x32x16_bf16 v[44:59], a[28:31], a[120:123], v[44:59]
    v_lshlrev_b32 v118, 16, v253
    v_and_b32 v119, 0xffff0000, v253
    v_lshlrev_b32_e64 v120, 16, v254
    v_mfma_f32_32x32x16_bf16 v[60:75], a[28:31], a[124:127], v[60:75]
    buffer_load_dwordx4 a[8:11], v29, s[28:31], s69 offen offset:0 sc1
    s_mov_b32 s69, 38912
    s_waitcnt vmcnt(10)
    v_mfma_f32_32x32x16_bf16 v[44:59], a[32:35], v[172:175], v[44:59]
    v_and_b32 v121, 0xffff0000, v254
    v_lshlrev_b32 v122, 16, v255
    v_and_b32 v123, 0xffff0000, v255
    v_mfma_f32_32x32x16_bf16 v[60:75], a[32:35], v[176:179], v[60:75]
    buffer_load_dwordx4 a[12:15], v29, s[28:31], s69 offen offset:0 sc1
    s_mov_b32 s69, 40960
    s_waitcnt vmcnt(10)
    v_mfma_f32_32x32x16_bf16 v[44:59], a[36:39], v[180:183], v[44:59]
    s_lshl_b32 s56, s54, 2
    s_lshr_b32 s57, s53, 1
    s_add_u32 s56, s56, s57
    v_mfma_f32_32x32x16_bf16 v[60:75], a[36:39], v[184:187], v[60:75]
    buffer_load_dwordx4 a[16:19], v29, s[28:31], s69 offen offset:0 sc1
    s_mov_b32 s69, 43008
    s_waitcnt vmcnt(10)
    v_mfma_f32_32x32x16_bf16 v[44:59], a[40:43], v[188:191], v[44:59]
    s_lshl_b32 s56, s56, 6
    s_add_u32 s56, s56, 0x638000
    v_mov_b32 v11, s56
    v_mfma_f32_32x32x16_bf16 v[60:75], a[40:43], v[192:195], v[60:75]
    buffer_load_dwordx4 a[20:23], v29, s[28:31], s69 offen offset:0 sc1
    s_mov_b32 s69, 45056
    s_waitcnt vmcnt(10)
    v_mfma_f32_32x32x16_bf16 v[44:59], a[44:47], v[196:199], v[44:59]
    v_mfma_f32_32x32x16_bf16 v[60:75], a[44:47], v[200:203], v[60:75]
    buffer_load_dwordx4 a[24:27], v29, s[28:31], s69 offen offset:0 sc1
    s_mov_b32 s69, 47104
    s_waitcnt vmcnt(10)
    v_mfma_f32_32x32x16_bf16 v[44:59], a[48:51], v[204:207], v[44:59]
    v_mfma_f32_32x32x16_bf16 v[60:75], a[48:51], v[208:211], v[60:75]
    buffer_load_dwordx4 a[28:31], v29, s[28:31], s69 offen offset:0 sc1
    s_mov_b32 s69, 49152
    s_waitcnt vmcnt(10)
    v_mfma_f32_32x32x16_bf16 v[44:59], a[52:55], v[212:215], v[44:59]
    ds_read_b64_tr_b16 v[140:141], v30 offset:0
    ds_read_b64_tr_b16 v[142:143], v30 offset:1024
    ds_read_b64_tr_b16 v[144:145], v33 offset:0
    ds_read_b64_tr_b16 v[146:147], v33 offset:1024
    v_mfma_f32_32x32x16_bf16 v[60:75], a[52:55], v[216:219], v[60:75]
    buffer_load_dwordx4 a[32:35], v29, s[28:31], s69 offen offset:0 sc1
    s_mov_b32 s69, 51200
    s_waitcnt vmcnt(10)
    v_mfma_f32_32x32x16_bf16 v[44:59], a[56:59], v[220:223], v[44:59]
    ds_read_b64_tr_b16 v[148:149], v30 offset:2048
    ds_read_b64_tr_b16 v[150:151], v30 offset:3072
    ds_read_b64_tr_b16 v[152:153], v33 offset:2048
    ds_read_b64_tr_b16 v[154:155], v33 offset:3072
    v_mfma_f32_32x32x16_bf16 v[60:75], a[56:59], v[224:227], v[60:75]
    buffer_load_dwordx4 a[36:39], v29, s[28:31], s69 offen offset:0 sc1
    s_mov_b32 s69, 53248
    s_waitcnt vmcnt(10)
    v_mfma_f32_32x32x16_bf16 v[44:59], a[60:63], v[228:231], v[44:59]
    ds_read_b64_tr_b16 v[156:157], v30 offset:4096
    ds_read_b64_tr_b16 v[158:159], v30 offset:5120
    ds_read_b64_tr_b16 v[160:161], v33 offset:4096
    ds_read_b64_tr_b16 v[162:163], v33 offset:5120
    v_mfma_f32_32x32x16_bf16 v[60:75], a[60:63], v[232:235], v[60:75]
    buffer_load_dwordx4 a[40:43], v29, s[28:31], s69 offen offset:0 sc1
    s_mov_b32 s69, 55296
    s_waitcnt vmcnt(10) lgkmcnt(10)
    v_mfma_f32_32x32x16_bf16 v[44:59], a[0:3], v[140:143], v[44:59]
    ds_read_b64_tr_b16 v[164:165], v30 offset:6144
    ds_read_b64_tr_b16 v[166:167], v30 offset:7168
    ds_read_b64_tr_b16 v[168:169], v33 offset:6144
    ds_read_b64_tr_b16 v[170:171], v33 offset:7168
    s_waitcnt lgkmcnt(12)
    v_mfma_f32_32x32x16_bf16 v[60:75], a[0:3], v[144:147], v[60:75]
    buffer_load_dwordx4 a[44:47], v29, s[28:31], s69 offen offset:0 sc1
    s_mov_b32 s69, 0
    s_waitcnt vmcnt(10) lgkmcnt(10)
    v_mfma_f32_32x32x16_bf16 v[44:59], a[4:7], v[148:151], v[44:59]
    ds_read_b64_tr_b16 v[140:141], v30 offset:32768
    ds_read_b64_tr_b16 v[142:143], v30 offset:33792
    ds_read_b64_tr_b16 v[144:145], v33 offset:32768
    ds_read_b64_tr_b16 v[146:147], v33 offset:33792
    s_waitcnt lgkmcnt(12)
    v_mfma_f32_32x32x16_bf16 v[60:75], a[4:7], v[152:155], v[60:75]
    buffer_load_dwordx4 a[48:51], v29, s[28:31], s69 offen offset:1024 sc1
    s_mov_b32 s69, 2048
    s_waitcnt vmcnt(10) lgkmcnt(10)
    v_mfma_f32_32x32x16_bf16 v[44:59], a[8:11], v[156:159], v[44:59]
    ds_read_b64_tr_b16 v[148:149], v30 offset:34816
    ds_read_b64_tr_b16 v[150:151], v30 offset:35840
    ds_read_b64_tr_b16 v[152:153], v33 offset:34816
    ds_read_b64_tr_b16 v[154:155], v33 offset:35840
    s_waitcnt lgkmcnt(12)
    v_mfma_f32_32x32x16_bf16 v[60:75], a[8:11], v[160:163], v[60:75]
    buffer_load_dwordx4 a[52:55], v29, s[28:31], s69 offen offset:1024 sc1
    s_mov_b32 s69, 4096
    s_waitcnt vmcnt(10) lgkmcnt(10)
    v_mfma_f32_32x32x16_bf16 v[44:59], a[12:15], v[164:167], v[44:59]
    ds_read_b64_tr_b16 v[156:157], v30 offset:36864
    ds_read_b64_tr_b16 v[158:159], v30 offset:37888
    ds_read_b64_tr_b16 v[160:161], v33 offset:36864
    ds_read_b64_tr_b16 v[162:163], v33 offset:37888
    s_waitcnt lgkmcnt(12)
    v_mfma_f32_32x32x16_bf16 v[60:75], a[12:15], v[168:171], v[60:75]
    buffer_load_dwordx4 a[56:59], v29, s[28:31], s69 offen offset:1024 sc1
    s_mov_b32 s69, 6144
    s_waitcnt vmcnt(10) lgkmcnt(10)
    v_mfma_f32_32x32x16_bf16 v[44:59], a[16:19], v[140:143], v[44:59]
    ds_read_b64_tr_b16 v[164:165], v30 offset:38912
    ds_read_b64_tr_b16 v[166:167], v30 offset:39936
    ds_read_b64_tr_b16 v[168:169], v33 offset:38912
    ds_read_b64_tr_b16 v[170:171], v33 offset:39936
    s_waitcnt lgkmcnt(12)
    v_mfma_f32_32x32x16_bf16 v[60:75], a[16:19], v[144:147], v[60:75]
    buffer_load_dwordx4 a[60:63], v29, s[28:31], s69 offen offset:1024 sc1
    s_mov_b32 s69, 8192
    s_waitcnt vmcnt(10) lgkmcnt(10)
    v_mfma_f32_32x32x16_bf16 v[44:59], a[20:23], v[148:151], v[44:59]
    ds_read_b64_tr_b16 v[140:141], v31 offset:0
    ds_read_b64_tr_b16 v[142:143], v31 offset:1024
    ds_read_b64_tr_b16 v[144:145], v34 offset:0
    ds_read_b64_tr_b16 v[146:147], v34 offset:1024
    s_waitcnt lgkmcnt(12)
    v_mfma_f32_32x32x16_bf16 v[60:75], a[20:23], v[152:155], v[60:75]
    buffer_load_dwordx4 a[0:3], v29, s[28:31], s69 offen offset:1024 sc1
    s_mov_b32 s69, 10240
    s_waitcnt vmcnt(10) lgkmcnt(10)
    v_mfma_f32_32x32x16_bf16 v[44:59], a[24:27], v[156:159], v[44:59]
    ds_read_b64_tr_b16 v[148:149], v31 offset:2048
    ds_read_b64_tr_b16 v[150:151], v31 offset:3072
    ds_read_b64_tr_b16 v[152:153], v34 offset:2048
    ds_read_b64_tr_b16 v[154:155], v34 offset:3072
    s_waitcnt lgkmcnt(12)
    v_mfma_f32_32x32x16_bf16 v[60:75], a[24:27], v[160:163], v[60:75]
    buffer_load_dwordx4 a[4:7], v29, s[28:31], s69 offen offset:1024 sc1
    s_mov_b32 s69, 12288
    s_waitcnt vmcnt(10) lgkmcnt(10)
    v_mfma_f32_32x32x16_bf16 v[44:59], a[28:31], v[164:167], v[44:59]
    ds_read_b64_tr_b16 v[156:157], v31 offset:4096
    ds_read_b64_tr_b16 v[158:159], v31 offset:5120
    ds_read_b64_tr_b16 v[160:161], v34 offset:4096
    ds_read_b64_tr_b16 v[162:163], v34 offset:5120
    s_waitcnt lgkmcnt(12)
    v_mfma_f32_32x32x16_bf16 v[60:75], a[28:31], v[168:171], v[60:75]
    buffer_load_dwordx4 a[8:11], v29, s[28:31], s69 offen offset:1024 sc1
    s_mov_b32 s69, 14336
    s_waitcnt vmcnt(10) lgkmcnt(10)
    v_mfma_f32_32x32x16_bf16 v[44:59], a[32:35], v[140:143], v[44:59]
    ds_read_b64_tr_b16 v[164:165], v31 offset:6144
    ds_read_b64_tr_b16 v[166:167], v31 offset:7168
    ds_read_b64_tr_b16 v[168:169], v34 offset:6144
    ds_read_b64_tr_b16 v[170:171], v34 offset:7168
    s_waitcnt lgkmcnt(12)
    v_mfma_f32_32x32x16_bf16 v[60:75], a[32:35], v[144:147], v[60:75]
    buffer_load_dwordx4 a[12:15], v29, s[28:31], s69 offen offset:1024 sc1
    s_mov_b32 s69, 16384
    s_waitcnt vmcnt(10) lgkmcnt(10)
    v_mfma_f32_32x32x16_bf16 v[44:59], a[36:39], v[148:151], v[44:59]
    s_waitcnt lgkmcnt(8)
    v_mfma_f32_32x32x16_bf16 v[60:75], a[36:39], v[152:155], v[60:75]
    buffer_load_dwordx4 a[16:19], v29, s[28:31], s69 offen offset:1024 sc1
    s_mov_b32 s69, 18432
    s_waitcnt vmcnt(10) lgkmcnt(6)
    v_mfma_f32_32x32x16_bf16 v[44:59], a[40:43], v[156:159], v[44:59]
    s_waitcnt lgkmcnt(4)
    v_mfma_f32_32x32x16_bf16 v[60:75], a[40:43], v[160:163], v[60:75]
    buffer_load_dwordx4 a[20:23], v29, s[28:31], s69 offen offset:1024 sc1
    s_mov_b32 s69, 20480
    s_waitcnt vmcnt(10) lgkmcnt(2)
    v_mfma_f32_32x32x16_bf16 v[44:59], a[44:47], v[164:167], v[44:59]
    s_waitcnt lgkmcnt(0)
    v_mfma_f32_32x32x16_bf16 v[60:75], a[44:47], v[168:171], v[60:75]
    buffer_load_dwordx4 a[24:27], v29, s[28:31], s69 offen offset:1024 sc1
    s_mov_b32 s69, 22528
    s_waitcnt vmcnt(10)
    v_mfma_f32_32x32x16_bf16 v[76:91], a[48:51], a[64:67], 0
    v_mfma_f32_32x32x16_bf16 v[92:107], a[48:51], a[68:71], 0
    buffer_load_dwordx4 a[28:31], v29, s[28:31], s69 offen offset:1024 sc1
    s_mov_b32 s69, 24576
    s_waitcnt vmcnt(10)
    v_mfma_f32_32x32x16_bf16 v[76:91], a[52:55], a[72:75], v[76:91]
    s_nop 0
    ds_write_b128 v14, v[44:47] offset:0
    v_mfma_f32_32x32x16_bf16 v[92:107], a[52:55], a[76:79], v[92:107]
    buffer_load_dwordx4 a[32:35], v29, s[28:31], s69 offen offset:1024 sc1
    s_mov_b32 s69, 26624
    s_waitcnt vmcnt(10)
    v_mfma_f32_32x32x16_bf16 v[76:91], a[56:59], a[80:83], v[76:91]
    ds_write_b128 v15, v[48:51] offset:0
    v_mfma_f32_32x32x16_bf16 v[92:107], a[56:59], a[84:87], v[92:107]
    buffer_load_dwordx4 a[36:39], v29, s[28:31], s69 offen offset:1024 sc1
    s_mov_b32 s69, 28672
    s_waitcnt vmcnt(10)
    v_mfma_f32_32x32x16_bf16 v[76:91], a[60:63], a[88:91], v[76:91]
    ds_write_b128 v16, v[52:55] offset:0
    v_mfma_f32_32x32x16_bf16 v[92:107], a[60:63], a[92:95], v[92:107]
    buffer_load_dwordx4 a[40:43], v29, s[28:31], s69 offen offset:1024 sc1
    s_mov_b32 s69, 30720
    s_waitcnt vmcnt(10)
    v_mfma_f32_32x32x16_bf16 v[76:91], a[0:3], a[96:99], v[76:91]
    ds_write_b128 v17, v[56:59] offset:0
    v_mfma_f32_32x32x16_bf16 v[92:107], a[0:3], a[100:103], v[92:107]
    buffer_load_dwordx4 a[44:47], v29, s[28:31], s69 offen offset:1024 sc1
    s_mov_b32 s69, 32768
    s_waitcnt vmcnt(10)
    v_mfma_f32_32x32x16_bf16 v[76:91], a[4:7], a[104:107], v[76:91]
    ds_write_b128 v14, v[60:63] offset:4096
    v_mfma_f32_32x32x16_bf16 v[92:107], a[4:7], a[108:111], v[92:107]
    buffer_load_dwordx4 a[48:51], v29, s[28:31], s69 offen offset:1024 sc1
    s_mov_b32 s69, 34816
    s_waitcnt vmcnt(10)
    v_mfma_f32_32x32x16_bf16 v[76:91], a[8:11], a[112:115], v[76:91]
    ds_write_b128 v15, v[64:67] offset:4096
    v_mfma_f32_32x32x16_bf16 v[92:107], a[8:11], a[116:119], v[92:107]
    buffer_load_dwordx4 a[52:55], v29, s[28:31], s69 offen offset:1024 sc1
    s_mov_b32 s69, 36864
    s_waitcnt vmcnt(10)
    v_mfma_f32_32x32x16_bf16 v[76:91], a[12:15], a[120:123], v[76:91]
    ds_write_b128 v16, v[68:71] offset:4096
    v_mfma_f32_32x32x16_bf16 v[92:107], a[12:15], a[124:127], v[92:107]
    buffer_load_dwordx4 a[56:59], v29, s[28:31], s69 offen offset:1024 sc1
    s_mov_b32 s69, 38912
    s_waitcnt vmcnt(10)
    v_mfma_f32_32x32x16_bf16 v[76:91], a[16:19], v[172:175], v[76:91]
    ds_write_b128 v17, v[72:75] offset:4096
    v_mfma_f32_32x32x16_bf16 v[92:107], a[16:19], v[176:179], v[92:107]
    buffer_load_dwordx4 a[60:63], v29, s[28:31], s69 offen offset:1024 sc1
    s_mov_b32 s69, 40960
    buffer_load_dword v10, v11, s[28:31], 0 offen sc1
    s_waitcnt vmcnt(11)
    v_mfma_f32_32x32x16_bf16 v[76:91], a[20:23], v[180:183], v[76:91]
    s_waitcnt lgkmcnt(0)
    s_barrier
    ds_read_b128 v[44:47], v18 offset:0
    ds_read_b128 v[48:51], v26 offset:0
    ds_read_b128 v[52:55], v18 offset:8192
    v_mfma_f32_32x32x16_bf16 v[92:107], a[20:23], v[184:187], v[92:107]
    buffer_load_dwordx4 a[0:3], v29, s[28:31], s69 offen offset:1024 sc1
    s_mov_b32 s69, 43008
    s_waitcnt vmcnt(11)
    v_mfma_f32_32x32x16_bf16 v[76:91], a[24:27], v[188:191], v[76:91]
    ds_read_b128 v[56:59], v26 offset:8192
    ds_read_b128 v[60:63], v18 offset:16384
    ds_read_b128 v[64:67], v26 offset:16384
    ds_read_b128 v[68:71], v18 offset:24576
    v_mfma_f32_32x32x16_bf16 v[92:107], a[24:27], v[192:195], v[92:107]
    buffer_load_dwordx4 a[4:7], v29, s[28:31], s69 offen offset:1024 sc1
    s_mov_b32 s69, 45056
    s_waitcnt vmcnt(11)
    v_mfma_f32_32x32x16_bf16 v[76:91], a[28:31], v[196:199], v[76:91]
    ds_read_b128 v[72:75], v26 offset:24576
    s_waitcnt lgkmcnt(5)
    v_add_f32 v44, v44, v52
    v_add_f32 v45, v45, v53
    s_waitcnt lgkmcnt(1)
    v_add_f32_e64 v60, v60, v68
    v_mfma_f32_32x32x16_bf16 v[92:107], a[28:31], v[200:203], v[92:107]
    buffer_load_dwordx4 a[8:11], v29, s[28:31], s69 offen offset:1024 sc1
    s_mov_b32 s69, 47104
    s_waitcnt vmcnt(11)
    v_mfma_f32_32x32x16_bf16 v[76:91], a[32:35], v[204:207], v[76:91]
    v_add_f32 v61, v61, v69
    v_add_f32 v46, v46, v54
    v_add_f32 v47, v47, v55
    v_add_f32 v62, v62, v70
    v_mfma_f32_32x32x16_bf16 v[92:107], a[32:35], v[208:211], v[92:107]
    buffer_load_dwordx4 a[12:15], v29, s[28:31], s69 offen offset:1024 sc1
    s_mov_b32 s69, 49152
    s_waitcnt vmcnt(11)
    v_mfma_f32_32x32x16_bf16 v[76:91], a[36:39], v[212:215], v[76:91]
    ds_read_b64_tr_b16 v[140:141], v30 offset:0
    ds_read_b64_tr_b16 v[142:143], v30 offset:1024
    ds_read_b64_tr_b16 v[144:145], v33 offset:0
    ds_read_b64_tr_b16 v[146:147], v33 offset:1024
    v_mfma_f32_32x32x16_bf16 v[92:107], a[36:39], v[216:219], v[92:107]
    buffer_load_dwordx4 a[16:19], v29, s[28:31], s69 offen offset:1024 sc1
    s_mov_b32 s69, 51200
    v_add_f32 v63, v63, v71
    v_add_f32 v48, v48, v56
    v_add_f32 v49, v49, v57
    s_waitcnt lgkmcnt(4)
    v_add_f32 v64, v64, v72
    s_waitcnt vmcnt(11)
    v_mfma_f32_32x32x16_bf16 v[76:91], a[40:43], v[220:223], v[76:91]
    ds_read_b64_tr_b16 v[148:149], v30 offset:2048
    ds_read_b64_tr_b16 v[150:151], v30 offset:3072
    ds_read_b64_tr_b16 v[152:153], v33 offset:2048
    ds_read_b64_tr_b16 v[154:155], v33 offset:3072
    v_mfma_f32_32x32x16_bf16 v[92:107], a[40:43], v[224:227], v[92:107]
    buffer_load_dwordx4 a[20:23], v29, s[28:31], s69 offen offset:1024 sc1
    s_mov_b32 s69, 53248
    v_add_f32 v65, v65, v73
    v_add_f32 v50, v50, v58
    v_add_f32_e64 v51, v51, v59
    v_add_f32 v66, v66, v74
    s_waitcnt vmcnt(11)
    v_mfma_f32_32x32x16_bf16 v[76:91], a[44:47], v[228:231], v[76:91]
    ds_read_b64_tr_b16 v[156:157], v30 offset:4096
    ds_read_b64_tr_b16 v[158:159], v30 offset:5120
    ds_read_b64_tr_b16 v[160:161], v33 offset:4096
    ds_read_b64_tr_b16 v[162:163], v33 offset:5120
    v_mfma_f32_32x32x16_bf16 v[92:107], a[44:47], v[232:235], v[92:107]
    buffer_load_dwordx4 a[24:27], v29, s[28:31], s69 offen offset:1024 sc1
    s_mov_b32 s69, 55296
    v_add_f32 v67, v67, v75
    v_add_f32 v124, v44, v60
    v_add_f32_e64 v125, v45, v61
    v_add_f32 v126, v46, v62
    s_waitcnt vmcnt(11) lgkmcnt(10)
    v_mfma_f32_32x32x16_bf16 v[76:91], a[48:51], v[140:143], v[76:91]
    ds_read_b64_tr_b16 v[164:165], v30 offset:6144
    ds_read_b64_tr_b16 v[166:167], v30 offset:7168
    ds_read_b64_tr_b16 v[168:169], v33 offset:6144
    ds_read_b64_tr_b16 v[170:171], v33 offset:7168
    s_waitcnt lgkmcnt(12)
    v_mfma_f32_32x32x16_bf16 v[92:107], a[48:51], v[144:147], v[92:107]
    buffer_load_dwordx4 a[28:31], v29, s[28:31], s69 offen offset:1024 sc1
    s_mov_b32 s69, 0
    v_add_f32 v127, v47, v63
    v_add_f32 v128, v48, v64
    v_add_f32_e64 v129, v49, v65
    v_add_f32 v130, v50, v66
    s_waitcnt vmcnt(11) lgkmcnt(10)
    v_mfma_f32_32x32x16_bf16 v[76:91], a[52:55], v[148:151], v[76:91]
    ds_read_b64_tr_b16 v[140:141], v30 offset:32768
    ds_read_b64_tr_b16 v[142:143], v30 offset:33792
    ds_read_b64_tr_b16 v[144:145], v33 offset:32768
    ds_read_b64_tr_b16 v[146:147], v33 offset:33792
    s_waitcnt lgkmcnt(12)
    v_mfma_f32_32x32x16_bf16 v[92:107], a[52:55], v[152:155], v[92:107]
    v_add_f32 v131, v51, v67
    v_add_f32 v124, v124, v38
    v_add_f32 v125, v125, v38
    v_add_f32 v126, v126, v38
    s_waitcnt vmcnt(10) lgkmcnt(10)
    v_mfma_f32_32x32x16_bf16 v[76:91], a[56:59], v[156:159], v[76:91]
    ds_read_b64_tr_b16 v[148:149], v30 offset:34816
    ds_read_b64_tr_b16 v[150:151], v30 offset:35840
    ds_read_b64_tr_b16 v[152:153], v33 offset:34816
    ds_read_b64_tr_b16 v[154:155], v33 offset:35840
    s_waitcnt lgkmcnt(12)
    v_mfma_f32_32x32x16_bf16 v[92:107], a[56:59], v[160:163], v[92:107]
    v_add_f32 v127, v127, v38
    v_add_f32 v128, v128, v38
    v_add_f32 v129, v129, v38
    v_add_f32 v130, v130, v38
    s_waitcnt vmcnt(8)
    v_cmp_ne_u32 vcc, 1, v10
    s_nop 0
    s_cbranch_vccnz L_slow_f4a
L_ok_f4a:
    buffer_load_dwordx4 v[240:243], v23, s[28:31], 0 offen sc1
    buffer_load_dwordx4 v[244:247], v28, s[28:31], 0 offen sc1
    s_waitcnt lgkmcnt(10)
    v_mfma_f32_32x32x16_bf16 v[76:91], a[60:63], v[164:167], v[76:91]
    ds_read_b64_tr_b16 v[156:157], v30 offset:36864
    ds_read_b64_tr_b16 v[158:159], v30 offset:37888
    ds_read_b64_tr_b16 v[160:161], v33 offset:36864
    ds_read_b64_tr_b16 v[162:163], v33 offset:37888
    s_waitcnt lgkmcnt(12)
    v_mfma_f32_32x32x16_bf16 v[92:107], a[60:63], v[168:171], v[92:107]
    v_add_f32 v131, v131, v38
    v_mul_f32 v44, v124, v40
    v_mul_f32 v45, v125, v40
    v_mul_f32 v46, v126, v40
    s_waitcnt vmcnt(9) lgkmcnt(10)
    v_mfma_f32_32x32x16_bf16 v[76:91], a[0:3], v[140:143], v[76:91]
    ds_read_b64_tr_b16 v[164:165], v30 offset:38912
    ds_read_b64_tr_b16 v[166:167], v30 offset:39936
    ds_read_b64_tr_b16 v[168:169], v33 offset:38912
    ds_read_b64_tr_b16 v[170:171], v33 offset:39936
    s_waitcnt lgkmcnt(12)
    v_mfma_f32_32x32x16_bf16 v[92:107], a[0:3], v[144:147], v[92:107]
    v_mul_f32 v47, v127, v40
    v_mul_f32 v48, v128, v40
    v_mul_f32 v49, v129, v40
    v_mul_f32 v50, v130, v40
    s_waitcnt vmcnt(8) lgkmcnt(10)
    v_mfma_f32_32x32x16_bf16 v[76:91], a[4:7], v[148:151], v[76:91]
    ds_read_b64_tr_b16 v[140:141], v31 offset:0
    ds_read_b64_tr_b16 v[142:143], v31 offset:1024
    ds_read_b64_tr_b16 v[144:145], v34 offset:0
    ds_read_b64_tr_b16 v[146:147], v34 offset:1024
    s_waitcnt lgkmcnt(12)
    v_mfma_f32_32x32x16_bf16 v[92:107], a[4:7], v[152:155], v[92:107]
    v_mul_f32 v51, v131, v40
    v_exp_f32_e64 v44, v44
    v_exp_f32 v45, v45
    s_waitcnt vmcnt(7) lgkmcnt(10)
    v_mfma_f32_32x32x16_bf16 v[76:91], a[8:11], v[156:159], v[76:91]
    ds_read_b64_tr_b16 v[148:149], v31 offset:2048
    ds_read_b64_tr_b16 v[150:151], v31 offset:3072
    ds_read_b64_tr_b16 v[152:153], v34 offset:2048
    ds_read_b64_tr_b16 v[154:155], v34 offset:3072
    s_waitcnt lgkmcnt(12)
    v_mfma_f32_32x32x16_bf16 v[92:107], a[8:11], v[160:163], v[92:107]
    v_exp_f32 v46, v46
    v_exp_f32 v47, v47
    s_waitcnt vmcnt(6) lgkmcnt(10)
    v_mfma_f32_32x32x16_bf16 v[76:91], a[12:15], v[164:167], v[76:91]
    ds_read_b64_tr_b16 v[156:157], v31 offset:4096
    ds_read_b64_tr_b16 v[158:159], v31 offset:5120
    ds_read_b64_tr_b16 v[160:161], v34 offset:4096
    ds_read_b64_tr_b16 v[162:163], v34 offset:5120
    s_waitcnt lgkmcnt(12)
    v_mfma_f32_32x32x16_bf16 v[92:107], a[12:15], v[168:171], v[92:107]
    v_exp_f32 v48, v48
    v_exp_f32 v49, v49
    s_waitcnt vmcnt(5) lgkmcnt(10)
    v_mfma_f32_32x32x16_bf16 v[76:91], a[16:19], v[140:143], v[76:91]
    ds_read_b64_tr_b16 v[164:165], v31 offset:6144
    ds_read_b64_tr_b16 v[166:167], v31 offset:7168
    ds_read_b64_tr_b16 v[168:169], v34 offset:6144
    ds_read_b64_tr_b16 v[170:171], v34 offset:7168
    s_waitcnt lgkmcnt(12)
    v_mfma_f32_32x32x16_bf16 v[92:107], a[16:19], v[144:147], v[92:107]
    v_exp_f32 v50, v50
    v_exp_f32 v51, v51
    s_waitcnt vmcnt(4) lgkmcnt(10)
    v_mfma_f32_32x32x16_bf16 v[76:91], a[20:23], v[148:151], v[76:91]
    v_add_f32 v44, v44, v42
    v_add_f32 v45, v45, v42
    v_add_f32_e64 v46, v46, v42
    v_add_f32 v47, v47, v42
    s_waitcnt lgkmcnt(8)
    v_mfma_f32_32x32x16_bf16 v[92:107], a[20:23], v[152:155], v[92:107]
    v_add_f32 v48, v48, v42
    v_add_f32 v49, v49, v42
    v_add_f32_e64 v50, v50, v42
    v_add_f32 v51, v51, v42
    s_waitcnt vmcnt(3) lgkmcnt(6)
    v_mfma_f32_32x32x16_bf16 v[76:91], a[24:27], v[156:159], v[76:91]
    v_rcp_f32_e64 v44, v44
    v_rcp_f32 v45, v45
    s_waitcnt lgkmcnt(4)
    v_mfma_f32_32x32x16_bf16 v[92:107], a[24:27], v[160:163], v[92:107]
    v_rcp_f32_e64 v46, v46
    v_rcp_f32 v47, v47
    s_waitcnt vmcnt(2) lgkmcnt(2)
    v_mfma_f32_32x32x16_bf16 v[76:91], a[28:31], v[164:167], v[76:91]
    v_rcp_f32_e64 v48, v48
    v_rcp_f32 v49, v49
    s_waitcnt lgkmcnt(0)
    v_mfma_f32_32x32x16_bf16 v[92:107], a[28:31], v[168:171], v[92:107]
    v_rcp_f32 v50, v50
    v_rcp_f32 v51, v51
    v_mul_f32 v124, v124, v44
    v_mul_f32 v125, v125, v45
    v_mul_f32 v126, v126, v46
    v_mul_f32 v127, v127, v47
    v_mul_f32 v128, v128, v48
    s_nop 0
    ds_write_b128 v14, v[76:79] offset:32768
    v_mul_f32 v129, v129, v49
    v_mul_f32 v130, v130, v50
    v_mul_f32 v131, v131, v51
    s_waitcnt vmcnt(1)
    v_lshlrev_b32_e64 v140, 16, v240
    v_and_b32 v141, 0xffff0000, v240
    ds_write_b128 v15, v[80:83] offset:32768
    v_lshlrev_b32_e64 v142, 16, v241
    v_and_b32 v143, 0xffff0000, v241
    v_lshlrev_b32_e64 v144, 16, v242
    v_and_b32 v145, 0xffff0000, v242
    v_lshlrev_b32_e64 v146, 16, v243
    ds_write_b128 v16, v[84:87] offset:32768
    v_and_b32 v147, 0xffff0000, v243
    s_waitcnt vmcnt(0)
    v_lshlrev_b32 v148, 16, v244
    v_and_b32 v149, 0xffff0000, v244
    v_lshlrev_b32_e64 v150, 16, v245
    v_and_b32 v151, 0xffff0000, v245
    ds_write_b128 v17, v[88:91] offset:32768
    v_lshlrev_b32_e64 v152, 16, v246
    v_and_b32 v153, 0xffff0000, v246
    v_lshlrev_b32_e64 v154, 16, v247
    v_and_b32 v155, 0xffff0000, v247
    v_pk_fma_f32 v[124:125], v[124:125], v[140:141], v[108:109]
    ds_write_b128 v14, v[92:95] offset:36864
    v_pk_fma_f32 v[126:127], v[126:127], v[142:143], v[110:111]
    v_pk_fma_f32 v[128:129], v[128:129], v[144:145], v[112:113]
    v_pk_fma_f32 v[130:131], v[130:131], v[146:147], v[114:115]
    v_cvt_pk_bf16_f32 v248, v124, v125
    v_cvt_pk_bf16_f32 v249, v126, v127
    ds_write_b128 v15, v[96:99] offset:36864
    v_cvt_pk_bf16_f32 v250, v128, v129
    v_cvt_pk_bf16_f32 v251, v130, v131
    buffer_store_dwordx4 v[248:251], v6, s[32:35], 0 offen offset:0
    ds_write_b128 v16, v[100:103] offset:36864
    ds_write_b128 v17, v[104:107] offset:36864
    s_waitcnt lgkmcnt(0)
    s_barrier
    ds_read_b128 v[172:175], v18 offset:32768
    ds_read_b128 v[176:179], v26 offset:32768
    ds_read_b128 v[180:183], v18 offset:40960
    ds_read_b128 v[184:187], v26 offset:40960
    ds_read_b128 v[188:191], v18 offset:49152
    ds_read_b128 v[192:195], v26 offset:49152
    ds_read_b128 v[196:199], v18 offset:57344
    ds_read_b128 v[200:203], v26 offset:57344
    s_waitcnt lgkmcnt(5)
    v_pk_add_f32 v[172:173], v[172:173], v[180:181]
    s_waitcnt lgkmcnt(1)
    v_pk_add_f32 v[188:189], v[188:189], v[196:197]
    v_pk_add_f32 v[174:175], v[174:175], v[182:183]
    v_pk_add_f32 v[190:191], v[190:191], v[198:199]
    v_pk_add_f32 v[176:177], v[176:177], v[184:185]
    s_waitcnt lgkmcnt(0)
    v_pk_add_f32 v[192:193], v[192:193], v[200:201]
    v_pk_add_f32 v[178:179], v[178:179], v[186:187]
    v_pk_add_f32 v[194:195], v[194:195], v[202:203]
    v_pk_add_f32 v[132:133], v[172:173], v[188:189]
    v_pk_add_f32 v[134:135], v[174:175], v[190:191]
    v_pk_add_f32 v[136:137], v[176:177], v[192:193]
    v_pk_add_f32 v[138:139], v[178:179], v[194:195]
    v_pk_add_f32 v[132:133], v[132:133], v[38:39] op_sel:[0,0] op_sel_hi:[1,0]
    v_pk_add_f32 v[134:135], v[134:135], v[38:39] op_sel:[0,0] op_sel_hi:[1,0]
    v_pk_add_f32 v[136:137], v[136:137], v[38:39] op_sel:[0,0] op_sel_hi:[1,0]
    v_pk_add_f32 v[138:139], v[138:139], v[38:39] op_sel:[0,0] op_sel_hi:[1,0]
    v_pk_mul_f32 v[172:173], v[132:133], v[40:41] op_sel:[0,0] op_sel_hi:[1,0]
    v_pk_mul_f32 v[174:175], v[134:135], v[40:41] op_sel:[0,0] op_sel_hi:[1,0]
    v_pk_mul_f32 v[176:177], v[136:137], v[40:41] op_sel:[0,0] op_sel_hi:[1,0]
    v_pk_mul_f32 v[178:179], v[138:139], v[40:41] op_sel:[0,0] op_sel_hi:[1,0]
    v_exp_f32 v172, v172
    v_exp_f32 v173, v173
    v_exp_f32 v174, v174
    v_exp_f32 v175, v175
    v_exp_f32 v176, v176
    v_exp_f32 v177, v177
    v_exp_f32 v178, v178
    v_exp_f32_e64 v179, v179
    v_pk_add_f32 v[172:173], v[172:173], v[42:43] op_sel:[0,0] op_sel_hi:[1,0]
    v_pk_add_f32 v[174:175], v[174:175], v[42:43] op_sel:[0,0] op_sel_hi:[1,0]
    v_pk_add_f32 v[176:177], v[176:177], v[42:43] op_sel:[0,0] op_sel_hi:[1,0]
    v_pk_add_f32 v[178:179], v[178:179], v[42:43] op_sel:[0,0] op_sel_hi:[1,0]
    v_rcp_f32 v172, v172
    v_rcp_f32 v173, v173
    v_rcp_f32 v174, v174
    v_rcp_f32 v175, v175
    v_rcp_f32 v176, v176
    v_rcp_f32 v177, v177
    v_rcp_f32 v178, v178
    v_rcp_f32 v179, v179
    v_pk_mul_f32 v[132:133], v[132:133], v[172:173]
    v_pk_mul_f32 v[134:135], v[134:135], v[174:175]
    v_pk_mul_f32 v[136:137], v[136:137], v[176:177]
    v_pk_mul_f32 v[138:139], v[138:139], v[178:179]
    v_pk_fma_f32 v[132:133], v[132:133], v[148:149], v[116:117]
    v_pk_fma_f32 v[134:135], v[134:135], v[150:151], v[118:119]
    v_pk_fma_f32 v[136:137], v[136:137], v[152:153], v[120:121]
    v_pk_fma_f32 v[138:139], v[138:139], v[154:155], v[122:123]
    v_cvt_pk_bf16_f32 v252, v132, v133
    v_cvt_pk_bf16_f32 v253, v134, v135
    v_cvt_pk_bf16_f32 v254, v136, v137
    v_cvt_pk_bf16_f32 v255, v138, v139
    buffer_store_dwordx4 v[252:255], v6, s[32:35], 0 offen offset:64
    s_endpgm
L_roleP:
    s_mov_b32 s57, s3
    s_mul_i32 s57, s57, 65536
    s_mul_i32 s56, s48, 1835008
    s_add_u32 s56, s56, s57
    s_and_b32 s57, s54, 28
    s_lshl_b32 s57, s57, 7
    s_add_u32 s56, s56, s57
    v_lshrrev_b32 v4, 2, v1
    v_min_u32 v4, 15, v4
    v_lshl_add_u32 v4, v4, 12, s56
    v_and_b32_e64 v5, 3, v1
    v_lshl_add_u32 v21, v5, 7, v4
    s_mul_i32 s56, s48, 1835008
    s_lshl_b32 s57, s54, 7
    s_add_u32 s56, s56, s57
    v_lshrrev_b32_e64 v4, 3, v1
    v_mul_u32_u24 v4, 4096, v4
    v_add3_u32 v19, v4, v13, s56
    v_add_u32 v20, 0x7c00, v19
    s_mul_i32 s56, s7, 28
    s_lshr_b32 s56, s56, 3
    s_lshl_b32 s56, s56, 8
    s_lshl_b32 s57, s48, 6
    s_add_u32 s57, s57, s3
    s_add_u32 s57, s57, 32
    s_mul_i32 s57, s57, 28672
    s_add_u32 s56, s56, s57
    v_lshrrev_b32 v4, 3, v1
    v_mul_u32_u24 v4, 3584, v4
    v_and_b32 v5, 7, v1
    v_lshlrev_b32 v5, 7, v5
    v_add3_u32 v14, v4, v5, s56
    buffer_load_dword v10, v11, s[36:39], 0 offen sc1
    s_mov_b32 s66, 0x0
    buffer_load_dword v148, v14, s[20:23], s66 offen
    s_waitcnt vmcnt(1)
    v_mov_b32 v10, v10
    s_cmp_lg_u32 s48, 0
    s_cbranch_scc1 L_ok_rdyp
    v_cmp_ne_u32 vcc, 1, v10
    s_nop 0
    s_cbranch_vccnz L_slow_rdyp
L_ok_rdyp:
    v_lshlrev_b32_e64 v11, 4, v0
    v_add_u32 v11, 0x620000, v11
    s_barrier
    s_cmp_lg_u32 s48, 0
    s_cbranch_scc1 L_nf_f1p
    buffer_store_dword v12, v9, s[28:31], 0 offen sc1
L_nf_f1p:
    s_mov_b32 s66, 0x1c000
    buffer_load_dword v149, v14, s[20:23], s66 offen
    s_barrier
    s_mov_b32 s66, 0x38000
    buffer_load_dword v150, v14, s[20:23], s66 offen
    s_barrier
    s_mov_b32 s66, 0x54000
    buffer_load_dword v151, v14, s[20:23], s66 offen
    s_barrier
    s_mov_b32 s66, 0x70000
    buffer_load_dword v152, v14, s[20:23], s66 offen
    s_barrier
    s_mov_b32 s66, 0x8c000
    buffer_load_dword v153, v14, s[20:23], s66 offen
    s_barrier
    s_mov_b32 s66, 0xa8000
    buffer_load_dword v154, v14, s[20:23], s66 offen
    s_barrier
    s_mov_b32 s66, 0xc4000
    buffer_load_dword v155, v14, s[20:23], s66 offen
    s_barrier
    s_mov_b32 s57, 0x100000
    buffer_load_dword v144, v21, s[24:27], s57 offen
    s_mov_b32 s57, 0x140000
    buffer_load_dword v145, v21, s[24:27], s57 offen
    s_mov_b32 s57, 0x180000
    buffer_load_dword v146, v21, s[24:27], s57 offen
    buffer_load_dword v10, v11, s[28:31], 0 offen sc1
    s_waitcnt vmcnt(0)
    v_cmp_ne_u32 vcc, 1, v10
    s_nop 0
    s_cbranch_vccnz L_slow_f1p
L_ok_f1p:
    s_barrier
    v_bfe_u32 v4, v1, 2, 2
    v_lshlrev_b32 v4, 7, v4
    v_lshl_add_u32 v4, v3, 9, v4
    v_bfe_u32 v5, v1, 4, 1
    v_lshl_add_u32 v4, v5, 5, v4
    v_and_b32_e64 v5, 3, v1
    v_lshl_add_u32 v4, v5, 3, v4
    v_bfe_u32 v5, v1, 3, 1
    v_lshl_add_u32 v4, v5, 6, v4
    v_add_u32 v30, s60, v4
    v_xor_b32 v33, 64, v30
    v_add_u32 v31, 0x10000, v30
    v_add_u32 v32, 0x20000, v30
    v_add_u32 v34, 0x10000, v33
    v_add_u32 v35, 0x20000, v33
    v_bfe_u32 v4, v1, 1, 2
    v_and_b32_e64 v5, 1, v1
    v_lshl_or_b32 v4, v5, 2, v4
    v_xor_b32 v4, v4, v3
    v_lshlrev_b32 v4, 4, v4
    v_lshl_add_u32 v4, v2, 7, v4
    s_add_u32 s56, s60, 0x18000
    v_add_u32 v14, s56, v4
    v_xor_b32 v15, 32, v14
    v_xor_b32_e64 v16, 64, v14
    v_xor_b32 v17, 96, v14
    v_bfe_u32 v4, v1, 3, 2
    v_and_or_b32 v4, v1, 4, v4
    v_and_b32 v5, 3, v1
    v_lshlrev_b32 v5, 1, v5
    v_xor_b32 v4, v4, v5
    v_lshlrev_b32 v4, 4, v4
    v_lshrrev_b32_e64 v5, 2, v1
    v_lshl_add_u32 v4, v5, 7, v4
    s_add_u32 s56, s64, 0x18000
    v_add_u32 v18, s56, v4
    v_xor_b32 v26, 16, v18
    v_mov_b32 v42, 1.0
    s_lshl_b32 s56, s54, 3
    s_add_u32 s56, s56, s53
    s_lshl_b32 s56, s56, 13
    s_add_u32 s56, s56, 0x800000
    v_lshl_add_u32 v23, v0, 4, s56
    v_add_u32 v28, 0x1000, v23
    s_lshl_b32 s56, s54, 6
    v_lshrrev_b32 v4, 2, v0
    v_add_u32 v4, s56, v4
    v_and_b32 v5, 3, v1
    v_lshlrev_b32_e64 v5, 4, v5
    v_lshl_add_u32 v5, v4, 10, v5
    s_lshl_b32 s56, s53, 7
    v_add_u32 v6, s56, v5
    buffer_load_dwordx4 v[248:251], v6, s[8:11], 0 offen
    buffer_load_dwordx4 v[252:255], v6, s[8:11], 0 offen offset:64
    s_mul_i32 s56, s53, 229376
    s_mul_i32 s57, s48, 57344
    s_add_u32 s56, s56, s57
    s_add_u32 s56, s56, 0x200000
    v_lshl_add_u32 v29, v1, 4, s56
    s_lshl_b32 s56, s53, 4
    s_mul_i32 s57, s48, 7
    s_lshr_b32 s57, s57, 1
    s_add_u32 s56, s56, s57
    s_lshl_b32 s56, s56, 6
    s_add_u32 s56, s56, 0x628000
    v_lshrrev_b32 v4, 4, v1
    v_lshl_add_u32 v7, v4, 6, s56
    s_add_u32 m0, s60, 0x18000
    s_mov_b32 s68, 0x0
    buffer_load_dwordx4 v19, s[24:27], s68 offen lds
    buffer_load_dwordx4 v20, s[24:27], s68 offen offset:1024 lds
    s_add_u32 m0, s60, 0x18800
    s_mov_b32 s68, 0x10000
    buffer_load_dwordx4 v19, s[24:27], s68 offen lds
    buffer_load_dwordx4 v20, s[24:27], s68 offen offset:1024 lds
    s_add_u32 m0, s60, 0x19000
    s_mov_b32 s68, 0x20000
    buffer_load_dwordx4 v19, s[24:27], s68 offen lds
    buffer_load_dwordx4 v20, s[24:27], s68 offen offset:1024 lds
    s_add_u32 m0, s60, 0x19800
    s_mov_b32 s68, 0x30000
    buffer_load_dwordx4 v19, s[24:27], s68 offen lds
    buffer_load_dwordx4 v20, s[24:27], s68 offen offset:1024 lds
    s_add_u32 m0, s60, 0x20000
    s_mov_b32 s68, 0x40000
    buffer_load_dwordx4 v19, s[24:27], s68 offen lds
    buffer_load_dwordx4 v20, s[24:27], s68 offen offset:1024 lds
    s_add_u32 m0, s60, 0x20800
    s_mov_b32 s68, 0x50000
    buffer_load_dwordx4 v19, s[24:27], s68 offen lds
    buffer_load_dwordx4 v20, s[24:27], s68 offen offset:1024 lds
    s_add_u32 m0, s60, 0x21000
    s_mov_b32 s68, 0x60000
    buffer_load_dwordx4 v19, s[24:27], s68 offen lds
    buffer_load_dwordx4 v20, s[24:27], s68 offen offset:1024 lds
    s_waitcnt vmcnt(12)
    ds_read_b64_tr_b16 a[64:65], v31 offset:32768
    ds_read_b64_tr_b16 a[66:67], v31 offset:33792
    ds_read_b64_tr_b16 a[68:69], v34 offset:32768
    ds_read_b64_tr_b16 a[70:71], v34 offset:33792
    s_add_u32 m0, s60, 0x21800
    s_mov_b32 s68, 0x70000
    buffer_load_dwordx4 v19, s[24:27], s68 offen lds
    buffer_load_dwordx4 v20, s[24:27], s68 offen offset:1024 lds
    s_waitcnt vmcnt(12)
    ds_read_b64_tr_b16 a[72:73], v31 offset:34816
    ds_read_b64_tr_b16 a[74:75], v31 offset:35840
    ds_read_b64_tr_b16 a[76:77], v34 offset:34816
    ds_read_b64_tr_b16 a[78:79], v34 offset:35840
    s_add_u32 m0, s60, 0x18000
    s_mov_b32 s68, 0x80000
    s_waitcnt lgkmcnt(4)
    buffer_load_dwordx4 v19, s[24:27], s68 offen lds
    buffer_load_dwordx4 v20, s[24:27], s68 offen offset:1024 lds
    s_waitcnt vmcnt(12)
    ds_read_b64_tr_b16 a[80:81], v31 offset:36864
    ds_read_b64_tr_b16 a[82:83], v31 offset:37888
    ds_read_b64_tr_b16 a[84:85], v34 offset:36864
    ds_read_b64_tr_b16 a[86:87], v34 offset:37888
    s_add_u32 m0, s60, 0x18800
    s_mov_b32 s68, 0x90000
    s_waitcnt lgkmcnt(4)
    buffer_load_dwordx4 v19, s[24:27], s68 offen lds
    buffer_load_dwordx4 v20, s[24:27], s68 offen offset:1024 lds
    s_waitcnt vmcnt(12)
    ds_read_b64_tr_b16 a[88:89], v31 offset:38912
    ds_read_b64_tr_b16 a[90:91], v31 offset:39936
    ds_read_b64_tr_b16 a[92:93], v34 offset:38912
    ds_read_b64_tr_b16 a[94:95], v34 offset:39936
    s_add_u32 m0, s60, 0x19000
    s_mov_b32 s68, 0xa0000
    s_waitcnt lgkmcnt(4)
    buffer_load_dwordx4 v19, s[24:27], s68 offen lds
    buffer_load_dwordx4 v20, s[24:27], s68 offen offset:1024 lds
    s_waitcnt vmcnt(12)
    ds_read_b64_tr_b16 a[96:97], v32 offset:0
    ds_read_b64_tr_b16 a[98:99], v32 offset:1024
    ds_read_b64_tr_b16 a[100:101], v35 offset:0
    ds_read_b64_tr_b16 a[102:103], v35 offset:1024
    s_add_u32 m0, s60, 0x19800
    s_mov_b32 s68, 0xb0000
    s_waitcnt lgkmcnt(4)
    buffer_load_dwordx4 v19, s[24:27], s68 offen lds
    buffer_load_dwordx4 v20, s[24:27], s68 offen offset:1024 lds
    s_waitcnt vmcnt(12)
    ds_read_b64_tr_b16 a[104:105], v32 offset:2048
    ds_read_b64_tr_b16 a[106:107], v32 offset:3072
    ds_read_b64_tr_b16 a[108:109], v35 offset:2048
    ds_read_b64_tr_b16 a[110:111], v35 offset:3072
    s_add_u32 m0, s60, 0x20000
    s_mov_b32 s68, 0xc0000
    s_waitcnt lgkmcnt(4)
    buffer_load_dwordx4 v19, s[24:27], s68 offen lds
    buffer_load_dwordx4 v20, s[24:27], s68 offen offset:1024 lds
    s_waitcnt vmcnt(12)
    ds_read_b64_tr_b16 a[112:113], v32 offset:4096
    ds_read_b64_tr_b16 a[114:115], v32 offset:5120
    ds_read_b64_tr_b16 a[116:117], v35 offset:4096
    ds_read_b64_tr_b16 a[118:119], v35 offset:5120
    s_add_u32 m0, s60, 0x20800
    s_mov_b32 s68, 0xd0000
    s_waitcnt lgkmcnt(4)
    buffer_load_dwordx4 v19, s[24:27], s68 offen lds
    buffer_load_dwordx4 v20, s[24:27], s68 offen offset:1024 lds
    s_waitcnt vmcnt(12)
    ds_read_b64_tr_b16 a[120:121], v32 offset:6144
    ds_read_b64_tr_b16 a[122:123], v32 offset:7168
    ds_read_b64_tr_b16 a[124:125], v35 offset:6144
    ds_read_b64_tr_b16 a[126:127], v35 offset:7168
    s_add_u32 m0, s60, 0x21000
    s_mov_b32 s68, 0xe0000
    s_waitcnt lgkmcnt(4)
    buffer_load_dwordx4 v19, s[24:27], s68 offen lds
    buffer_load_dwordx4 v20, s[24:27], s68 offen offset:1024 lds
    s_waitcnt vmcnt(12)
    ds_read_b64_tr_b16 v[172:173], v31 offset:32768
    ds_read_b64_tr_b16 v[174:175], v31 offset:33792
    ds_read_b64_tr_b16 v[176:177], v34 offset:32768
    ds_read_b64_tr_b16 v[178:179], v34 offset:33792
    s_add_u32 m0, s60, 0x21800
    s_mov_b32 s68, 0xf0000
    s_waitcnt lgkmcnt(4)
    buffer_load_dwordx4 v19, s[24:27], s68 offen lds
    buffer_load_dwordx4 v20, s[24:27], s68 offen offset:1024 lds
    s_waitcnt vmcnt(12)
    ds_read_b64_tr_b16 v[180:181], v31 offset:34816
    ds_read_b64_tr_b16 v[182:183], v31 offset:35840
    ds_read_b64_tr_b16 v[184:185], v34 offset:34816
    ds_read_b64_tr_b16 v[186:187], v34 offset:35840
    s_add_u32 m0, s60, 0x0
    s_mov_b32 s68, 0x100000
    buffer_load_dwordx4 v19, s[24:27], s68 offen lds
    buffer_load_dwordx4 v20, s[24:27], s68 offen offset:1024 lds
    s_waitcnt vmcnt(12)
    ds_read_b64_tr_b16 v[188:189], v31 offset:36864
    ds_read_b64_tr_b16 v[190:191], v31 offset:37888
    ds_read_b64_tr_b16 v[192:193], v34 offset:36864
    ds_read_b64_tr_b16 v[194:195], v34 offset:37888
    s_add_u32 m0, s60, 0x800
    s_mov_b32 s68, 0x110000
    buffer_load_dwordx4 v19, s[24:27], s68 offen lds
    buffer_load_dwordx4 v20, s[24:27], s68 offen offset:1024 lds
    s_waitcnt vmcnt(12)
    ds_read_b64_tr_b16 v[196:197], v31 offset:38912
    ds_read_b64_tr_b16 v[198:199], v31 offset:39936
    ds_read_b64_tr_b16 v[200:201], v34 offset:38912
    ds_read_b64_tr_b16 v[202:203], v34 offset:39936
    s_add_u32 m0, s60, 0x1000
    s_mov_b32 s68, 0x120000
    buffer_load_dwordx4 v19, s[24:27], s68 offen lds
    buffer_load_dwordx4 v20, s[24:27], s68 offen offset:1024 lds
    s_waitcnt vmcnt(12)
    ds_read_b64_tr_b16 v[204:205], v32 offset:0
    ds_read_b64_tr_b16 v[206:207], v32 offset:1024
    ds_read_b64_tr_b16 v[208:209], v35 offset:0
    ds_read_b64_tr_b16 v[210:211], v35 offset:1024
    s_add_u32 m0, s60, 0x1800
    s_mov_b32 s68, 0x130000
    buffer_load_dwordx4 v19, s[24:27], s68 offen lds
    buffer_load_dwordx4 v20, s[24:27], s68 offen offset:1024 lds
    s_waitcnt vmcnt(12)
    ds_read_b64_tr_b16 v[212:213], v32 offset:2048
    ds_read_b64_tr_b16 v[214:215], v32 offset:3072
    ds_read_b64_tr_b16 v[216:217], v35 offset:2048
    ds_read_b64_tr_b16 v[218:219], v35 offset:3072
    s_add_u32 m0, s60, 0x8000
    s_mov_b32 s68, 0x140000
    buffer_load_dwordx4 v19, s[24:27], s68 offen lds
    buffer_load_dwordx4 v20, s[24:27], s68 offen offset:1024 lds
    s_waitcnt vmcnt(12)
    ds_read_b64_tr_b16 v[220:221], v32 offset:4096
    ds_read_b64_tr_b16 v[222:223], v32 offset:5120
    ds_read_b64_tr_b16 v[224:225], v35 offset:4096
    ds_read_b64_tr_b16 v[226:227], v35 offset:5120
    s_add_u32 m0, s60, 0x8800
    s_mov_b32 s68, 0x150000
    buffer_load_dwordx4 v19, s[24:27], s68 offen lds
    buffer_load_dwordx4 v20, s[24:27], s68 offen offset:1024 lds
    s_waitcnt vmcnt(12)
    ds_read_b64_tr_b16 v[228:229], v32 offset:6144
    ds_read_b64_tr_b16 v[230:231], v32 offset:7168
    ds_read_b64_tr_b16 v[232:233], v35 offset:6144
    ds_read_b64_tr_b16 v[234:235], v35 offset:7168
    s_add_u32 m0, s60, 0x9000
    s_mov_b32 s68, 0x160000
    buffer_load_dwordx4 v19, s[24:27], s68 offen lds
    buffer_load_dwordx4 v20, s[24:27], s68 offen offset:1024 lds
    s_add_u32 m0, s60, 0x9800
    s_mov_b32 s68, 0x170000
    buffer_load_dwordx4 v19, s[24:27], s68 offen lds
    buffer_load_dwordx4 v20, s[24:27], s68 offen offset:1024 lds
    s_add_u32 m0, s60, 0x10000
    s_mov_b32 s68, 0x180000
    buffer_load_dwordx4 v19, s[24:27], s68 offen lds
    buffer_load_dwordx4 v20, s[24:27], s68 offen offset:1024 lds
    s_add_u32 m0, s60, 0x10800
    s_mov_b32 s68, 0x190000
    buffer_load_dwordx4 v19, s[24:27], s68 offen lds
    buffer_load_dwordx4 v20, s[24:27], s68 offen offset:1024 lds
    s_add_u32 m0, s60, 0x11000
    s_mov_b32 s68, 0x1a0000
    buffer_load_dwordx4 v19, s[24:27], s68 offen lds
    buffer_load_dwordx4 v20, s[24:27], s68 offen offset:1024 lds
    s_add_u32 m0, s60, 0x11800
    s_mov_b32 s68, 0x1b0000
    buffer_load_dwordx4 v19, s[24:27], s68 offen lds
    buffer_load_dwordx4 v20, s[24:27], s68 offen offset:1024 lds
    v_mov_b32 v11, v7
    buffer_load_dword v10, v11, s[28:31], 0 offen sc1
    s_waitcnt vmcnt(0) lgkmcnt(0)
    s_waitcnt lgkmcnt(0)
    s_branch L_join
    s_nop 0
L_slow_rdym:
    s_mov_b32 s70, 0
L_spin_rdym:
    s_sleep 2
    buffer_load_dword v10, v11, s[36:39], 0 offen sc1
    s_add_u32 s70, s70, 1
    s_waitcnt vmcnt(0)
    v_cmp_ne_u32_e64 vcc, 1, v10
    s_nop 0
    s_cbranch_vccz L_ok_rdym
    s_cmp_lt_u32 s70, 0x100000
    s_cbranch_scc1 L_spin_rdym
    s_branch L_ok_rdym
L_slow_f1m:
    s_mov_b32 s70, 0
L_spin_f1m:
    s_sleep 2
    buffer_load_dword v10, v11, s[28:31], 0 offen sc1
    s_add_u32 s70, s70, 1
    s_waitcnt vmcnt(0)
    v_cmp_ne_u32_e64 vcc, 1, v10
    s_nop 0
    s_cbranch_vccz L_ok_f1m
    s_cmp_lt_u32 s70, 0x100000
    s_cbranch_scc1 L_spin_f1m
    s_branch L_ok_f1m
L_slow_f2:
    s_mov_b32 s70, 0
L_spin_f2:
    s_sleep 2
    buffer_load_dword v10, v11, s[28:31], 0 offen sc1
    s_add_u32 s70, s70, 1
    s_waitcnt vmcnt(0)
    v_cmp_ne_u32_e64 vcc, 1, v10
    s_nop 0
    s_cbranch_vccz L_ok_f2
    s_cmp_lt_u32 s70, 0x100000
    s_cbranch_scc1 L_spin_f2
    s_branch L_ok_f2
L_slow_f4m:
    s_mov_b32 s70, 0
L_spin_f4m:
    s_sleep 2
    buffer_load_dword v10, v11, s[28:31], 0 offen sc1
    s_add_u32 s70, s70, 1
    s_waitcnt vmcnt(0)
    v_cmp_ne_u32_e64 vcc, 1, v10
    s_nop 0
    s_cbranch_vccz L_ok_f4m
    s_cmp_lt_u32 s70, 0x100000
    s_cbranch_scc1 L_spin_f4m
    s_branch L_ok_f4m
L_slow_rdya:
    s_mov_b32 s70, 0
L_spin_rdya:
    s_sleep 2
    buffer_load_dword v10, v11, s[36:39], 0 offen sc1
    s_add_u32 s70, s70, 1
    s_waitcnt vmcnt(0)
    v_cmp_ne_u32_e64 vcc, 1, v10
    s_nop 0
    s_cbranch_vccz L_ok_rdya
    s_cmp_lt_u32 s70, 0x100000
    s_cbranch_scc1 L_spin_rdya
    s_branch L_ok_rdya
L_slow_f1a:
    s_mov_b32 s70, 0
L_spin_f1a:
    s_sleep 2
    buffer_load_dword v10, v11, s[28:31], 0 offen sc1
    s_add_u32 s70, s70, 1
    s_waitcnt vmcnt(0)
    v_cmp_ne_u32_e64 vcc, 1, v10
    s_nop 0
    s_cbranch_vccz L_ok_f1a
    s_cmp_lt_u32 s70, 0x100000
    s_cbranch_scc1 L_spin_f1a
    s_branch L_ok_f1a
L_slow_f5:
    s_mov_b32 s70, 0
L_spin_f5:
    s_sleep 2
    buffer_load_dword v10, v11, s[28:31], 0 offen sc1
    s_add_u32 s70, s70, 1
    s_waitcnt vmcnt(0)
    v_cmp_ne_u32_e64 vcc, 1, v10
    s_nop 0
    s_cbranch_vccz L_ok_f5
    s_cmp_lt_u32 s70, 0x100000
    s_cbranch_scc1 L_spin_f5
    s_branch L_ok_f5
L_slow_f3a:
    s_mov_b32 s70, 0
L_spin_f3a:
    s_sleep 2
    buffer_load_dword v10, v11, s[28:31], 0 offen sc1
    s_add_u32 s70, s70, 1
    s_waitcnt vmcnt(0)
    v_cmp_ne_u32_e64 vcc, 1, v10
    s_nop 0
    s_cbranch_vccz L_ok_f3a
    s_cmp_lt_u32 s70, 0x100000
    s_cbranch_scc1 L_spin_f3a
    s_branch L_ok_f3a
L_slow_f2a:
    s_mov_b32 s70, 0
L_spin_f2a:
    s_sleep 2
    buffer_load_dword v10, v11, s[28:31], 0 offen sc1
    s_add_u32 s70, s70, 1
    s_waitcnt vmcnt(0)
    v_cmp_ne_u32_e64 vcc, 1, v10
    s_nop 0
    s_cbranch_vccz L_ok_f2a
    s_cmp_lt_u32 s70, 0x100000
    s_cbranch_scc1 L_spin_f2a
    s_branch L_ok_f2a
L_slow_f4a:
    s_mov_b32 s70, 0
L_spin_f4a:
    s_sleep 2
    buffer_load_dword v10, v11, s[28:31], 0 offen sc1
    s_add_u32 s70, s70, 1
    s_waitcnt vmcnt(0)
    v_cmp_ne_u32_e64 vcc, 1, v10
    s_nop 0
    s_cbranch_vccz L_ok_f4a
    s_cmp_lt_u32 s70, 0x100000
    s_cbranch_scc1 L_spin_f4a
    s_branch L_ok_f4a
L_slow_rdyp:
    s_mov_b32 s70, 0
L_spin_rdyp:
    s_sleep 2
    buffer_load_dword v10, v11, s[36:39], 0 offen sc1
    s_add_u32 s70, s70, 1
    s_waitcnt vmcnt(0)
    v_cmp_ne_u32_e64 vcc, 1, v10
    s_nop 0
    s_cbranch_vccz L_ok_rdyp
    s_cmp_lt_u32 s70, 0x100000
    s_cbranch_scc1 L_spin_rdyp
    s_branch L_ok_rdyp
L_slow_f1p:
    s_mov_b32 s70, 0
L_spin_f1p:
    s_sleep 2
    buffer_load_dword v10, v11, s[28:31], 0 offen sc1
    s_add_u32 s70, s70, 1
    s_waitcnt vmcnt(0)
    v_cmp_ne_u32_e64 vcc, 1, v10
    s_nop 0
    s_cbranch_vccz L_ok_f1p
    s_cmp_lt_u32 s70, 0x100000
    s_cbranch_scc1 L_spin_f1p
    s_branch L_ok_f1p
L_last:
    s_endpgm
.section .rodata,"a"
.p2align 6
.amdhsa_kernel recurrent_scan__linear_attn_block__mixer_token_mlp__prompt_kernel
  .amdhsa_next_free_vgpr 512
  .amdhsa_next_free_sgpr 102
  .amdhsa_accum_offset 256
  .amdhsa_group_segment_fixed_size 0
  .amdhsa_kernarg_size 88
  .amdhsa_user_sgpr_count 2
  .amdhsa_user_sgpr_kernarg_segment_ptr 1
  .amdhsa_system_sgpr_workgroup_id_x 1
  .amdhsa_float_denorm_mode_32 3
.end_amdhsa_kernel
```
